```python
import torch

def _softmax(x, axis=-1):
    return torch.softmax(x, dim=axis)

def _gelu(x):
    return torch.nn.functional.gelu(x, approximate='tanh')

def _silu(x):
    return torch.nn.functional.silu(x)

def _sigmoid(x):
    return torch.sigmoid(x)

def _layernorm(x, axis=-1, eps=1e-05):
    m = x.mean(dim=axis, keepdim=True)
    v = x.var(dim=axis, keepdim=True, unbiased=False)
    return (x - m) / torch.sqrt(v + eps)

def _scatter_add(tgt, idx, src, axis=0):
    return tgt.clone().index_add_(axis, idx, src)

def _segment_sum(src, seg, n):
    out = torch.zeros((n,) + src.shape[1:], dtype=src.dtype)
    return out.index_add_(0, seg, src)

def _pad(x, pw):
    flat = tuple((v for pair in reversed(pw) for v in pair))
    return torch.nn.functional.pad(x, flat)
kernel_name = 'gated_mix__sliding_block__memory_aug_recurrent_mem_tr__prompt'

def setup_inputs():

    _w = lambda a: (lambda t: t.to(torch.bfloat16) if t.is_floating_point() else t)(torch.as_tensor(a))

    def _A_setup():
        B, S, D = (1, 2048, 512)
        return {'x': _w((lambda *s: torch.randn(*s, dtype=torch.bfloat16) * 0.05)(B, S, D)), 'wqkv': _w((lambda *s: torch.randn(*s, dtype=torch.bfloat16) * 1.6)(D, 3 * D)), 'wo': _w((lambda *s: torch.randn(*s, dtype=torch.bfloat16) * 0.05)(D, D))}
    _A_in = _A_setup()

    def _B_setup():
        B, S, Dm = (1, 2048, 512)
        H, Dh = (32, 128)
        M, seg = (8, 32)
        seg = min(seg, S)
        S = S // seg * seg
        return {'x': _w((lambda *s: torch.randn(*s, dtype=torch.bfloat16) * 0.05)(B, S, Dm)), 'mem0': _w((lambda *s: torch.randn(*s, dtype=torch.bfloat16) * 1.6)(B, M, Dm)), 'Wq': _w((lambda *s: torch.randn(*s, dtype=torch.bfloat16) * 0.8)(Dm, H, Dh) * Dm ** (-0.5)), 'Wk': _w((lambda *s: torch.randn(*s, dtype=torch.bfloat16) * 0.8)(Dm, H, Dh) * Dm ** (-0.5)), 'Wv': _w((lambda *s: torch.randn(*s, dtype=torch.bfloat16) * 1.6)(Dm, H, Dh) * Dm ** (-0.5)), 'Wo': _w((lambda *s: torch.randn(*s, dtype=torch.bfloat16) * 1.6)(H, Dh, Dm) * (H * Dh) ** (-0.5)), 'seg_len': seg}
    _B_in = _B_setup()
    return {'A_x': _A_in['x'], 'A_wqkv': _A_in['wqkv'], 'A_wo': _A_in['wo'], 'B_x': _B_in['x'], 'B_mem0': _B_in['mem0'], 'B_Wq': _B_in['Wq'], 'B_Wk': _B_in['Wk'], 'B_Wv': _B_in['Wv'], 'B_Wo': _B_in['Wo'], 'B_seg_len': _B_in['seg_len'], 'gate_w': _w((lambda *s: torch.randn(*s, dtype=torch.bfloat16) * 0.05)(512) * 16.0)}

def reference(A_x, A_wqkv, A_wo, B_x, B_mem0, B_Wq, B_Wk, B_Wv, B_Wo, B_seg_len, gate_w):

    def _A_ref(x, wqkv, wo):
        B, S, D = x.shape
        H = 32
        Dh = D // H
        W = 256
        qkv = (lambda x, *d: x.permute(*d))((x @ wqkv).reshape(B, S, 3, H, Dh), 2, 0, 3, 1, 4)
        q, k, v = (qkv[0], qkv[1], qkv[2])
        scores = torch.einsum('bhqd,bhkd->bhqk', q, k) * Dh ** (-0.5)
        idx = torch.arange(S)
        mask = (idx[:, None] - idx[None, :] >= 0) & (idx[:, None] - idx[None, :] < W)
        scores = torch.where(mask[None, None], scores, -1000000000.0)
        p = _softmax(scores, axis=-1)
        o = torch.einsum('bhqk,bhkd->bhqd', p, v)
        return (lambda x, *d: x.permute(*d))(o, 0, 2, 1, 3).reshape(B, S, D) @ wo

    def _B_ref(x, mem0, Wq, Wk, Wv, Wo, seg_len):
        B, S, Dm = x.shape
        H, Dh = (Wq.shape[1], Wq.shape[2])
        M = mem0.shape[1]
        scale = Dh ** (-0.5)
        n_seg = S // seg_len
        L = M + seg_len
        idx = torch.arange(L)
        mask = (idx[:, None] < M) | (idx[:, None] >= idx[None, :])
        mem = mem0
        outs = []
        for s in range(n_seg):
            xs = x[:, s * seg_len:(s + 1) * seg_len, :].clone()
            h = torch.concatenate([mem, xs], axis=1)
            q = torch.einsum('btd,dhe->bhte', h, Wq)
            k = torch.einsum('btd,dhe->bhte', h, Wk)
            v = torch.einsum('btd,dhe->bhte', h, Wv)
            scores = torch.einsum('bhqe,bhke->bhqk', q, k) * scale
            scores = torch.where(mask[None, None], scores, -1000000000.0)
            p = _softmax(scores, axis=-1)
            o = torch.einsum('bhqk,bhke->bhqe', p, v)
            o = torch.einsum('bhte,hed->btd', o, Wo)
            mem = o[:, :M, :].clone()
            outs.append(o[:, M:, :])
        return torch.concatenate(outs, axis=1)
    x = A_x
    g = _sigmoid((x * gate_w).sum(-1, keepdims=True))
    a = _A_ref(x, A_wqkv, A_wo)
    b = _B_ref(x, B_mem0, B_Wq, B_Wk, B_Wv, B_Wo, B_seg_len)
    return g * a + (1 - g) * b
```

```asm
; @launch grid=(256,1,1) block=(256,1,1) lds=163840
.amdgcn_target "amdgcn-amd-amdhsa--gfx950"
.text
.globl gated_mix__sliding_block__memory_aug_recurrent_mem_tr__prompt_kernel
.p2align 8
.type gated_mix__sliding_block__memory_aug_recurrent_mem_tr__prompt_kernel,@function
gated_mix__sliding_block__memory_aug_recurrent_mem_tr__prompt_kernel:
    s_cmp_ge_u32 s2, 256
    s_cbranch_scc1 L_end
    s_load_dwordx16 s[16:31], s[0:1], 0
    s_load_dwordx8 s[32:39], s[0:1], 64
    s_load_dwordx4 s[40:43], s[0:1], 96
    v_lshrrev_b32 v1, 6, v0
    s_nop 0
    v_readfirstlane_b32 s3, v1
    v_and_b32 v0, 63, v0
    s_waitcnt lgkmcnt(0)
    s_and_b32 s6, s2, 7
    s_cmp_lg_u32 s6, 0
    s_cbranch_scc1 L_worker
    s_lshr_b32 s4, s2, 3
    v_lshlrev_b32 v14, 4, v0
    s_lshl_b32 s67, s3, 12
    s_lshl_b32 s66, s4, 17
    s_add_u32 s66, s66, s67
    s_add_u32 m0, s67, 32768
    s_add_u32 s64, s32, s66
    s_addc_u32 s65, s33, 0
    global_load_lds_dwordx4 v14, s[64:65] offset:0
    global_load_lds_dwordx4 v14, s[64:65] offset:1024
    global_load_lds_dwordx4 v14, s[64:65] offset:2048
    global_load_lds_dwordx4 v14, s[64:65] offset:3072
    s_add_u32 m0, m0, 16384
    s_add_u32 s64, s64, 16384
    s_addc_u32 s65, s65, 0
    global_load_lds_dwordx4 v14, s[64:65] offset:0
    global_load_lds_dwordx4 v14, s[64:65] offset:1024
    global_load_lds_dwordx4 v14, s[64:65] offset:2048
    global_load_lds_dwordx4 v14, s[64:65] offset:3072
    s_add_u32 m0, m0, 16384
    s_add_u32 s64, s64, 16384
    s_addc_u32 s65, s65, 0
    global_load_lds_dwordx4 v14, s[64:65] offset:0
    global_load_lds_dwordx4 v14, s[64:65] offset:1024
    global_load_lds_dwordx4 v14, s[64:65] offset:2048
    global_load_lds_dwordx4 v14, s[64:65] offset:3072
    s_add_u32 m0, m0, 16384
    s_add_u32 s64, s64, 16384
    s_addc_u32 s65, s65, 0
    global_load_lds_dwordx4 v14, s[64:65] offset:0
    global_load_lds_dwordx4 v14, s[64:65] offset:1024
    global_load_lds_dwordx4 v14, s[64:65] offset:2048
    global_load_lds_dwordx4 v14, s[64:65] offset:3072
    s_add_u32 m0, m0, 16384
    s_add_u32 s64, s64, 16384
    s_addc_u32 s65, s65, 0
    global_load_lds_dwordx4 v14, s[64:65] offset:0
    global_load_lds_dwordx4 v14, s[64:65] offset:1024
    global_load_lds_dwordx4 v14, s[64:65] offset:2048
    global_load_lds_dwordx4 v14, s[64:65] offset:3072
    s_add_u32 m0, m0, 16384
    s_add_u32 s64, s64, 16384
    s_addc_u32 s65, s65, 0
    global_load_lds_dwordx4 v14, s[64:65] offset:0
    global_load_lds_dwordx4 v14, s[64:65] offset:1024
    global_load_lds_dwordx4 v14, s[64:65] offset:2048
    global_load_lds_dwordx4 v14, s[64:65] offset:3072
    s_add_u32 m0, m0, 16384
    s_add_u32 s64, s64, 16384
    s_addc_u32 s65, s65, 0
    global_load_lds_dwordx4 v14, s[64:65] offset:0
    global_load_lds_dwordx4 v14, s[64:65] offset:1024
    global_load_lds_dwordx4 v14, s[64:65] offset:2048
    global_load_lds_dwordx4 v14, s[64:65] offset:3072
    s_add_u32 m0, m0, 16384
    s_add_u32 s64, s64, 16384
    s_addc_u32 s65, s65, 0
    global_load_lds_dwordx4 v14, s[64:65] offset:0
    global_load_lds_dwordx4 v14, s[64:65] offset:1024
    global_load_lds_dwordx4 v14, s[64:65] offset:2048
    global_load_lds_dwordx4 v14, s[64:65] offset:3072
    v_mov_b32 v13, v0
    v_lshlrev_b32 v0, 4, v13
    v_lshrrev_b32 v14, 4, v13
    v_lshlrev_b32 v1, 7, v14
    v_and_b32 v14, 7, v13
    v_lshl_add_u32 v1, v14, 4, v1
    s_lshl_b32 s64, s3, 11
    v_add_u32 v2, s64, v0
    v_and_b32 v14, 8, v13
    v_cmp_ne_u32 vcc, 0, v14
    v_mov_b32 v6, 0x4444
    v_mov_b32 v15, 0xeeee
    v_cndmask_b32 v6, v6, v15, vcc
    v_and_b32 v14, 15, v13
    v_lshrrev_b32 v15, 5, v13
    v_lshl_add_u32 v14, v15, 4, v14
    v_lshlrev_b32 v14, 5, v14
    v_bfe_u32 v15, v13, 4, 1
    v_lshl_add_u32 v14, v15, 4, v14
    s_lshl_b32 s64, s3, 10
    s_add_u32 s64, s64, 24576
    v_add_u32 v7, s64, v14
    v_lshrrev_b32 v14, 2, v13
    v_lshlrev_b32 v8, 5, v14
    v_and_b32 v14, 1, v13
    v_lshl_add_u32 v8, v14, 4, v8
    v_bfe_u32 v14, v13, 1, 1
    v_xor_b32 v14, 1, v14
    v_lshl_add_u32 v8, v14, 3, v8
    s_lshl_b32 s64, s3, 9
    s_add_u32 s64, s64, 28672
    v_add_u32 v9, s64, v1
    v_lshrrev_b32 v14, 5, v13
    v_lshlrev_b32 v10, 14, v14
    v_bfe_u32 v14, v13, 2, 2
    v_lshl_add_u32 v10, v14, 12, v10
    v_bfe_u32 v14, v13, 4, 1
    v_lshl_add_u32 v10, v14, 11, v10
    v_and_b32 v14, 3, v13
    v_lshl_add_u32 v10, v14, 4, v10
    s_lshl_b32 s64, s3, 16
    s_lshl_b32 s65, s4, 6
    s_add_u32 s64, s64, s65
    v_add_u32 v10, s64, v10
    s_lshl_b32 s66, s4, 2
    s_add_u32 s66, s66, s3
    s_lshl_b32 s64, s66, 11
    s_add_u32 s16, s42, s64
    s_addc_u32 s17, s43, 0
    s_add_u32 s16, s16, 83886080
    s_addc_u32 s17, s17, 0
    s_add_u32 s18, s42, s64
    s_addc_u32 s19, s43, 0
    s_add_u32 s18, s18, 84148224
    s_addc_u32 s19, s19, 0
    v_bfe_u32 v14, v13, 4, 1
    v_lshlrev_b32 v14, 5, v14
    v_and_b32 v15, 7, v13
    v_lshl_add_u32 v14, v15, 2, v14
    s_lshl_b32 s64, s66, 6
    v_add_u32 v11, s64, v14
    s_lshl_b32 s64, s3, 12
    s_add_u32 s64, s64, 32768
    v_add_u32 v12, s64, v0
    v_add_u32 v3, 65536, v12
    s_add_u32 s44, s42, 84410368
    s_addc_u32 s45, s43, 0
    s_add_u32 s48, s42, 83886080
    s_addc_u32 s49, s43, 0
    s_add_u32 s52, s42, 83918848
    s_addc_u32 s53, s43, 0
    s_add_u32 s46, s42, 84418560
    s_addc_u32 s47, s43, 0
    s_add_u32 s50, s42, 84148224
    s_addc_u32 s51, s43, 0
    s_add_u32 s54, s42, 84180992
    s_addc_u32 s55, s43, 0
    s_lshl_b32 s64, s4, 19
    s_lshl_b32 s65, s3, 11
    s_add_u32 s64, s64, s65
    s_add_u32 s56, s42, s64
    s_addc_u32 s57, s43, 0
    s_add_u32 s58, s42, s64
    s_addc_u32 s59, s43, 0
    s_add_u32 s58, s58, 16777216
    s_addc_u32 s59, s59, 0
    s_mul_i32 s64, s4, 266240
    s_lshl_b32 s65, s3, 10
    s_add_u32 s64, s64, s65
    s_add_u32 s60, s42, s64
    s_addc_u32 s61, s43, 0
    s_add_u32 s60, s60, 88215552
    s_addc_u32 s61, s61, 0
    v_lshlrev_b32 v4, 7, v13
    v_add_u32 v4, 84475904, v4
    s_lshl_b32 s78, s3, 11
    s_add_u32 s78, s78, 8192
    s_mov_b32 s69, 0x3e0293ee
    s_mov_b32 s80, s69
    s_mov_b32 s81, s69
    s_mov_b32 s62, 0x3f803f80
    s_mov_b32 s63, 0x3f803f80
    v_and_b32 v14, 4, v13
    v_cmp_ne_u32 s[70:71], 0, v14
    s_cmp_eq_u32 s3, 0
    s_cselect_b32 s72, 1, 0
    s_mov_b32 s73, 0
    s_lshl_b32 s79, s4, 7
    s_lshl_b32 s64, s3, 2
    s_add_u32 s79, s79, s64
    s_add_u32 s79, s79, 84520960
    s_add_u32 s36, s42, s79
    s_addc_u32 s37, s43, 0
    v_and_b32 v14, 1, v13
    v_lshlrev_b32 v14, 4, v14
    v_mov_b32 v15, 0x3f80
    v_lshlrev_b32 v15, v14, v15
    v_and_b32 v14, 14, v13
    v_cmp_eq_u32 vcc, 0, v14
    s_nop 1
    v_cndmask_b32 v20, 0, v15, vcc
    v_cmp_eq_u32 vcc, 2, v14
    s_nop 1
    v_cndmask_b32 v21, 0, v15, vcc
    v_cmp_eq_u32 vcc, 4, v14
    s_nop 1
    v_cndmask_b32 v22, 0, v15, vcc
    v_cmp_eq_u32 vcc, 6, v14
    s_nop 1
    v_cndmask_b32 v23, 0, v15, vcc
    v_cmp_le_u32 vcc, 32, v13
    v_mov_b32 v14, 0xf149f2ca
    s_nop 0
    v_cndmask_b32 v24, 0, v14, vcc
    v_cndmask_b32 v25, 0, v14, vcc
    v_cndmask_b32 v26, 0, v14, vcc
    v_cndmask_b32 v27, 0, v14, vcc
    v_mov_b32 v16, 0
    v_mov_b32 v17, 0
    v_mov_b32 v18, 0
    v_mov_b32 v19, 0
    s_getreg_b32 s64, hwreg(HW_REG_XCC_ID)
    s_and_b32 s64, s64, 15
    s_lshl_b32 s64, 1, s64
    v_mov_b32 v14, 4
    v_mov_b32 v15, s64
    s_mov_b64 exec, s[72:73]
    global_atomic_or v14, v15, s[40:41]
    s_mov_b64 exec, -1
    v_mov_b32 v40, -1
    v_mov_b32 v41, -1
    v_mov_b32 v42, -1
    v_mov_b32 v43, -1
    global_store_dwordx4 v0, v[40:43], s[16:17] offset:0 sc1
    global_store_dwordx4 v0, v[40:43], s[16:17] offset:1024 sc1
    global_store_dwordx4 v0, v[40:43], s[18:19] offset:0 sc1
    global_store_dwordx4 v0, v[40:43], s[18:19] offset:1024 sc1
    s_lshl_b32 s66, s4, 2
    s_add_u32 s66, s66, s3
    s_lshr_b32 s64, s66, 4
    s_lshl_b32 s64, s64, 7
    s_bfe_u32 s65, s66, 0x10003
    s_lshl_b32 s65, s65, 5
    s_add_u32 s64, s64, s65
    s_bfe_u32 s65, s66, 0x20001
    s_lshl_b32 s65, s65, 3
    s_add_u32 s64, s64, s65
    s_and_b32 s65, s66, 1
    s_lshl_b32 s65, s65, 12
    s_add_u32 s64, s64, s65
    v_bfe_u32 v14, v13, 4, 1
    v_lshlrev_b32 v14, 11, v14
    v_bfe_u32 v15, v13, 2, 1
    v_lshl_add_u32 v14, v15, 10, v14
    v_and_b32 v15, 3, v13
    v_lshl_add_u32 v14, v15, 1, v14
    v_add_u32 v14, s64, v14
    global_load_ushort v44, v14, s[24:25]
    global_load_ushort v45, v14, s[24:25] offset:64
    s_mov_b32 s68, 0
    s_mov_b32 s76, 0
    s_mov_b32 s77, 0
    v_lshrrev_b32 v14, 4, v13
    v_and_b32 v15, 15, v13
    v_lshlrev_b32 v15, 4, v15
    v_lshl_add_u32 v48, v14, 13, v15
    s_lshl_b32 s64, s4, 8
    s_lshl_b32 s65, s3, 17
    s_add_u32 s64, s64, s65
    v_add_u32 v48, s64, v48
    v_bfe_u32 v14, v13, 3, 1
    v_lshlrev_b32 v49, 5, v14
    v_and_b32 v14, 3, v13
    v_lshl_add_u32 v49, v14, 3, v49
    s_lshl_b32 s64, s3, 8
    s_add_u32 s64, s64, 32768
    v_add_u32 v51, s64, v49
    s_lshl_b32 s64, s3, 6
    s_add_u32 s64, s64, 32768
    v_add_u32 v49, s64, v49
    v_bfe_u32 v14, v13, 2, 1
    v_lshl_add_u32 v49, v14, 13, v49
    v_lshl_add_u32 v51, v14, 10, v51
    v_bfe_u32 v14, v13, 5, 1
    v_lshl_add_u32 v49, v14, 10, v49
    v_lshl_add_u32 v51, v14, 12, v51
    v_bfe_u32 v14, v13, 4, 1
    v_lshl_add_u32 v49, v14, 9, v49
    v_lshl_add_u32 v51, v14, 14, v51
    v_add_u32 v50, 65536, v49
    v_add_u32 v52, 65536, v51
    s_lshl_b32 s67, s3, 12
    s_add_u32 s67, s67, 32768
    s_waitcnt vmcnt(34)
    s_barrier
    s_waitcnt vmcnt(30)
    s_barrier
    ds_read_b64_tr_b16 v[96:97], v51 offset:0
    ds_read_b64_tr_b16 v[98:99], v51 offset:2048
    ds_read_b64_tr_b16 v[100:101], v51 offset:8192
    ds_read_b64_tr_b16 v[102:103], v51 offset:10240
    ds_read_b64_tr_b16 v[144:145], v51 offset:64
    ds_read_b64_tr_b16 v[146:147], v51 offset:2112
    ds_read_b64_tr_b16 v[148:149], v51 offset:8256
    ds_read_b64_tr_b16 v[150:151], v51 offset:10304
    ds_read_b64_tr_b16 v[160:161], v51 offset:128
    ds_read_b64_tr_b16 v[162:163], v51 offset:2176
    ds_read_b64_tr_b16 v[164:165], v51 offset:8320
    ds_read_b64_tr_b16 v[166:167], v51 offset:10368
    ds_read_b64_tr_b16 v[176:177], v51 offset:192
    ds_read_b64_tr_b16 v[178:179], v51 offset:2240
    ds_read_b64_tr_b16 v[180:181], v51 offset:8384
    ds_read_b64_tr_b16 v[182:183], v51 offset:10432
    s_waitcnt lgkmcnt(0)
    s_waitcnt vmcnt(26)
    s_barrier
    s_add_u32 s64, s26, 0
    s_addc_u32 s65, s27, 0
    s_add_u32 m0, s67, 0
    s_nop 0
    global_load_lds_dwordx4 v48, s[64:65]
    s_add_u32 m0, s67, 1024
    s_add_u32 s64, s64, 32768
    s_addc_u32 s65, s65, 0
    global_load_lds_dwordx4 v48, s[64:65]
    s_add_u32 m0, s67, 2048
    s_add_u32 s64, s64, 32768
    s_addc_u32 s65, s65, 0
    global_load_lds_dwordx4 v48, s[64:65]
    s_add_u32 m0, s67, 3072
    s_add_u32 s64, s64, 32768
    s_addc_u32 s65, s65, 0
    global_load_lds_dwordx4 v48, s[64:65]
    s_add_u32 s64, s26, 524288
    s_addc_u32 s65, s27, 0
    s_add_u32 m0, s67, 16384
    s_nop 0
    global_load_lds_dwordx4 v48, s[64:65]
    s_add_u32 m0, s67, 17408
    s_add_u32 s64, s64, 32768
    s_addc_u32 s65, s65, 0
    global_load_lds_dwordx4 v48, s[64:65]
    s_add_u32 m0, s67, 18432
    s_add_u32 s64, s64, 32768
    s_addc_u32 s65, s65, 0
    global_load_lds_dwordx4 v48, s[64:65]
    s_add_u32 m0, s67, 19456
    s_add_u32 s64, s64, 32768
    s_addc_u32 s65, s65, 0
    global_load_lds_dwordx4 v48, s[64:65]
    s_waitcnt vmcnt(30)
    s_barrier
    ds_read_b64_tr_b16 v[104:105], v51 offset:32768
    ds_read_b64_tr_b16 v[106:107], v51 offset:34816
    ds_read_b64_tr_b16 v[108:109], v51 offset:40960
    ds_read_b64_tr_b16 v[110:111], v51 offset:43008
    ds_read_b64_tr_b16 v[152:153], v51 offset:32832
    ds_read_b64_tr_b16 v[154:155], v51 offset:34880
    ds_read_b64_tr_b16 v[156:157], v51 offset:41024
    ds_read_b64_tr_b16 v[158:159], v51 offset:43072
    ds_read_b64_tr_b16 v[168:169], v51 offset:32896
    ds_read_b64_tr_b16 v[170:171], v51 offset:34944
    ds_read_b64_tr_b16 v[172:173], v51 offset:41088
    ds_read_b64_tr_b16 v[174:175], v51 offset:43136
    ds_read_b64_tr_b16 v[184:185], v51 offset:32960
    ds_read_b64_tr_b16 v[186:187], v51 offset:35008
    ds_read_b64_tr_b16 v[188:189], v51 offset:41152
    ds_read_b64_tr_b16 v[190:191], v51 offset:43200
    s_waitcnt lgkmcnt(0)
    s_waitcnt vmcnt(26)
    s_barrier
    s_add_u32 s64, s26, 1048576
    s_addc_u32 s65, s27, 0
    s_add_u32 m0, s67, 32768
    s_nop 0
    global_load_lds_dwordx4 v48, s[64:65]
    s_add_u32 m0, s67, 33792
    s_add_u32 s64, s64, 32768
    s_addc_u32 s65, s65, 0
    global_load_lds_dwordx4 v48, s[64:65]
    s_add_u32 m0, s67, 34816
    s_add_u32 s64, s64, 32768
    s_addc_u32 s65, s65, 0
    global_load_lds_dwordx4 v48, s[64:65]
    s_add_u32 m0, s67, 35840
    s_add_u32 s64, s64, 32768
    s_addc_u32 s65, s65, 0
    global_load_lds_dwordx4 v48, s[64:65]
    s_add_u32 s64, s26, 1572864
    s_addc_u32 s65, s27, 0
    s_add_u32 m0, s67, 49152
    s_nop 0
    global_load_lds_dwordx4 v48, s[64:65]
    s_add_u32 m0, s67, 50176
    s_add_u32 s64, s64, 32768
    s_addc_u32 s65, s65, 0
    global_load_lds_dwordx4 v48, s[64:65]
    s_add_u32 m0, s67, 51200
    s_add_u32 s64, s64, 32768
    s_addc_u32 s65, s65, 0
    global_load_lds_dwordx4 v48, s[64:65]
    s_add_u32 m0, s67, 52224
    s_add_u32 s64, s64, 32768
    s_addc_u32 s65, s65, 0
    global_load_lds_dwordx4 v48, s[64:65]
    s_waitcnt vmcnt(30)
    s_barrier
    ds_read_b64_tr_b16 v[192:193], v52 offset:0
    ds_read_b64_tr_b16 v[194:195], v52 offset:2048
    ds_read_b64_tr_b16 v[196:197], v52 offset:8192
    ds_read_b64_tr_b16 v[198:199], v52 offset:10240
    ds_read_b64_tr_b16 v[208:209], v52 offset:64
    ds_read_b64_tr_b16 v[210:211], v52 offset:2112
    ds_read_b64_tr_b16 v[212:213], v52 offset:8256
    ds_read_b64_tr_b16 v[214:215], v52 offset:10304
    ds_read_b64_tr_b16 v[224:225], v52 offset:128
    ds_read_b64_tr_b16 v[226:227], v52 offset:2176
    ds_read_b64_tr_b16 v[228:229], v52 offset:8320
    ds_read_b64_tr_b16 v[230:231], v52 offset:10368
    ds_read_b64_tr_b16 v[240:241], v52 offset:192
    ds_read_b64_tr_b16 v[242:243], v52 offset:2240
    ds_read_b64_tr_b16 v[244:245], v52 offset:8384
    ds_read_b64_tr_b16 v[246:247], v52 offset:10432
    s_waitcnt lgkmcnt(0)
    s_waitcnt vmcnt(26)
    s_barrier
    s_add_u32 s64, s26, 2097152
    s_addc_u32 s65, s27, 0
    s_add_u32 m0, s67, 65536
    s_nop 0
    global_load_lds_dwordx4 v48, s[64:65]
    s_add_u32 m0, s67, 66560
    s_add_u32 s64, s64, 32768
    s_addc_u32 s65, s65, 0
    global_load_lds_dwordx4 v48, s[64:65]
    s_add_u32 m0, s67, 67584
    s_add_u32 s64, s64, 32768
    s_addc_u32 s65, s65, 0
    global_load_lds_dwordx4 v48, s[64:65]
    s_add_u32 m0, s67, 68608
    s_add_u32 s64, s64, 32768
    s_addc_u32 s65, s65, 0
    global_load_lds_dwordx4 v48, s[64:65]
    s_add_u32 s64, s26, 2621440
    s_addc_u32 s65, s27, 0
    s_add_u32 m0, s67, 81920
    s_nop 0
    global_load_lds_dwordx4 v48, s[64:65]
    s_add_u32 m0, s67, 82944
    s_add_u32 s64, s64, 32768
    s_addc_u32 s65, s65, 0
    global_load_lds_dwordx4 v48, s[64:65]
    s_add_u32 m0, s67, 83968
    s_add_u32 s64, s64, 32768
    s_addc_u32 s65, s65, 0
    global_load_lds_dwordx4 v48, s[64:65]
    s_add_u32 m0, s67, 84992
    s_add_u32 s64, s64, 32768
    s_addc_u32 s65, s65, 0
    global_load_lds_dwordx4 v48, s[64:65]
    s_waitcnt vmcnt(30)
    s_barrier
    ds_read_b64_tr_b16 v[200:201], v52 offset:32768
    ds_read_b64_tr_b16 v[202:203], v52 offset:34816
    ds_read_b64_tr_b16 v[204:205], v52 offset:40960
    ds_read_b64_tr_b16 v[206:207], v52 offset:43008
    ds_read_b64_tr_b16 v[216:217], v52 offset:32832
    ds_read_b64_tr_b16 v[218:219], v52 offset:34880
    ds_read_b64_tr_b16 v[220:221], v52 offset:41024
    ds_read_b64_tr_b16 v[222:223], v52 offset:43072
    ds_read_b64_tr_b16 v[232:233], v52 offset:32896
    ds_read_b64_tr_b16 v[234:235], v52 offset:34944
    ds_read_b64_tr_b16 v[236:237], v52 offset:41088
    ds_read_b64_tr_b16 v[238:239], v52 offset:43136
    ds_read_b64_tr_b16 v[248:249], v52 offset:32960
    ds_read_b64_tr_b16 v[250:251], v52 offset:35008
    ds_read_b64_tr_b16 v[252:253], v52 offset:41152
    ds_read_b64_tr_b16 v[254:255], v52 offset:43200
    s_waitcnt lgkmcnt(0)
    s_waitcnt vmcnt(20)
    s_barrier
    s_add_u32 s64, s26, 3145728
    s_addc_u32 s65, s27, 0
    s_add_u32 m0, s67, 98304
    s_nop 0
    global_load_lds_dwordx4 v48, s[64:65]
    s_add_u32 m0, s67, 99328
    s_add_u32 s64, s64, 32768
    s_addc_u32 s65, s65, 0
    global_load_lds_dwordx4 v48, s[64:65]
    s_add_u32 m0, s67, 100352
    s_add_u32 s64, s64, 32768
    s_addc_u32 s65, s65, 0
    global_load_lds_dwordx4 v48, s[64:65]
    s_add_u32 m0, s67, 101376
    s_add_u32 s64, s64, 32768
    s_addc_u32 s65, s65, 0
    global_load_lds_dwordx4 v48, s[64:65]
    s_add_u32 s64, s26, 3670016
    s_addc_u32 s65, s27, 0
    s_add_u32 m0, s67, 114688
    s_nop 0
    global_load_lds_dwordx4 v48, s[64:65]
    s_add_u32 m0, s67, 115712
    s_add_u32 s64, s64, 32768
    s_addc_u32 s65, s65, 0
    global_load_lds_dwordx4 v48, s[64:65]
    s_add_u32 m0, s67, 116736
    s_add_u32 s64, s64, 32768
    s_addc_u32 s65, s65, 0
    global_load_lds_dwordx4 v48, s[64:65]
    s_add_u32 m0, s67, 117760
    s_add_u32 s64, s64, 32768
    s_addc_u32 s65, s65, 0
    global_load_lds_dwordx4 v48, s[64:65]
    ds_read_b64_tr_b16 a[0:1], v49 offset:0
    ds_read_b64_tr_b16 a[2:3], v49 offset:256
    ds_read_b64_tr_b16 a[4:5], v49 offset:2048
    ds_read_b64_tr_b16 a[6:7], v49 offset:2304
    ds_read_b64_tr_b16 a[8:9], v49 offset:4096
    ds_read_b64_tr_b16 a[10:11], v49 offset:4352
    ds_read_b64_tr_b16 a[12:13], v49 offset:6144
    ds_read_b64_tr_b16 a[14:15], v49 offset:6400
    s_waitcnt lgkmcnt(0)
    s_waitcnt vmcnt(24)
    s_barrier
    s_add_u32 s64, s28, 3670016
    s_addc_u32 s65, s29, 0
    s_add_u32 m0, s67, 0
    s_nop 0
    global_load_lds_dwordx4 v48, s[64:65]
    s_add_u32 m0, s67, 1024
    s_add_u32 s64, s64, 32768
    s_addc_u32 s65, s65, 0
    global_load_lds_dwordx4 v48, s[64:65]
    s_add_u32 m0, s67, 2048
    s_add_u32 s64, s64, 32768
    s_addc_u32 s65, s65, 0
    global_load_lds_dwordx4 v48, s[64:65]
    s_add_u32 m0, s67, 3072
    s_add_u32 s64, s64, 32768
    s_addc_u32 s65, s65, 0
    global_load_lds_dwordx4 v48, s[64:65]
    v_lshl_or_b32 v44, v45, 16, v44
    v_min_u32 v44, -2, v44
    s_mov_b64 exec, 0x00ff00ff
    global_store_dword v11, v44, s[44:45] sc1
    global_store_dword v11, v40, s[46:47] sc1
    s_mov_b64 exec, -1
    ds_read_b64_tr_b16 a[16:17], v49 offset:16384
    ds_read_b64_tr_b16 a[18:19], v49 offset:16640
    ds_read_b64_tr_b16 a[20:21], v49 offset:18432
    ds_read_b64_tr_b16 a[22:23], v49 offset:18688
    ds_read_b64_tr_b16 a[24:25], v49 offset:20480
    ds_read_b64_tr_b16 a[26:27], v49 offset:20736
    ds_read_b64_tr_b16 a[28:29], v49 offset:22528
    ds_read_b64_tr_b16 a[30:31], v49 offset:22784
    s_waitcnt lgkmcnt(0)
    s_waitcnt vmcnt(24)
    s_barrier
    s_add_u32 s64, s30, 0
    s_addc_u32 s65, s31, 0
    s_add_u32 m0, s67, 16384
    s_nop 0
    global_load_lds_dwordx4 v48, s[64:65]
    s_add_u32 m0, s67, 17408
    s_add_u32 s64, s64, 32768
    s_addc_u32 s65, s65, 0
    global_load_lds_dwordx4 v48, s[64:65]
    s_add_u32 m0, s67, 18432
    s_add_u32 s64, s64, 32768
    s_addc_u32 s65, s65, 0
    global_load_lds_dwordx4 v48, s[64:65]
    s_add_u32 m0, s67, 19456
    s_add_u32 s64, s64, 32768
    s_addc_u32 s65, s65, 0
    global_load_lds_dwordx4 v48, s[64:65]
    ds_read_b64_tr_b16 a[32:33], v49 offset:32768
    ds_read_b64_tr_b16 a[34:35], v49 offset:33024
    ds_read_b64_tr_b16 a[36:37], v49 offset:34816
    ds_read_b64_tr_b16 a[38:39], v49 offset:35072
    ds_read_b64_tr_b16 a[40:41], v49 offset:36864
    ds_read_b64_tr_b16 a[42:43], v49 offset:37120
    ds_read_b64_tr_b16 a[44:45], v49 offset:38912
    ds_read_b64_tr_b16 a[46:47], v49 offset:39168
    s_waitcnt lgkmcnt(0)
    v_mov_b32 v14, 128
    global_load_dword v42, v14, s[40:41] sc1
    s_waitcnt vmcnt(24)
    s_barrier
    s_add_u32 s64, s30, 524288
    s_addc_u32 s65, s31, 0
    s_add_u32 m0, s67, 32768
    s_nop 0
    global_load_lds_dwordx4 v48, s[64:65]
    s_add_u32 m0, s67, 33792
    s_add_u32 s64, s64, 32768
    s_addc_u32 s65, s65, 0
    global_load_lds_dwordx4 v48, s[64:65]
    s_add_u32 m0, s67, 34816
    s_add_u32 s64, s64, 32768
    s_addc_u32 s65, s65, 0
    global_load_lds_dwordx4 v48, s[64:65]
    s_add_u32 m0, s67, 35840
    s_add_u32 s64, s64, 32768
    s_addc_u32 s65, s65, 0
    global_load_lds_dwordx4 v48, s[64:65]
    ds_read_b64_tr_b16 a[48:49], v49 offset:49152
    ds_read_b64_tr_b16 a[50:51], v49 offset:49408
    ds_read_b64_tr_b16 a[52:53], v49 offset:51200
    ds_read_b64_tr_b16 a[54:55], v49 offset:51456
    ds_read_b64_tr_b16 a[56:57], v49 offset:53248
    ds_read_b64_tr_b16 a[58:59], v49 offset:53504
    ds_read_b64_tr_b16 a[60:61], v49 offset:55296
    ds_read_b64_tr_b16 a[62:63], v49 offset:55552
    s_waitcnt lgkmcnt(0)
    s_waitcnt vmcnt(24)
    s_barrier
    s_add_u32 s64, s30, 1048576
    s_addc_u32 s65, s31, 0
    s_add_u32 m0, s67, 49152
    s_nop 0
    global_load_lds_dwordx4 v48, s[64:65]
    s_add_u32 m0, s67, 50176
    s_add_u32 s64, s64, 32768
    s_addc_u32 s65, s65, 0
    global_load_lds_dwordx4 v48, s[64:65]
    s_add_u32 m0, s67, 51200
    s_add_u32 s64, s64, 32768
    s_addc_u32 s65, s65, 0
    global_load_lds_dwordx4 v48, s[64:65]
    s_add_u32 m0, s67, 52224
    s_add_u32 s64, s64, 32768
    s_addc_u32 s65, s65, 0
    global_load_lds_dwordx4 v48, s[64:65]
    ds_read_b64_tr_b16 a[64:65], v50 offset:0
    ds_read_b64_tr_b16 a[66:67], v50 offset:256
    ds_read_b64_tr_b16 a[68:69], v50 offset:2048
    ds_read_b64_tr_b16 a[70:71], v50 offset:2304
    ds_read_b64_tr_b16 a[72:73], v50 offset:4096
    ds_read_b64_tr_b16 a[74:75], v50 offset:4352
    ds_read_b64_tr_b16 a[76:77], v50 offset:6144
    ds_read_b64_tr_b16 a[78:79], v50 offset:6400
    s_waitcnt lgkmcnt(0)
    s_waitcnt vmcnt(24)
    s_barrier
    s_add_u32 s64, s30, 1572864
    s_addc_u32 s65, s31, 0
    s_add_u32 m0, s67, 65536
    s_nop 0
    global_load_lds_dwordx4 v48, s[64:65]
    s_add_u32 m0, s67, 66560
    s_add_u32 s64, s64, 32768
    s_addc_u32 s65, s65, 0
    global_load_lds_dwordx4 v48, s[64:65]
    s_add_u32 m0, s67, 67584
    s_add_u32 s64, s64, 32768
    s_addc_u32 s65, s65, 0
    global_load_lds_dwordx4 v48, s[64:65]
    s_add_u32 m0, s67, 68608
    s_add_u32 s64, s64, 32768
    s_addc_u32 s65, s65, 0
    global_load_lds_dwordx4 v48, s[64:65]
    ds_read_b64_tr_b16 a[80:81], v50 offset:16384
    ds_read_b64_tr_b16 a[82:83], v50 offset:16640
    ds_read_b64_tr_b16 a[84:85], v50 offset:18432
    ds_read_b64_tr_b16 a[86:87], v50 offset:18688
    ds_read_b64_tr_b16 a[88:89], v50 offset:20480
    ds_read_b64_tr_b16 a[90:91], v50 offset:20736
    ds_read_b64_tr_b16 a[92:93], v50 offset:22528
    ds_read_b64_tr_b16 a[94:95], v50 offset:22784
    s_waitcnt lgkmcnt(0)
    s_waitcnt vmcnt(24)
    s_barrier
    s_add_u32 s64, s30, 2097152
    s_addc_u32 s65, s31, 0
    s_add_u32 m0, s67, 81920
    s_nop 0
    global_load_lds_dwordx4 v48, s[64:65]
    s_add_u32 m0, s67, 82944
    s_add_u32 s64, s64, 32768
    s_addc_u32 s65, s65, 0
    global_load_lds_dwordx4 v48, s[64:65]
    s_add_u32 m0, s67, 83968
    s_add_u32 s64, s64, 32768
    s_addc_u32 s65, s65, 0
    global_load_lds_dwordx4 v48, s[64:65]
    s_add_u32 m0, s67, 84992
    s_add_u32 s64, s64, 32768
    s_addc_u32 s65, s65, 0
    global_load_lds_dwordx4 v48, s[64:65]
    ds_read_b64_tr_b16 a[96:97], v50 offset:32768
    ds_read_b64_tr_b16 a[98:99], v50 offset:33024
    ds_read_b64_tr_b16 a[100:101], v50 offset:34816
    ds_read_b64_tr_b16 a[102:103], v50 offset:35072
    ds_read_b64_tr_b16 a[104:105], v50 offset:36864
    ds_read_b64_tr_b16 a[106:107], v50 offset:37120
    ds_read_b64_tr_b16 a[108:109], v50 offset:38912
    ds_read_b64_tr_b16 a[110:111], v50 offset:39168
    s_waitcnt lgkmcnt(0)
    s_waitcnt vmcnt(24)
    s_barrier
    s_add_u32 s64, s30, 2621440
    s_addc_u32 s65, s31, 0
    s_add_u32 m0, s67, 98304
    s_nop 0
    global_load_lds_dwordx4 v48, s[64:65]
    s_add_u32 m0, s67, 99328
    s_add_u32 s64, s64, 32768
    s_addc_u32 s65, s65, 0
    global_load_lds_dwordx4 v48, s[64:65]
    s_add_u32 m0, s67, 100352
    s_add_u32 s64, s64, 32768
    s_addc_u32 s65, s65, 0
    global_load_lds_dwordx4 v48, s[64:65]
    s_add_u32 m0, s67, 101376
    s_add_u32 s64, s64, 32768
    s_addc_u32 s65, s65, 0
    global_load_lds_dwordx4 v48, s[64:65]
    ds_read_b64_tr_b16 a[112:113], v50 offset:49152
    ds_read_b64_tr_b16 a[114:115], v50 offset:49408
    ds_read_b64_tr_b16 a[116:117], v50 offset:51200
    ds_read_b64_tr_b16 a[118:119], v50 offset:51456
    ds_read_b64_tr_b16 a[120:121], v50 offset:53248
    ds_read_b64_tr_b16 a[122:123], v50 offset:53504
    ds_read_b64_tr_b16 a[124:125], v50 offset:55296
    ds_read_b64_tr_b16 a[126:127], v50 offset:55552
    s_waitcnt lgkmcnt(0)
    s_waitcnt vmcnt(24)
    s_barrier
    s_add_u32 s64, s30, 3145728
    s_addc_u32 s65, s31, 0
    s_add_u32 m0, s67, 114688
    s_nop 0
    global_load_lds_dwordx4 v48, s[64:65]
    s_add_u32 m0, s67, 115712
    s_add_u32 s64, s64, 32768
    s_addc_u32 s65, s65, 0
    global_load_lds_dwordx4 v48, s[64:65]
    s_add_u32 m0, s67, 116736
    s_add_u32 s64, s64, 32768
    s_addc_u32 s65, s65, 0
    global_load_lds_dwordx4 v48, s[64:65]
    s_add_u32 m0, s67, 117760
    s_add_u32 s64, s64, 32768
    s_addc_u32 s65, s65, 0
    global_load_lds_dwordx4 v48, s[64:65]
    ds_read_b64_tr_b16 a[128:129], v49 offset:0
    ds_read_b64_tr_b16 a[130:131], v49 offset:256
    ds_read_b64_tr_b16 a[132:133], v49 offset:2048
    ds_read_b64_tr_b16 a[134:135], v49 offset:2304
    ds_read_b64_tr_b16 a[136:137], v49 offset:4096
    ds_read_b64_tr_b16 a[138:139], v49 offset:4352
    ds_read_b64_tr_b16 a[140:141], v49 offset:6144
    ds_read_b64_tr_b16 a[142:143], v49 offset:6400
    s_waitcnt lgkmcnt(0)
    s_waitcnt vmcnt(24)
    s_barrier
    s_add_u32 s64, s30, 3670016
    s_addc_u32 s65, s31, 0
    s_add_u32 m0, s67, 0
    s_nop 0
    global_load_lds_dwordx4 v48, s[64:65]
    s_add_u32 m0, s67, 1024
    s_add_u32 s64, s64, 32768
    s_addc_u32 s65, s65, 0
    global_load_lds_dwordx4 v48, s[64:65]
    s_add_u32 m0, s67, 2048
    s_add_u32 s64, s64, 32768
    s_addc_u32 s65, s65, 0
    global_load_lds_dwordx4 v48, s[64:65]
    s_add_u32 m0, s67, 3072
    s_add_u32 s64, s64, 32768
    s_addc_u32 s65, s65, 0
    global_load_lds_dwordx4 v48, s[64:65]
    ds_read_b64_tr_b16 a[144:145], v49 offset:16384
    ds_read_b64_tr_b16 a[146:147], v49 offset:16640
    ds_read_b64_tr_b16 a[148:149], v49 offset:18432
    ds_read_b64_tr_b16 a[150:151], v49 offset:18688
    ds_read_b64_tr_b16 a[152:153], v49 offset:20480
    ds_read_b64_tr_b16 a[154:155], v49 offset:20736
    ds_read_b64_tr_b16 a[156:157], v49 offset:22528
    ds_read_b64_tr_b16 a[158:159], v49 offset:22784
    s_waitcnt lgkmcnt(0)
    s_waitcnt vmcnt(24)
    s_barrier
    s_add_u32 s64, s28, 0
    s_addc_u32 s65, s29, 0
    s_add_u32 m0, s67, 16384
    s_nop 0
    global_load_lds_dwordx4 v48, s[64:65]
    s_add_u32 m0, s67, 17408
    s_add_u32 s64, s64, 32768
    s_addc_u32 s65, s65, 0
    global_load_lds_dwordx4 v48, s[64:65]
    s_add_u32 m0, s67, 18432
    s_add_u32 s64, s64, 32768
    s_addc_u32 s65, s65, 0
    global_load_lds_dwordx4 v48, s[64:65]
    s_add_u32 m0, s67, 19456
    s_add_u32 s64, s64, 32768
    s_addc_u32 s65, s65, 0
    global_load_lds_dwordx4 v48, s[64:65]
    v_mov_b32 v14, 0
    v_mov_b32 v15, 1
    s_mov_b64 exec, s[72:73]
    global_atomic_add v14, v15, s[40:41]
    s_mov_b64 exec, -1
    ds_read_b64_tr_b16 a[160:161], v49 offset:32768
    ds_read_b64_tr_b16 a[162:163], v49 offset:33024
    ds_read_b64_tr_b16 a[164:165], v49 offset:34816
    ds_read_b64_tr_b16 a[166:167], v49 offset:35072
    ds_read_b64_tr_b16 a[168:169], v49 offset:36864
    ds_read_b64_tr_b16 a[170:171], v49 offset:37120
    ds_read_b64_tr_b16 a[172:173], v49 offset:38912
    ds_read_b64_tr_b16 a[174:175], v49 offset:39168
    s_waitcnt lgkmcnt(0)
    s_waitcnt vmcnt(24)
    s_barrier
    s_add_u32 s64, s28, 524288
    s_addc_u32 s65, s29, 0
    s_add_u32 m0, s67, 32768
    s_nop 0
    global_load_lds_dwordx4 v48, s[64:65]
    s_add_u32 m0, s67, 33792
    s_add_u32 s64, s64, 32768
    s_addc_u32 s65, s65, 0
    global_load_lds_dwordx4 v48, s[64:65]
    s_add_u32 m0, s67, 34816
    s_add_u32 s64, s64, 32768
    s_addc_u32 s65, s65, 0
    global_load_lds_dwordx4 v48, s[64:65]
    s_add_u32 m0, s67, 35840
    s_add_u32 s64, s64, 32768
    s_addc_u32 s65, s65, 0
    global_load_lds_dwordx4 v48, s[64:65]
    ds_read_b64_tr_b16 a[176:177], v49 offset:49152
    ds_read_b64_tr_b16 a[178:179], v49 offset:49408
    ds_read_b64_tr_b16 a[180:181], v49 offset:51200
    ds_read_b64_tr_b16 a[182:183], v49 offset:51456
    ds_read_b64_tr_b16 a[184:185], v49 offset:53248
    ds_read_b64_tr_b16 a[186:187], v49 offset:53504
    ds_read_b64_tr_b16 a[188:189], v49 offset:55296
    ds_read_b64_tr_b16 a[190:191], v49 offset:55552
    s_waitcnt lgkmcnt(0)
    s_waitcnt vmcnt(24)
    s_barrier
    s_add_u32 s64, s28, 1048576
    s_addc_u32 s65, s29, 0
    s_add_u32 m0, s67, 49152
    s_nop 0
    global_load_lds_dwordx4 v48, s[64:65]
    s_add_u32 m0, s67, 50176
    s_add_u32 s64, s64, 32768
    s_addc_u32 s65, s65, 0
    global_load_lds_dwordx4 v48, s[64:65]
    s_add_u32 m0, s67, 51200
    s_add_u32 s64, s64, 32768
    s_addc_u32 s65, s65, 0
    global_load_lds_dwordx4 v48, s[64:65]
    s_add_u32 m0, s67, 52224
    s_add_u32 s64, s64, 32768
    s_addc_u32 s65, s65, 0
    global_load_lds_dwordx4 v48, s[64:65]
    ds_read_b64_tr_b16 a[192:193], v50 offset:0
    ds_read_b64_tr_b16 a[194:195], v50 offset:256
    ds_read_b64_tr_b16 a[196:197], v50 offset:2048
    ds_read_b64_tr_b16 a[198:199], v50 offset:2304
    ds_read_b64_tr_b16 a[200:201], v50 offset:4096
    ds_read_b64_tr_b16 a[202:203], v50 offset:4352
    ds_read_b64_tr_b16 a[204:205], v50 offset:6144
    ds_read_b64_tr_b16 a[206:207], v50 offset:6400
    s_waitcnt lgkmcnt(0)
    v_readfirstlane_b32 s64, v42
    s_nop 0
    s_cmp_ge_u32 s64, 8
    s_cbranch_scc1 Lini_1
    v_mov_b32 v14, 128
    s_mov_b32 s65, 0
Lwi_2:
    global_load_dword v15, v14, s[40:41] sc1
    s_add_u32 s65, s65, 1
    s_cmp_gt_u32 s65, 0x100000
    s_cbranch_scc1 Lwi_3
    s_waitcnt vmcnt(0)
    v_readfirstlane_b32 s64, v15
    s_nop 0
    s_cmp_lt_u32 s64, 8
    s_cbranch_scc1 Lwi_2
Lwi_3:
Lini_1:
    global_load_dword v5, v4, s[42:43] sc1
    s_waitcnt vmcnt(24)
    s_barrier
    s_add_u32 s64, s28, 1572864
    s_addc_u32 s65, s29, 0
    s_add_u32 m0, s67, 65536
    s_nop 0
    global_load_lds_dwordx4 v48, s[64:65]
    s_add_u32 m0, s67, 66560
    s_add_u32 s64, s64, 32768
    s_addc_u32 s65, s65, 0
    global_load_lds_dwordx4 v48, s[64:65]
    s_add_u32 m0, s67, 67584
    s_add_u32 s64, s64, 32768
    s_addc_u32 s65, s65, 0
    global_load_lds_dwordx4 v48, s[64:65]
    s_add_u32 m0, s67, 68608
    s_add_u32 s64, s64, 32768
    s_addc_u32 s65, s65, 0
    global_load_lds_dwordx4 v48, s[64:65]
    ds_read_b64_tr_b16 a[208:209], v50 offset:16384
    ds_read_b64_tr_b16 a[210:211], v50 offset:16640
    ds_read_b64_tr_b16 a[212:213], v50 offset:18432
    ds_read_b64_tr_b16 a[214:215], v50 offset:18688
    ds_read_b64_tr_b16 a[216:217], v50 offset:20480
    ds_read_b64_tr_b16 a[218:219], v50 offset:20736
    ds_read_b64_tr_b16 a[220:221], v50 offset:22528
    ds_read_b64_tr_b16 a[222:223], v50 offset:22784
    s_waitcnt lgkmcnt(0)
    s_waitcnt vmcnt(24)
    s_barrier
    s_add_u32 s64, s28, 2097152
    s_addc_u32 s65, s29, 0
    s_add_u32 m0, s67, 81920
    s_nop 0
    global_load_lds_dwordx4 v48, s[64:65]
    s_add_u32 m0, s67, 82944
    s_add_u32 s64, s64, 32768
    s_addc_u32 s65, s65, 0
    global_load_lds_dwordx4 v48, s[64:65]
    s_add_u32 m0, s67, 83968
    s_add_u32 s64, s64, 32768
    s_addc_u32 s65, s65, 0
    global_load_lds_dwordx4 v48, s[64:65]
    s_add_u32 m0, s67, 84992
    s_add_u32 s64, s64, 32768
    s_addc_u32 s65, s65, 0
    global_load_lds_dwordx4 v48, s[64:65]
    ds_read_b64_tr_b16 a[224:225], v50 offset:32768
    ds_read_b64_tr_b16 a[226:227], v50 offset:33024
    ds_read_b64_tr_b16 a[228:229], v50 offset:34816
    ds_read_b64_tr_b16 a[230:231], v50 offset:35072
    ds_read_b64_tr_b16 a[232:233], v50 offset:36864
    ds_read_b64_tr_b16 a[234:235], v50 offset:37120
    ds_read_b64_tr_b16 a[236:237], v50 offset:38912
    ds_read_b64_tr_b16 a[238:239], v50 offset:39168
    s_waitcnt lgkmcnt(0)
    s_waitcnt vmcnt(24)
    s_barrier
    s_add_u32 s64, s28, 2621440
    s_addc_u32 s65, s29, 0
    s_add_u32 m0, s67, 98304
    s_nop 0
    global_load_lds_dwordx4 v48, s[64:65]
    s_add_u32 m0, s67, 99328
    s_add_u32 s64, s64, 32768
    s_addc_u32 s65, s65, 0
    global_load_lds_dwordx4 v48, s[64:65]
    s_add_u32 m0, s67, 100352
    s_add_u32 s64, s64, 32768
    s_addc_u32 s65, s65, 0
    global_load_lds_dwordx4 v48, s[64:65]
    s_add_u32 m0, s67, 101376
    s_add_u32 s64, s64, 32768
    s_addc_u32 s65, s65, 0
    global_load_lds_dwordx4 v48, s[64:65]
    ds_read_b64_tr_b16 a[240:241], v50 offset:49152
    ds_read_b64_tr_b16 a[242:243], v50 offset:49408
    ds_read_b64_tr_b16 a[244:245], v50 offset:51200
    ds_read_b64_tr_b16 a[246:247], v50 offset:51456
    ds_read_b64_tr_b16 a[248:249], v50 offset:53248
    ds_read_b64_tr_b16 a[250:251], v50 offset:53504
    ds_read_b64_tr_b16 a[252:253], v50 offset:55296
    ds_read_b64_tr_b16 a[254:255], v50 offset:55552
    s_waitcnt lgkmcnt(0)
    s_waitcnt vmcnt(24)
    s_barrier
    s_add_u32 s64, s28, 3145728
    s_addc_u32 s65, s29, 0
    s_add_u32 m0, s67, 114688
    s_nop 0
    global_load_lds_dwordx4 v48, s[64:65]
    s_add_u32 m0, s67, 115712
    s_add_u32 s64, s64, 32768
    s_addc_u32 s65, s65, 0
    global_load_lds_dwordx4 v48, s[64:65]
    s_add_u32 m0, s67, 116736
    s_add_u32 s64, s64, 32768
    s_addc_u32 s65, s65, 0
    global_load_lds_dwordx4 v48, s[64:65]
    s_add_u32 m0, s67, 117760
    s_add_u32 s64, s64, 32768
    s_addc_u32 s65, s65, 0
    global_load_lds_dwordx4 v48, s[64:65]
    ds_read_b64_tr_b16 v[128:129], v49 offset:0
    ds_read_b64_tr_b16 v[130:131], v49 offset:256
    ds_read_b64_tr_b16 v[132:133], v49 offset:2048
    ds_read_b64_tr_b16 v[134:135], v49 offset:2304
    ds_read_b64_tr_b16 v[136:137], v49 offset:4096
    ds_read_b64_tr_b16 v[138:139], v49 offset:4352
    ds_read_b64_tr_b16 v[140:141], v49 offset:6144
    ds_read_b64_tr_b16 v[142:143], v49 offset:6400
    s_waitcnt lgkmcnt(0)
    s_waitcnt vmcnt(24)
    s_barrier
    ds_read_b64_tr_b16 v[72:73], v49 offset:16384
    ds_read_b64_tr_b16 v[74:75], v49 offset:16640
    ds_read_b64_tr_b16 v[76:77], v49 offset:18432
    ds_read_b64_tr_b16 v[78:79], v49 offset:18688
    ds_read_b64_tr_b16 v[80:81], v49 offset:20480
    ds_read_b64_tr_b16 v[82:83], v49 offset:20736
    ds_read_b64_tr_b16 v[84:85], v49 offset:22528
    ds_read_b64_tr_b16 v[86:87], v49 offset:22784
    s_waitcnt lgkmcnt(0)
    s_barrier
    ds_write_b128 v12, v[72:75] offset:16384
    ds_write_b128 v12, v[76:79] offset:17408
    ds_write_b128 v12, v[80:83] offset:18432
    ds_write_b128 v12, v[84:87] offset:19456
    s_waitcnt lgkmcnt(0)
    s_waitcnt vmcnt(20)
    s_barrier
    ds_read_b64_tr_b16 v[72:73], v49 offset:32768
    ds_read_b64_tr_b16 v[74:75], v49 offset:33024
    ds_read_b64_tr_b16 v[76:77], v49 offset:34816
    ds_read_b64_tr_b16 v[78:79], v49 offset:35072
    ds_read_b64_tr_b16 v[80:81], v49 offset:36864
    ds_read_b64_tr_b16 v[82:83], v49 offset:37120
    ds_read_b64_tr_b16 v[84:85], v49 offset:38912
    ds_read_b64_tr_b16 v[86:87], v49 offset:39168
    s_waitcnt lgkmcnt(0)
    s_barrier
    ds_write_b128 v12, v[72:75] offset:32768
    ds_write_b128 v12, v[76:79] offset:33792
    ds_write_b128 v12, v[80:83] offset:34816
    ds_write_b128 v12, v[84:87] offset:35840
    s_waitcnt lgkmcnt(0)
    s_waitcnt vmcnt(16)
    s_barrier
    ds_read_b64_tr_b16 v[72:73], v49 offset:49152
    ds_read_b64_tr_b16 v[74:75], v49 offset:49408
    ds_read_b64_tr_b16 v[76:77], v49 offset:51200
    ds_read_b64_tr_b16 v[78:79], v49 offset:51456
    ds_read_b64_tr_b16 v[80:81], v49 offset:53248
    ds_read_b64_tr_b16 v[82:83], v49 offset:53504
    ds_read_b64_tr_b16 v[84:85], v49 offset:55296
    ds_read_b64_tr_b16 v[86:87], v49 offset:55552
    s_waitcnt lgkmcnt(0)
    s_barrier
    ds_write_b128 v12, v[72:75] offset:49152
    ds_write_b128 v12, v[76:79] offset:50176
    ds_write_b128 v12, v[80:83] offset:51200
    ds_write_b128 v12, v[84:87] offset:52224
    s_waitcnt lgkmcnt(0)
    s_waitcnt vmcnt(12)
    s_barrier
    ds_read_b64_tr_b16 v[72:73], v50 offset:0
    ds_read_b64_tr_b16 v[74:75], v50 offset:256
    ds_read_b64_tr_b16 v[76:77], v50 offset:2048
    ds_read_b64_tr_b16 v[78:79], v50 offset:2304
    ds_read_b64_tr_b16 v[80:81], v50 offset:4096
    ds_read_b64_tr_b16 v[82:83], v50 offset:4352
    ds_read_b64_tr_b16 v[84:85], v50 offset:6144
    ds_read_b64_tr_b16 v[86:87], v50 offset:6400
    s_waitcnt lgkmcnt(0)
    s_barrier
    ds_write_b128 v3, v[72:75] offset:0
    ds_write_b128 v3, v[76:79] offset:1024
    ds_write_b128 v3, v[80:83] offset:2048
    ds_write_b128 v3, v[84:87] offset:3072
    s_waitcnt lgkmcnt(0)
    v_cmp_le_u32 s[74:75], 32, v5
    s_nop 0
    s_ff0_i32_b64 s76, s[74:75]
    s_add_u32 s64, s68, 0
    s_cmp_lt_u32 s64, s76
    s_cbranch_scc0 Lrs_4
Lrb_5:
    s_add_u32 m0, s78, 0
    global_load_dwordx4 v[112:115], v0, s[58:59] sc1
    global_load_lds_dwordx4 v0, s[56:57] sc1
    global_load_lds_dwordx4 v0, s[56:57] offset:1024 sc1
    global_load_dwordx4 v[116:119], v0, s[58:59] offset:1024 sc1
    s_add_u32 s56, s56, 8192
    s_addc_u32 s57, s57, 0
    s_add_u32 s58, s58, 8192
    s_addc_u32 s59, s59, 0
    v_mov_b32 v14, 0
    global_load_dwordx2 v[40:41], v14, s[40:41] sc1
    global_load_dword v5, v4, s[42:43] sc1
    s_getpc_b64 s[82:83]
Lpcref:
    s_lshl_b32 s64, s3, 13
    s_add_u32 s64, s64, Lrec_local-Lpcref
    v_lshlrev_b32 v14, 3, v0
    v_add_u32 v14, s64, v14
    global_load_dword v56, v14, s[82:83]
    global_load_dwordx4 v[56:59], v0, s[16:17] sc1
    global_load_dwordx4 v[56:59], v0, s[16:17] offset:1024 sc1
    global_load_dword v56, v11, s[44:45] sc1
    global_load_dwordx4 v[56:59], v0, s[18:19] sc1
    global_load_dwordx4 v[56:59], v0, s[18:19] offset:1024 sc1
    global_load_dword v56, v11, s[46:47] sc1
    s_waitcnt vmcnt(21)
    s_barrier
    ds_read_b64_tr_b16 v[72:73], v50 offset:16384
    ds_read_b64_tr_b16 v[74:75], v50 offset:16640
    ds_read_b64_tr_b16 v[76:77], v50 offset:18432
    ds_read_b64_tr_b16 v[78:79], v50 offset:18688
    ds_read_b64_tr_b16 v[80:81], v50 offset:20480
    ds_read_b64_tr_b16 v[82:83], v50 offset:20736
    ds_read_b64_tr_b16 v[84:85], v50 offset:22528
    ds_read_b64_tr_b16 v[86:87], v50 offset:22784
    s_waitcnt lgkmcnt(0)
    s_barrier
    ds_write_b128 v3, v[72:75] offset:16384
    ds_write_b128 v3, v[76:79] offset:17408
    ds_write_b128 v3, v[80:83] offset:18432
    ds_write_b128 v3, v[84:87] offset:19456
    s_waitcnt lgkmcnt(0)
    s_waitcnt vmcnt(17)
    s_barrier
    ds_read_b64_tr_b16 v[72:73], v50 offset:32768
    ds_read_b64_tr_b16 v[74:75], v50 offset:33024
    ds_read_b64_tr_b16 v[76:77], v50 offset:34816
    ds_read_b64_tr_b16 v[78:79], v50 offset:35072
    ds_read_b64_tr_b16 v[80:81], v50 offset:36864
    ds_read_b64_tr_b16 v[82:83], v50 offset:37120
    ds_read_b64_tr_b16 v[84:85], v50 offset:38912
    ds_read_b64_tr_b16 v[86:87], v50 offset:39168
    s_waitcnt lgkmcnt(0)
    s_barrier
    ds_write_b128 v3, v[72:75] offset:32768
    ds_write_b128 v3, v[76:79] offset:33792
    ds_write_b128 v3, v[80:83] offset:34816
    ds_write_b128 v3, v[84:87] offset:35840
    s_waitcnt lgkmcnt(0)
    s_waitcnt vmcnt(13)
    s_barrier
    ds_read_b64_tr_b16 v[72:73], v50 offset:49152
    ds_read_b64_tr_b16 v[74:75], v50 offset:49408
    ds_read_b64_tr_b16 v[76:77], v50 offset:51200
    ds_read_b64_tr_b16 v[78:79], v50 offset:51456
    ds_read_b64_tr_b16 v[80:81], v50 offset:53248
    ds_read_b64_tr_b16 v[82:83], v50 offset:53504
    ds_read_b64_tr_b16 v[84:85], v50 offset:55296
    ds_read_b64_tr_b16 v[86:87], v50 offset:55552
    s_waitcnt lgkmcnt(0)
    s_barrier
    ds_write_b128 v3, v[72:75] offset:49152
    ds_write_b128 v3, v[76:79] offset:50176
    ds_write_b128 v3, v[80:83] offset:51200
    ds_write_b128 v3, v[84:87] offset:52224
    s_waitcnt lgkmcnt(0)
    ds_write_b128 v12, v[96:99] offset:0
    ds_write_b128 v12, v[100:103] offset:1024
    ds_write_b128 v12, v[104:107] offset:2048
    ds_write_b128 v12, v[108:111] offset:3072
    s_waitcnt vmcnt(0) lgkmcnt(0)
    v_readfirstlane_b32 s64, v40
    s_nop 0
    s_cmp_ge_u32 s64, 32
    s_cbranch_scc1 Lgrp_6
    v_mov_b32 v14, 0
Lgb_7:
    global_load_dwordx2 v[40:41], v14, s[40:41] sc1
    s_add_u32 s77, s77, 1
    s_cmp_gt_u32 s77, 0x100000
    s_cbranch_scc1 Lgb_8
    s_waitcnt vmcnt(0)
    v_readfirstlane_b32 s64, v40
    s_nop 0
    s_cmp_lt_u32 s64, 32
    s_cbranch_scc1 Lgb_7
Lgb_8:
    s_waitcnt vmcnt(0)
    v_readfirstlane_b32 s64, v41
    s_nop 0
    s_bcnt1_i32_b32 s5, s64
Lgrp_6:
    v_readfirstlane_b32 s64, v41
    s_nop 0
    s_bcnt1_i32_b32 s5, s64
    v_cmp_le_u32 s[74:75], 32, v5
    s_nop 0
    s_ff0_i32_b64 s76, s[74:75]
    s_add_u32 s64, s68, 2
    s_cmp_lt_u32 s64, s76
    s_cbranch_scc0 Lrs_12
Lrb_13:
    s_cmp_lg_u32 s5, 1
    s_cbranch_scc1 Lremote_10
Lrec_local:
    s_cmp_eq_u32 s3, 1
    s_cbranch_scc1 Lrw_15
    s_cmp_eq_u32 s3, 2
    s_cbranch_scc1 Lrw_16
    s_cmp_eq_u32 s3, 3
    s_cbranch_scc1 Lrw_17
Lrw_14:
    ds_read_b128 v[72:75], v12 offset:16384
    ds_read_b128 v[76:79], v12 offset:17408
    ds_read_b128 v[80:83], v12 offset:18432
    ds_read_b128 v[84:87], v12 offset:19456
    ds_read_b128 v[88:91], v12 offset:32768
    ds_read_b128 v[92:95], v12 offset:33792
    v_mov_b64 v[28:29], 0
    v_mov_b64 v[30:31], 0
    v_mov_b64 v[32:33], 0
    v_mov_b64 v[34:35], 0
    v_mov_b64 v[36:37], 0
    v_mov_b64 v[38:39], 0
    v_mov_b64 v[96:97], -1
    v_mov_b64 v[98:99], -1
Lrec_18:
    s_waitcnt vmcnt(0)
    global_load_dwordx4 v[104:107], v2, s[44:45] offset:0 sc1
    global_load_dwordx4 v[108:111], v2, s[44:45] offset:1024 sc1
    s_sleep 2
    global_load_dwordx4 v[64:67], v2, s[44:45] offset:0 sc1
    global_load_dwordx4 v[68:71], v2, s[44:45] offset:1024 sc1
    s_waitcnt vmcnt(2)
    ds_write_b128 v2, v[104:107] offset:0
    ds_write_b128 v2, v[108:111] offset:1024
    v_max3_u32 v14, v104, v105, v106
    v_max3_u32 v15, v107, v108, v109
    v_max3_u32 v14, v14, v110, v111
    v_max_u32 v14, v14, v15
    v_cmp_eq_u32 vcc, -1, v14
    s_cbranch_vccnz LslA_22
LokA_21:
    ds_read_b128 v[40:43], v1 offset:0
    ds_read_b128 v[44:47], v1 offset:512
    ds_read_b128 v[48:51], v1 offset:1024
    ds_read_b128 v[52:55], v1 offset:1536
    s_waitcnt lgkmcnt(4)
    s_barrier
    s_waitcnt lgkmcnt(3)
    v_smfmac_f32_16x16x64_bf16 v[28:31], v[40:43], a[0:7], v6
    ds_read_b128 v[56:59], v1 offset:2048
    v_smfmac_f32_16x16x64_bf16 v[36:39], v[40:43], a[144:151], v6
    ds_read_b128 v[60:63], v1 offset:2560
    v_smfmac_f32_16x16x64_bf16 v[32:35], v[40:43], v[72:79], v6
    ds_read_b128 v[72:75], v12 offset:34816
    s_waitcnt lgkmcnt(5)
    v_smfmac_f32_16x16x64_bf16 v[28:31], v[44:47], a[8:15], v6
    ds_read_b128 v[76:79], v12 offset:35840
    v_smfmac_f32_16x16x64_bf16 v[36:39], v[44:47], a[152:159], v6
    ds_read_b128 v[40:43], v1 offset:4096
    v_smfmac_f32_16x16x64_bf16 v[32:35], v[44:47], v[80:87], v6
    ds_read_b128 v[80:83], v12 offset:49152
    s_waitcnt vmcnt(0)
    s_waitcnt lgkmcnt(7)
    v_smfmac_f32_16x16x64_bf16 v[28:31], v[48:51], a[16:23], v6
    s_mov_b64 exec, 0x00ff00ff
    global_store_dword v11, v96, s[46:47]
    s_mov_b64 exec, -1
    v_smfmac_f32_16x16x64_bf16 v[36:39], v[48:51], a[160:167], v6
    ds_read_b128 v[84:87], v12 offset:50176
    s_add_u32 m0, s78, 8192
    global_load_dwordx4 v[120:123], v0, s[58:59] sc1
    v_smfmac_f32_16x16x64_bf16 v[32:35], v[48:51], v[88:95], v6
    ds_read_b128 v[88:91], v12 offset:51200
    global_load_lds_dwordx4 v0, s[56:57] sc1
    s_waitcnt lgkmcnt(8)
    v_smfmac_f32_16x16x64_bf16 v[28:31], v[52:55], a[24:31], v6
    ds_read_b128 v[92:95], v12 offset:52224
    global_load_lds_dwordx4 v0, s[56:57] offset:1024 sc1
    v_smfmac_f32_16x16x64_bf16 v[36:39], v[52:55], a[168:175], v6
    ds_read_b128 v[64:67], v1 offset:3072
    global_load_dwordx4 v[124:127], v0, s[58:59] offset:1024 sc1
    s_waitcnt lgkmcnt(6)
    v_smfmac_f32_16x16x64_bf16 v[32:35], v[52:55], v[72:79], v6
    ds_read_b128 v[72:75], v3 offset:0
    s_add_u32 s56, s56, 8192
    s_addc_u32 s57, s57, 0
    v_smfmac_f32_16x16x64_bf16 v[28:31], v[56:59], a[32:39], v6
    ds_read_b128 v[76:79], v3 offset:1024
    s_add_u32 s58, s58, 8192
    s_addc_u32 s59, s59, 0
    v_smfmac_f32_16x16x64_bf16 v[36:39], v[56:59], a[176:183], v6
    s_mov_b64 exec, 1
    global_store_dword v0, v6, s[36:37] sc1
    s_mov_b64 exec, -1
    s_waitcnt lgkmcnt(5)
    v_smfmac_f32_16x16x64_bf16 v[32:35], v[56:59], v[80:87], v6
    ds_read_b128 v[68:71], v1 offset:3584
    s_add_u32 s36, s36, 4096
    s_addc_u32 s37, s37, 0
    v_smfmac_f32_16x16x64_bf16 v[28:31], v[60:63], a[40:47], v6
    ds_read_b128 v[80:83], v3 offset:2048
    global_store_dwordx4 v0, v[96:99], s[18:19]
    v_smfmac_f32_16x16x64_bf16 v[36:39], v[60:63], a[184:191], v6
    ds_read_b128 v[84:87], v3 offset:3072
    s_waitcnt lgkmcnt(6)
    v_smfmac_f32_16x16x64_bf16 v[32:35], v[60:63], v[88:95], v6
    ds_read_b128 v[88:91], v3 offset:16384
    s_waitcnt lgkmcnt(6)
    v_smfmac_f32_16x16x64_bf16 v[28:31], v[64:67], a[48:55], v6
    ds_read_b128 v[92:95], v3 offset:17408
    v_smfmac_f32_16x16x64_bf16 v[36:39], v[64:67], a[192:199], v6
    ds_read_b128 v[44:47], v1 offset:4608
    s_waitcnt lgkmcnt(6)
    v_smfmac_f32_16x16x64_bf16 v[32:35], v[64:67], v[72:79], v6
    ds_read_b128 v[72:75], v3 offset:18432
    s_waitcnt lgkmcnt(6)
    v_smfmac_f32_16x16x64_bf16 v[28:31], v[68:71], a[56:63], v6
    ds_read_b128 v[76:79], v3 offset:19456
    v_smfmac_f32_16x16x64_bf16 v[36:39], v[68:71], a[200:207], v6
    ds_read_b128 v[48:51], v1 offset:5120
    s_waitcnt lgkmcnt(6)
    v_smfmac_f32_16x16x64_bf16 v[32:35], v[68:71], v[80:87], v6
    ds_read_b128 v[80:83], v3 offset:32768
    global_store_dwordx4 v0, v[96:99], s[18:19] offset:1024
    v_smfmac_f32_16x16x64_bf16 v[28:31], v[40:43], a[64:71], v6
    ds_read_b128 v[84:87], v3 offset:33792
    s_waitcnt lgkmcnt(6)
    v_smfmac_f32_16x16x64_bf16 v[32:35], v[40:43], v[88:95], v6
    ds_read_b128 v[52:55], v1 offset:5632
    s_waitcnt lgkmcnt(6)
    v_smfmac_f32_16x16x64_bf16 v[28:31], v[44:47], a[72:79], v6
    ds_read_b128 v[88:91], v3 offset:34816
    s_waitcnt lgkmcnt(5)
    v_smfmac_f32_16x16x64_bf16 v[32:35], v[44:47], v[72:79], v6
    ds_read_b128 v[92:95], v3 offset:35840
    s_waitcnt lgkmcnt(5)
    v_smfmac_f32_16x16x64_bf16 v[28:31], v[48:51], a[80:87], v6
    ds_read_b128 v[56:59], v1 offset:6144
    s_waitcnt lgkmcnt(4)
    v_smfmac_f32_16x16x64_bf16 v[32:35], v[48:51], v[80:87], v6
    ds_read_b128 v[72:75], v3 offset:49152
    s_waitcnt lgkmcnt(4)
    v_smfmac_f32_16x16x64_bf16 v[28:31], v[52:55], a[88:95], v6
    ds_read_b128 v[76:79], v3 offset:50176
    s_waitcnt lgkmcnt(3)
    v_smfmac_f32_16x16x64_bf16 v[32:35], v[52:55], v[88:95], v6
    ds_read_b128 v[60:63], v1 offset:6656
    s_waitcnt lgkmcnt(3)
    v_smfmac_f32_16x16x64_bf16 v[28:31], v[56:59], a[96:103], v6
    ds_read_b128 v[80:83], v3 offset:51200
    s_waitcnt lgkmcnt(2)
    v_smfmac_f32_16x16x64_bf16 v[32:35], v[56:59], v[72:79], v6
    ds_read_b128 v[84:87], v3 offset:52224
    s_waitcnt lgkmcnt(2)
    v_smfmac_f32_16x16x64_bf16 v[28:31], v[60:63], a[104:111], v6
    ds_read_b128 v[64:67], v1 offset:7168
    s_waitcnt lgkmcnt(1)
    v_smfmac_f32_16x16x64_bf16 v[32:35], v[60:63], v[80:87], v6
    ds_read_b128 v[68:71], v1 offset:7680
    s_waitcnt lgkmcnt(1)
    v_smfmac_f32_16x16x64_bf16 v[28:31], v[64:67], a[112:119], v6
    ds_read_b128 v[88:91], v0 offset:8192
    v_smfmac_f32_16x16x64_bf16 v[32:35], v[64:67], a[128:135], v6
    ds_read_b128 v[92:95], v0 offset:12288
    s_waitcnt lgkmcnt(2)
    v_smfmac_f32_16x16x64_bf16 v[28:31], v[68:71], a[120:127], v6
    ds_read_b128 v[72:75], v0 offset:9216
    v_smfmac_f32_16x16x64_bf16 v[32:35], v[68:71], a[136:143], v6
    ds_read_b128 v[76:79], v0 offset:13312
    v_smfmac_f32_16x16x64_bf16 v[36:39], v[40:43], a[208:215], v6
    ds_read_b128 v[80:83], v0 offset:10240
    v_smfmac_f32_16x16x64_bf16 v[36:39], v[44:47], a[216:223], v6
    ds_read_b128 v[84:87], v0 offset:14336
    v_cvt_pk_bf16_f32 v14, v28, v29
    v_cvt_pk_bf16_f32 v15, v30, v31
    v_cvt_pk_bf16_f32 v16, v32, v33
    v_cvt_pk_bf16_f32 v17, v34, v35
    ds_write_b128 v7, v[14:17]
    ds_read_b64_tr_b16 v[96:97], v8 offset:24576
    ds_read_b64_tr_b16 v[98:99], v8 offset:25088
    v_smfmac_f32_16x16x64_bf16 v[36:39], v[48:51], a[224:231], v6
    ds_read_b128 v[28:31], v0 offset:11264
    v_smfmac_f32_16x16x64_bf16 v[36:39], v[56:59], a[240:247], v6
    ds_read_b128 v[32:35], v0 offset:15360
    v_smfmac_f32_16x16x64_bf16 v[36:39], v[60:63], a[248:255], v6
    v_smfmac_f32_16x16x64_bf16 v[36:39], v[52:55], a[232:239], v6
    s_waitcnt lgkmcnt(4)
    s_barrier
    ds_read_b64_tr_b16 v[100:101], v8 offset:25600
    ds_read_b64_tr_b16 v[102:103], v8 offset:26112
    ds_read_b64_tr_b16 v[104:105], v8 offset:26624
    ds_read_b64_tr_b16 v[106:107], v8 offset:27136
    ds_read_b64_tr_b16 v[108:109], v8 offset:27648
    ds_read_b64_tr_b16 v[110:111], v8 offset:28160
    v_smfmac_f32_16x16x64_bf16 v[36:39], v[64:67], v[128:135], v6
    v_smfmac_f32_16x16x64_bf16 v[36:39], v[68:71], v[136:143], v6
    s_waitcnt lgkmcnt(8)
    v_mfma_f32_16x16x32_bf16 v[48:51], v[96:99], v[96:99], v[24:27]
    v_mov_b64 v[52:53], s[62:63]
    v_mov_b64 v[54:55], s[62:63]
    v_mfma_f32_16x16x32_bf16 v[40:43], v[88:91], v[96:99], 0
    v_mfma_f32_16x16x32_bf16 v[44:47], v[92:95], v[96:99], 0
    v_cvt_pk_bf16_f32 v18, v36, v37
    v_cvt_pk_bf16_f32 v19, v38, v39
    s_waitcnt lgkmcnt(4)
    v_mfma_f32_16x16x32_bf16 v[48:51], v[100:103], v[100:103], v[48:51]
    v_mov_b64 v[36:37], v[18:19]
    v_mov_b64 v[38:39], v[18:19]
    v_mfma_f32_16x16x32_bf16 v[40:43], v[72:75], v[100:103], v[40:43]
    v_mfma_f32_16x16x32_bf16 v[44:47], v[76:79], v[100:103], v[44:47]
    v_permlane32_swap_b32 v36, v38
    s_waitcnt lgkmcnt(2)
    v_mfma_f32_16x16x32_bf16 v[48:51], v[104:107], v[104:107], v[48:51]
    v_permlane32_swap_b32 v37, v39
    v_mfma_f32_16x16x32_bf16 v[40:43], v[80:83], v[104:107], v[40:43]
    global_store_dwordx4 v0, v[16:19], s[60:61] sc1
    v_mfma_f32_16x16x32_bf16 v[44:47], v[84:87], v[104:107], v[44:47]
    s_waitcnt lgkmcnt(0)
    v_mfma_f32_16x16x32_bf16 v[48:51], v[108:111], v[108:111], v[48:51]
    v_mfma_f32_16x16x32_bf16 v[40:43], v[28:31], v[108:111], v[40:43]
    v_mfma_f32_16x16x32_bf16 v[44:47], v[32:35], v[108:111], v[44:47]
    s_add_u32 s60, s60, 4096
    s_addc_u32 s61, s61, 0
    ds_read_b128 v[72:75], v12 offset:0
    v_max3_f32 v14, v48, v49, v50
    v_max3_f32 v14, v14, v51, v40
    v_max3_f32 v15, v41, v42, v43
    s_nop 1
    v_max3_f32 v14, v14, v44, v45
    v_max3_f32 v15, v15, v46, v47
    v_max_f32 v14, v14, v15
    v_mov_b32 v15, v14
    v_mov_b64 v[56:57], 0
    v_mov_b64 v[58:59], 0
    ds_read_b128 v[76:79], v12 offset:1024
    v_permlane32_swap_b32 v14, v15
    v_max_f32 v14, v14, v15
    v_mov_b32 v15, v14
    v_mov_b64 v[60:61], 0
    v_mov_b64 v[62:63], 0
    ds_read_b128 v[80:83], v12 offset:2048
    v_permlane16_swap_b32 v14, v15
    v_max_f32 v14, v14, v15
    v_mul_f32 v14, s69, v14
    v_pk_fma_f32 v[40:41], v[40:41], s[80:81], v[14:15] op_sel_hi:[1,1,0] neg_lo:[0,0,1] neg_hi:[0,0,1]
    v_pk_fma_f32 v[42:43], v[42:43], s[80:81], v[14:15] op_sel_hi:[1,1,0] neg_lo:[0,0,1] neg_hi:[0,0,1]
    v_pk_fma_f32 v[44:45], v[44:45], s[80:81], v[14:15] op_sel_hi:[1,1,0] neg_lo:[0,0,1] neg_hi:[0,0,1]
    v_pk_fma_f32 v[46:47], v[46:47], s[80:81], v[14:15] op_sel_hi:[1,1,0] neg_lo:[0,0,1] neg_hi:[0,0,1]
    v_exp_f32 v40, v40
    v_exp_f32 v41, v41
    v_exp_f32 v42, v42
    v_exp_f32 v43, v43
    v_exp_f32 v44, v44
    v_exp_f32 v45, v45
    v_exp_f32 v46, v46
    v_exp_f32 v47, v47
    v_pk_fma_f32 v[48:49], v[48:49], s[80:81], v[14:15] op_sel_hi:[1,1,0] neg_lo:[0,0,1] neg_hi:[0,0,1]
    v_pk_fma_f32 v[50:51], v[50:51], s[80:81], v[14:15] op_sel_hi:[1,1,0] neg_lo:[0,0,1] neg_hi:[0,0,1]
    v_cvt_pk_bf16_f32 v96, v40, v41
    v_cvt_pk_bf16_f32 v97, v42, v43
    v_cvt_pk_bf16_f32 v98, v44, v45
    v_cvt_pk_bf16_f32 v99, v46, v47
    v_exp_f32 v48, v48
    s_nop 0
    v_mfma_f32_16x16x32_bf16 v[40:43], v[52:55], v[96:99], 0
    ds_read_b128 v[84:87], v12 offset:3072
    v_exp_f32 v49, v49
    v_mfma_f32_16x16x32_bf16 v[28:31], v[112:115], v[96:99], 0
    v_exp_f32 v50, v50
    v_mfma_f32_16x16x32_bf16 v[32:35], v[116:119], v[96:99], 0
    v_exp_f32 v51, v51
    v_cvt_pk_bf16_f32 v100, v48, v49
    v_cvt_pk_bf16_f32 v101, v50, v51
    v_mov_b64 v[64:65], 0
    v_mov_b64 v[66:67], 0
    v_mfma_f32_16x16x16_bf16 v[40:43], v[52:53], v[100:101], v[40:43]
    v_mov_b64 v[68:69], 0
    v_mov_b64 v[70:71], 0
    v_mfma_f32_16x16x16_bf16 v[28:31], v[36:37], v[100:101], v[28:31]
    v_mfma_f32_16x16x16_bf16 v[32:35], v[38:39], v[100:101], v[32:35]
    v_rcp_f32 v14, v40
    s_mov_b32 exec_lo, 0xff00ff00
    s_mov_b32 exec_hi, 0xff00ff00
    s_nop 0
    v_pk_mul_f32 v[28:29], v[28:29], v[14:15] op_sel_hi:[1,0]
    v_pk_mul_f32 v[30:31], v[30:31], v[14:15] op_sel_hi:[1,0]
    v_cvt_pk_bf16_f32 v88, v28, v29
    v_cvt_pk_bf16_f32 v89, v30, v31
    v_pk_mul_f32 v[32:33], v[32:33], v[14:15] op_sel_hi:[1,0]
    v_pk_mul_f32 v[34:35], v[34:35], v[14:15] op_sel_hi:[1,0]
    v_cvt_pk_bf16_f32 v90, v32, v33
    v_cvt_pk_bf16_f32 v91, v34, v35
    ds_write_b128 v9, v[88:91]
    s_mov_b64 exec, -1
    v_mov_b32_dpp v88, v88 row_ror:8 row_mask:0xf bank_mask:0x3
    v_mov_b32_dpp v89, v89 row_ror:8 row_mask:0xf bank_mask:0x3
    v_mov_b32_dpp v90, v90 row_ror:8 row_mask:0xf bank_mask:0x3
    v_mov_b32_dpp v91, v91 row_ror:8 row_mask:0xf bank_mask:0x3
    s_waitcnt lgkmcnt(3)
    s_nop 0
    v_smfmac_f32_16x16x64_bf16 v[56:59], v[88:91], v[72:79], v6
    v_smfmac_f32_16x16x64_bf16 v[60:63], v[88:91], v[144:151], v6
    s_waitcnt vmcnt(8) lgkmcnt(0)
    s_barrier
    ds_read_b128 v[100:103], v1 offset:29184
    ds_read_b128 v[104:107], v1 offset:29696
    ds_read_b128 v[108:111], v1 offset:30208
    v_smfmac_f32_16x16x64_bf16 v[64:67], v[88:91], v[160:167], v6
    v_smfmac_f32_16x16x64_bf16 v[68:71], v[88:91], v[176:183], v6
    s_waitcnt lgkmcnt(2)
    v_smfmac_f32_16x16x64_bf16 v[56:59], v[100:103], v[80:87], v6
    v_smfmac_f32_16x16x64_bf16 v[60:63], v[100:103], v[152:159], v6
    s_waitcnt lgkmcnt(1)
    v_smfmac_f32_16x16x64_bf16 v[56:59], v[104:107], v[192:199], v6
    v_smfmac_f32_16x16x64_bf16 v[60:63], v[104:107], v[208:215], v6
    s_waitcnt lgkmcnt(0)
    v_smfmac_f32_16x16x64_bf16 v[56:59], v[108:111], v[200:207], v6
    v_smfmac_f32_16x16x64_bf16 v[60:63], v[108:111], v[216:223], v6
    v_smfmac_f32_16x16x64_bf16 v[64:67], v[100:103], v[168:175], v6
    v_smfmac_f32_16x16x64_bf16 v[68:71], v[100:103], v[184:191], v6
    v_cvt_pk_bf16_f32 v40, v56, v60
    v_smfmac_f32_16x16x64_bf16 v[64:67], v[104:107], v[224:231], v6
    v_cvt_pk_bf16_f32 v41, v57, v61
    v_smfmac_f32_16x16x64_bf16 v[68:71], v[104:107], v[240:247], v6
    v_cvt_pk_bf16_f32 v42, v58, v62
    v_smfmac_f32_16x16x64_bf16 v[64:67], v[108:111], v[232:239], v6
    v_cvt_pk_bf16_f32 v43, v59, v63
    v_smfmac_f32_16x16x64_bf16 v[68:71], v[108:111], v[248:255], v6
    global_store_dwordx4 v10, v[40:43], s[48:49]
    s_nop 6
    v_cvt_pk_bf16_f32 v44, v64, v68
    v_cvt_pk_bf16_f32 v45, v65, v69
    v_cvt_pk_bf16_f32 v46, v66, v70
    v_cvt_pk_bf16_f32 v47, v67, v71
    global_store_dwordx4 v10, v[44:47], s[52:53]
    s_waitcnt vmcnt(1)
    ds_read_b128 v[72:75], v12 offset:16384
    ds_read_b128 v[76:79], v12 offset:17408
    ds_read_b128 v[80:83], v12 offset:18432
    ds_read_b128 v[84:87], v12 offset:19456
    ds_read_b128 v[88:91], v12 offset:32768
    ds_read_b128 v[92:95], v12 offset:33792
    global_load_dwordx4 v[48:51], v0, s[16:17] offset:0 sc1
    global_load_dwordx4 v[52:55], v0, s[16:17] offset:1024 sc1
    s_sleep 2
    global_load_dwordx4 v[64:67], v0, s[16:17] offset:0 sc1
    global_load_dwordx4 v[68:71], v0, s[16:17] offset:1024 sc1
    v_mov_b64 v[28:29], 0
    v_mov_b64 v[30:31], 0
    v_mov_b64 v[32:33], 0
    v_mov_b64 v[34:35], 0
    v_mov_b64 v[36:37], 0
    v_mov_b64 v[38:39], 0
    v_mov_b64 v[96:97], -1
    v_mov_b64 v[98:99], -1
    s_waitcnt vmcnt(2)
    v_mfma_f32_16x16x32_bf16 v[100:103], v[20:23], v[48:51], 0
    v_max3_u32 v14, v48, v49, v50
    v_mfma_f32_16x16x32_bf16 v[100:103], v[20:23], v[52:55], v[100:103]
    v_max3_u32 v15, v51, v52, v53
    v_max3_u32 v14, v14, v54, v55
    v_max_u32 v14, v14, v15
    v_cmp_eq_u32 vcc, -1, v14
    s_cbranch_vccnz LlB_23
LokB_24:
    s_nop 2
    v_add_f32_dpp v100, v100, v100 row_ror:4 row_mask:0xf bank_mask:0xf
    v_add_f32_dpp v101, v101, v101 row_ror:4 row_mask:0xf bank_mask:0xf
    v_add_f32_dpp v102, v102, v102 row_ror:4 row_mask:0xf bank_mask:0xf
    v_add_f32_dpp v103, v103, v103 row_ror:4 row_mask:0xf bank_mask:0xf
    v_add_f32_dpp v100, v100, v100 row_ror:8 row_mask:0xf bank_mask:0xf
    v_add_f32_dpp v101, v101, v101 row_ror:8 row_mask:0xf bank_mask:0xf
    v_add_f32_dpp v102, v102, v102 row_ror:8 row_mask:0xf bank_mask:0xf
    v_add_f32_dpp v103, v103, v103 row_ror:8 row_mask:0xf bank_mask:0xf
    v_cvt_pk_bf16_f32 v100, v100, v101
    v_cvt_pk_bf16_f32 v101, v102, v103
    v_cndmask_b32 v100, v100, v101, s[70:71]
    s_mov_b64 exec, 0x00ff00ff
    global_store_dword v11, v100, s[46:47]
    s_mov_b64 exec, -1
    s_add_u32 s68, s68, 1
    s_waitcnt vmcnt(0)
    global_load_dwordx4 v[104:107], v2, s[46:47] offset:0 sc1
    global_load_dwordx4 v[108:111], v2, s[46:47] offset:1024 sc1
    s_sleep 2
    global_load_dwordx4 v[64:67], v2, s[46:47] offset:0 sc1
    global_load_dwordx4 v[68:71], v2, s[46:47] offset:1024 sc1
    s_waitcnt vmcnt(2)
    ds_write_b128 v2, v[104:107] offset:0
    ds_write_b128 v2, v[108:111] offset:1024
    v_max3_u32 v14, v104, v105, v106
    v_max3_u32 v15, v107, v108, v109
    v_max3_u32 v14, v14, v110, v111
    v_max_u32 v14, v14, v15
    v_cmp_eq_u32 vcc, -1, v14
    s_cbranch_vccnz LslA_27
LokA_26:
    ds_read_b128 v[40:43], v1 offset:0
    ds_read_b128 v[44:47], v1 offset:512
    ds_read_b128 v[48:51], v1 offset:1024
    ds_read_b128 v[52:55], v1 offset:1536
    s_waitcnt lgkmcnt(4)
    s_barrier
    s_waitcnt lgkmcnt(3)
    v_smfmac_f32_16x16x64_bf16 v[28:31], v[40:43], a[0:7], v6
    ds_read_b128 v[56:59], v1 offset:2048
    v_smfmac_f32_16x16x64_bf16 v[36:39], v[40:43], a[144:151], v6
    ds_read_b128 v[60:63], v1 offset:2560
    v_smfmac_f32_16x16x64_bf16 v[32:35], v[40:43], v[72:79], v6
    ds_read_b128 v[72:75], v12 offset:34816
    s_waitcnt lgkmcnt(5)
    v_smfmac_f32_16x16x64_bf16 v[28:31], v[44:47], a[8:15], v6
    ds_read_b128 v[76:79], v12 offset:35840
    v_smfmac_f32_16x16x64_bf16 v[36:39], v[44:47], a[152:159], v6
    ds_read_b128 v[40:43], v1 offset:4096
    v_smfmac_f32_16x16x64_bf16 v[32:35], v[44:47], v[80:87], v6
    ds_read_b128 v[80:83], v12 offset:49152
    s_waitcnt vmcnt(0)
    s_waitcnt lgkmcnt(7)
    v_smfmac_f32_16x16x64_bf16 v[28:31], v[48:51], a[16:23], v6
    s_mov_b64 exec, 0x00ff00ff
    global_store_dword v11, v96, s[44:45]
    s_mov_b64 exec, -1
    v_smfmac_f32_16x16x64_bf16 v[36:39], v[48:51], a[160:167], v6
    ds_read_b128 v[84:87], v12 offset:50176
    s_add_u32 m0, s78, 0
    global_load_dwordx4 v[112:115], v0, s[58:59] sc1
    v_smfmac_f32_16x16x64_bf16 v[32:35], v[48:51], v[88:95], v6
    ds_read_b128 v[88:91], v12 offset:51200
    global_load_lds_dwordx4 v0, s[56:57] sc1
    s_waitcnt lgkmcnt(8)
    v_smfmac_f32_16x16x64_bf16 v[28:31], v[52:55], a[24:31], v6
    ds_read_b128 v[92:95], v12 offset:52224
    global_load_lds_dwordx4 v0, s[56:57] offset:1024 sc1
    v_smfmac_f32_16x16x64_bf16 v[36:39], v[52:55], a[168:175], v6
    ds_read_b128 v[64:67], v1 offset:3072
    global_load_dwordx4 v[116:119], v0, s[58:59] offset:1024 sc1
    s_waitcnt lgkmcnt(6)
    v_smfmac_f32_16x16x64_bf16 v[32:35], v[52:55], v[72:79], v6
    ds_read_b128 v[72:75], v3 offset:0
    s_add_u32 s56, s56, 8192
    s_addc_u32 s57, s57, 0
    v_smfmac_f32_16x16x64_bf16 v[28:31], v[56:59], a[32:39], v6
    ds_read_b128 v[76:79], v3 offset:1024
    s_add_u32 s58, s58, 8192
    s_addc_u32 s59, s59, 0
    v_smfmac_f32_16x16x64_bf16 v[36:39], v[56:59], a[176:183], v6
    s_mov_b64 exec, 1
    global_store_dword v0, v6, s[36:37] sc1
    s_mov_b64 exec, -1
    s_waitcnt lgkmcnt(5)
    v_smfmac_f32_16x16x64_bf16 v[32:35], v[56:59], v[80:87], v6
    ds_read_b128 v[68:71], v1 offset:3584
    s_add_u32 s36, s36, 4096
    s_addc_u32 s37, s37, 0
    v_smfmac_f32_16x16x64_bf16 v[28:31], v[60:63], a[40:47], v6
    ds_read_b128 v[80:83], v3 offset:2048
    global_store_dwordx4 v0, v[96:99], s[16:17]
    v_smfmac_f32_16x16x64_bf16 v[36:39], v[60:63], a[184:191], v6
    ds_read_b128 v[84:87], v3 offset:3072
    s_waitcnt lgkmcnt(6)
    v_smfmac_f32_16x16x64_bf16 v[32:35], v[60:63], v[88:95], v6
    ds_read_b128 v[88:91], v3 offset:16384
    s_waitcnt lgkmcnt(6)
    v_smfmac_f32_16x16x64_bf16 v[28:31], v[64:67], a[48:55], v6
    ds_read_b128 v[92:95], v3 offset:17408
    v_smfmac_f32_16x16x64_bf16 v[36:39], v[64:67], a[192:199], v6
    ds_read_b128 v[44:47], v1 offset:4608
    s_waitcnt lgkmcnt(6)
    v_smfmac_f32_16x16x64_bf16 v[32:35], v[64:67], v[72:79], v6
    ds_read_b128 v[72:75], v3 offset:18432
    s_waitcnt lgkmcnt(6)
    v_smfmac_f32_16x16x64_bf16 v[28:31], v[68:71], a[56:63], v6
    ds_read_b128 v[76:79], v3 offset:19456
    v_smfmac_f32_16x16x64_bf16 v[36:39], v[68:71], a[200:207], v6
    ds_read_b128 v[48:51], v1 offset:5120
    s_waitcnt lgkmcnt(6)
    v_smfmac_f32_16x16x64_bf16 v[32:35], v[68:71], v[80:87], v6
    ds_read_b128 v[80:83], v3 offset:32768
    global_store_dwordx4 v0, v[96:99], s[16:17] offset:1024
    v_smfmac_f32_16x16x64_bf16 v[28:31], v[40:43], a[64:71], v6
    ds_read_b128 v[84:87], v3 offset:33792
    s_waitcnt lgkmcnt(6)
    v_smfmac_f32_16x16x64_bf16 v[32:35], v[40:43], v[88:95], v6
    ds_read_b128 v[52:55], v1 offset:5632
    s_waitcnt lgkmcnt(6)
    v_smfmac_f32_16x16x64_bf16 v[28:31], v[44:47], a[72:79], v6
    ds_read_b128 v[88:91], v3 offset:34816
    s_waitcnt lgkmcnt(5)
    v_smfmac_f32_16x16x64_bf16 v[32:35], v[44:47], v[72:79], v6
    ds_read_b128 v[92:95], v3 offset:35840
    s_waitcnt lgkmcnt(5)
    v_smfmac_f32_16x16x64_bf16 v[28:31], v[48:51], a[80:87], v6
    ds_read_b128 v[56:59], v1 offset:6144
    s_waitcnt lgkmcnt(4)
    v_smfmac_f32_16x16x64_bf16 v[32:35], v[48:51], v[80:87], v6
    ds_read_b128 v[72:75], v3 offset:49152
    s_waitcnt lgkmcnt(4)
    v_smfmac_f32_16x16x64_bf16 v[28:31], v[52:55], a[88:95], v6
    ds_read_b128 v[76:79], v3 offset:50176
    s_waitcnt lgkmcnt(3)
    v_smfmac_f32_16x16x64_bf16 v[32:35], v[52:55], v[88:95], v6
    ds_read_b128 v[60:63], v1 offset:6656
    s_waitcnt lgkmcnt(3)
    v_smfmac_f32_16x16x64_bf16 v[28:31], v[56:59], a[96:103], v6
    ds_read_b128 v[80:83], v3 offset:51200
    s_waitcnt lgkmcnt(2)
    v_smfmac_f32_16x16x64_bf16 v[32:35], v[56:59], v[72:79], v6
    ds_read_b128 v[84:87], v3 offset:52224
    s_waitcnt lgkmcnt(2)
    v_smfmac_f32_16x16x64_bf16 v[28:31], v[60:63], a[104:111], v6
    ds_read_b128 v[64:67], v1 offset:7168
    s_waitcnt lgkmcnt(1)
    v_smfmac_f32_16x16x64_bf16 v[32:35], v[60:63], v[80:87], v6
    ds_read_b128 v[68:71], v1 offset:7680
    s_waitcnt lgkmcnt(1)
    v_smfmac_f32_16x16x64_bf16 v[28:31], v[64:67], a[112:119], v6
    ds_read_b128 v[88:91], v0 offset:16384
    v_smfmac_f32_16x16x64_bf16 v[32:35], v[64:67], a[128:135], v6
    ds_read_b128 v[92:95], v0 offset:20480
    s_waitcnt lgkmcnt(2)
    v_smfmac_f32_16x16x64_bf16 v[28:31], v[68:71], a[120:127], v6
    ds_read_b128 v[72:75], v0 offset:17408
    v_smfmac_f32_16x16x64_bf16 v[32:35], v[68:71], a[136:143], v6
    ds_read_b128 v[76:79], v0 offset:21504
    v_smfmac_f32_16x16x64_bf16 v[36:39], v[40:43], a[208:215], v6
    ds_read_b128 v[80:83], v0 offset:18432
    v_smfmac_f32_16x16x64_bf16 v[36:39], v[44:47], a[216:223], v6
    ds_read_b128 v[84:87], v0 offset:22528
    v_cvt_pk_bf16_f32 v14, v28, v29
    v_cvt_pk_bf16_f32 v15, v30, v31
    v_cvt_pk_bf16_f32 v16, v32, v33
    v_cvt_pk_bf16_f32 v17, v34, v35
    ds_write_b128 v7, v[14:17]
    ds_read_b64_tr_b16 v[96:97], v8 offset:24576
    ds_read_b64_tr_b16 v[98:99], v8 offset:25088
    v_smfmac_f32_16x16x64_bf16 v[36:39], v[48:51], a[224:231], v6
    ds_read_b128 v[28:31], v0 offset:19456
    v_smfmac_f32_16x16x64_bf16 v[36:39], v[56:59], a[240:247], v6
    ds_read_b128 v[32:35], v0 offset:23552
    v_smfmac_f32_16x16x64_bf16 v[36:39], v[60:63], a[248:255], v6
    v_smfmac_f32_16x16x64_bf16 v[36:39], v[52:55], a[232:239], v6
    s_waitcnt lgkmcnt(4)
    s_barrier
    ds_read_b64_tr_b16 v[100:101], v8 offset:25600
    ds_read_b64_tr_b16 v[102:103], v8 offset:26112
    ds_read_b64_tr_b16 v[104:105], v8 offset:26624
    ds_read_b64_tr_b16 v[106:107], v8 offset:27136
    ds_read_b64_tr_b16 v[108:109], v8 offset:27648
    ds_read_b64_tr_b16 v[110:111], v8 offset:28160
    v_smfmac_f32_16x16x64_bf16 v[36:39], v[64:67], v[128:135], v6
    v_smfmac_f32_16x16x64_bf16 v[36:39], v[68:71], v[136:143], v6
    s_waitcnt lgkmcnt(8)
    v_mfma_f32_16x16x32_bf16 v[48:51], v[96:99], v[96:99], v[24:27]
    v_mov_b64 v[52:53], s[62:63]
    v_mov_b64 v[54:55], s[62:63]
    v_mfma_f32_16x16x32_bf16 v[40:43], v[88:91], v[96:99], 0
    v_mfma_f32_16x16x32_bf16 v[44:47], v[92:95], v[96:99], 0
    v_cvt_pk_bf16_f32 v18, v36, v37
    v_cvt_pk_bf16_f32 v19, v38, v39
    s_waitcnt lgkmcnt(4)
    v_mfma_f32_16x16x32_bf16 v[48:51], v[100:103], v[100:103], v[48:51]
    v_mov_b64 v[36:37], v[18:19]
    v_mov_b64 v[38:39], v[18:19]
    v_mfma_f32_16x16x32_bf16 v[40:43], v[72:75], v[100:103], v[40:43]
    v_mfma_f32_16x16x32_bf16 v[44:47], v[76:79], v[100:103], v[44:47]
    v_permlane32_swap_b32 v36, v38
    s_waitcnt lgkmcnt(2)
    v_mfma_f32_16x16x32_bf16 v[48:51], v[104:107], v[104:107], v[48:51]
    v_permlane32_swap_b32 v37, v39
    v_mfma_f32_16x16x32_bf16 v[40:43], v[80:83], v[104:107], v[40:43]
    global_store_dwordx4 v0, v[16:19], s[60:61] sc1
    v_mfma_f32_16x16x32_bf16 v[44:47], v[84:87], v[104:107], v[44:47]
    s_waitcnt lgkmcnt(0)
    v_mfma_f32_16x16x32_bf16 v[48:51], v[108:111], v[108:111], v[48:51]
    v_mfma_f32_16x16x32_bf16 v[40:43], v[28:31], v[108:111], v[40:43]
    v_mfma_f32_16x16x32_bf16 v[44:47], v[32:35], v[108:111], v[44:47]
    s_add_u32 s60, s60, 4096
    s_addc_u32 s61, s61, 0
    s_cmp_ge_u32 s68, 63
    s_cbranch_scc1 Ldn_19
    ds_read_b128 v[72:75], v12 offset:0
    v_max3_f32 v14, v48, v49, v50
    v_max3_f32 v14, v14, v51, v40
    v_max3_f32 v15, v41, v42, v43
    v_max3_f32 v14, v14, v44, v45
    v_max3_f32 v15, v15, v46, v47
    v_max_f32 v14, v14, v15
    v_mov_b32 v15, v14
    v_mov_b64 v[56:57], 0
    v_mov_b64 v[58:59], 0
    ds_read_b128 v[76:79], v12 offset:1024
    v_permlane32_swap_b32 v14, v15
    v_max_f32 v14, v14, v15
    v_mov_b32 v15, v14
    v_mov_b64 v[60:61], 0
    v_mov_b64 v[62:63], 0
    ds_read_b128 v[80:83], v12 offset:2048
    v_permlane16_swap_b32 v14, v15
    v_max_f32 v14, v14, v15
    v_mul_f32 v14, s69, v14
    v_pk_fma_f32 v[40:41], v[40:41], s[80:81], v[14:15] op_sel_hi:[1,1,0] neg_lo:[0,0,1] neg_hi:[0,0,1]
    v_pk_fma_f32 v[42:43], v[42:43], s[80:81], v[14:15] op_sel_hi:[1,1,0] neg_lo:[0,0,1] neg_hi:[0,0,1]
    v_pk_fma_f32 v[44:45], v[44:45], s[80:81], v[14:15] op_sel_hi:[1,1,0] neg_lo:[0,0,1] neg_hi:[0,0,1]
    v_pk_fma_f32 v[46:47], v[46:47], s[80:81], v[14:15] op_sel_hi:[1,1,0] neg_lo:[0,0,1] neg_hi:[0,0,1]
    v_exp_f32 v40, v40
    v_exp_f32 v41, v41
    v_exp_f32 v42, v42
    v_exp_f32 v43, v43
    v_exp_f32 v44, v44
    v_exp_f32 v45, v45
    v_exp_f32 v46, v46
    v_exp_f32 v47, v47
    v_pk_fma_f32 v[48:49], v[48:49], s[80:81], v[14:15] op_sel_hi:[1,1,0] neg_lo:[0,0,1] neg_hi:[0,0,1]
    v_pk_fma_f32 v[50:51], v[50:51], s[80:81], v[14:15] op_sel_hi:[1,1,0] neg_lo:[0,0,1] neg_hi:[0,0,1]
    v_cvt_pk_bf16_f32 v96, v40, v41
    v_cvt_pk_bf16_f32 v97, v42, v43
    v_cvt_pk_bf16_f32 v98, v44, v45
    v_cvt_pk_bf16_f32 v99, v46, v47
    v_exp_f32 v48, v48
    s_nop 0
    v_mfma_f32_16x16x32_bf16 v[40:43], v[52:55], v[96:99], 0
    ds_read_b128 v[84:87], v12 offset:3072
    v_exp_f32 v49, v49
    v_mfma_f32_16x16x32_bf16 v[28:31], v[120:123], v[96:99], 0
    v_exp_f32 v50, v50
    v_mfma_f32_16x16x32_bf16 v[32:35], v[124:127], v[96:99], 0
    v_exp_f32 v51, v51
    v_cvt_pk_bf16_f32 v100, v48, v49
    v_cvt_pk_bf16_f32 v101, v50, v51
    v_mov_b64 v[64:65], 0
    v_mov_b64 v[66:67], 0
    v_mfma_f32_16x16x16_bf16 v[40:43], v[52:53], v[100:101], v[40:43]
    v_mov_b64 v[68:69], 0
    v_mov_b64 v[70:71], 0
    v_mfma_f32_16x16x16_bf16 v[28:31], v[36:37], v[100:101], v[28:31]
    v_mfma_f32_16x16x16_bf16 v[32:35], v[38:39], v[100:101], v[32:35]
    v_rcp_f32 v14, v40
    s_mov_b32 exec_lo, 0xff00ff00
    s_mov_b32 exec_hi, 0xff00ff00
    s_nop 0
    v_pk_mul_f32 v[28:29], v[28:29], v[14:15] op_sel_hi:[1,0]
    v_pk_mul_f32 v[30:31], v[30:31], v[14:15] op_sel_hi:[1,0]
    v_cvt_pk_bf16_f32 v88, v28, v29
    v_cvt_pk_bf16_f32 v89, v30, v31
    v_pk_mul_f32 v[32:33], v[32:33], v[14:15] op_sel_hi:[1,0]
    v_pk_mul_f32 v[34:35], v[34:35], v[14:15] op_sel_hi:[1,0]
    v_cvt_pk_bf16_f32 v90, v32, v33
    v_cvt_pk_bf16_f32 v91, v34, v35
    ds_write_b128 v9, v[88:91]
    s_mov_b64 exec, -1
    v_mov_b32_dpp v88, v88 row_ror:8 row_mask:0xf bank_mask:0x3
    v_mov_b32_dpp v89, v89 row_ror:8 row_mask:0xf bank_mask:0x3
    v_mov_b32_dpp v90, v90 row_ror:8 row_mask:0xf bank_mask:0x3
    v_mov_b32_dpp v91, v91 row_ror:8 row_mask:0xf bank_mask:0x3
    s_waitcnt lgkmcnt(3)
    s_nop 0
    v_smfmac_f32_16x16x64_bf16 v[56:59], v[88:91], v[72:79], v6
    v_smfmac_f32_16x16x64_bf16 v[60:63], v[88:91], v[144:151], v6
    s_waitcnt vmcnt(8) lgkmcnt(0)
    s_barrier
    ds_read_b128 v[100:103], v1 offset:29184
    ds_read_b128 v[104:107], v1 offset:29696
    ds_read_b128 v[108:111], v1 offset:30208
    v_smfmac_f32_16x16x64_bf16 v[64:67], v[88:91], v[160:167], v6
    v_smfmac_f32_16x16x64_bf16 v[68:71], v[88:91], v[176:183], v6
    s_waitcnt lgkmcnt(2)
    v_smfmac_f32_16x16x64_bf16 v[56:59], v[100:103], v[80:87], v6
    v_smfmac_f32_16x16x64_bf16 v[60:63], v[100:103], v[152:159], v6
    s_waitcnt lgkmcnt(1)
    v_smfmac_f32_16x16x64_bf16 v[56:59], v[104:107], v[192:199], v6
    v_smfmac_f32_16x16x64_bf16 v[60:63], v[104:107], v[208:215], v6
    s_waitcnt lgkmcnt(0)
    v_smfmac_f32_16x16x64_bf16 v[56:59], v[108:111], v[200:207], v6
    v_smfmac_f32_16x16x64_bf16 v[60:63], v[108:111], v[216:223], v6
    v_smfmac_f32_16x16x64_bf16 v[64:67], v[100:103], v[168:175], v6
    v_smfmac_f32_16x16x64_bf16 v[68:71], v[100:103], v[184:191], v6
    v_cvt_pk_bf16_f32 v40, v56, v60
    v_smfmac_f32_16x16x64_bf16 v[64:67], v[104:107], v[224:231], v6
    v_cvt_pk_bf16_f32 v41, v57, v61
    v_smfmac_f32_16x16x64_bf16 v[68:71], v[104:107], v[240:247], v6
    v_cvt_pk_bf16_f32 v42, v58, v62
    v_smfmac_f32_16x16x64_bf16 v[64:67], v[108:111], v[232:239], v6
    v_cvt_pk_bf16_f32 v43, v59, v63
    v_smfmac_f32_16x16x64_bf16 v[68:71], v[108:111], v[248:255], v6
    global_store_dwordx4 v10, v[40:43], s[50:51]
    s_nop 6
    v_cvt_pk_bf16_f32 v44, v64, v68
    v_cvt_pk_bf16_f32 v45, v65, v69
    v_cvt_pk_bf16_f32 v46, v66, v70
    v_cvt_pk_bf16_f32 v47, v67, v71
    global_store_dwordx4 v10, v[44:47], s[54:55]
    s_waitcnt vmcnt(1)
    ds_read_b128 v[72:75], v12 offset:16384
    ds_read_b128 v[76:79], v12 offset:17408
    ds_read_b128 v[80:83], v12 offset:18432
    ds_read_b128 v[84:87], v12 offset:19456
    ds_read_b128 v[88:91], v12 offset:32768
    ds_read_b128 v[92:95], v12 offset:33792
    global_load_dwordx4 v[48:51], v0, s[18:19] offset:0 sc1
    global_load_dwordx4 v[52:55], v0, s[18:19] offset:1024 sc1
    s_sleep 2
    global_load_dwordx4 v[64:67], v0, s[18:19] offset:0 sc1
    global_load_dwordx4 v[68:71], v0, s[18:19] offset:1024 sc1
    v_mov_b64 v[28:29], 0
    v_mov_b64 v[30:31], 0
    v_mov_b64 v[32:33], 0
    v_mov_b64 v[34:35], 0
    v_mov_b64 v[36:37], 0
    v_mov_b64 v[38:39], 0
    v_mov_b64 v[96:97], -1
    v_mov_b64 v[98:99], -1
    s_waitcnt vmcnt(2)
    v_mfma_f32_16x16x32_bf16 v[100:103], v[20:23], v[48:51], 0
    v_max3_u32 v14, v48, v49, v50
    v_mfma_f32_16x16x32_bf16 v[100:103], v[20:23], v[52:55], v[100:103]
    v_max3_u32 v15, v51, v52, v53
    v_max3_u32 v14, v14, v54, v55
    v_max_u32 v14, v14, v15
    v_cmp_eq_u32 vcc, -1, v14
    s_cbranch_vccnz LlB_28
LokB_29:
    s_nop 2
    v_add_f32_dpp v100, v100, v100 row_ror:4 row_mask:0xf bank_mask:0xf
    v_add_f32_dpp v101, v101, v101 row_ror:4 row_mask:0xf bank_mask:0xf
    v_add_f32_dpp v102, v102, v102 row_ror:4 row_mask:0xf bank_mask:0xf
    v_add_f32_dpp v103, v103, v103 row_ror:4 row_mask:0xf bank_mask:0xf
    v_add_f32_dpp v100, v100, v100 row_ror:8 row_mask:0xf bank_mask:0xf
    v_add_f32_dpp v101, v101, v101 row_ror:8 row_mask:0xf bank_mask:0xf
    v_add_f32_dpp v102, v102, v102 row_ror:8 row_mask:0xf bank_mask:0xf
    v_add_f32_dpp v103, v103, v103 row_ror:8 row_mask:0xf bank_mask:0xf
    v_cvt_pk_bf16_f32 v100, v100, v101
    v_cvt_pk_bf16_f32 v101, v102, v103
    v_cndmask_b32 v100, v100, v101, s[70:71]
    s_mov_b64 exec, 0x00ff00ff
    global_store_dword v11, v100, s[44:45]
    s_mov_b64 exec, -1
    s_add_u32 s68, s68, 1
    s_add_u32 s64, s68, 2
    s_cmp_lt_u32 s64, s76
    s_cbranch_scc1 Lrec_18
Lrs_30:
Lrdy_31:
    global_load_dword v5, v4, s[42:43] sc1
    s_add_u32 s77, s77, 1
    s_cmp_gt_u32 s77, 0x100000
    s_cbranch_scc1 Lrec_18
    s_waitcnt vmcnt(0)
    v_cmp_le_u32 s[74:75], 32, v5
    s_nop 0
    s_ff0_i32_b64 s76, s[74:75]
    s_add_u32 s64, s68, 2
    s_cmp_lt_u32 s64, s76
    s_cbranch_scc0 Lrdy_31
    s_branch Lrec_18
Ldn_19:
    s_waitcnt vmcnt(0)
    s_mov_b64 exec, 1
    global_store_dword v0, v6, s[36:37] sc1
    s_mov_b64 exec, -1
    s_add_u32 s36, s36, 4096
    s_addc_u32 s37, s37, 0
    s_endpgm
LslA_22:
    s_mov_b64 exec, vcc
    global_load_dwordx4 v[104:107], v2, s[44:45] offset:0 sc1
    global_load_dwordx4 v[108:111], v2, s[44:45] offset:1024 sc1
    s_mov_b64 exec, -1
    s_waitcnt vmcnt(2)
    ds_write_b128 v2, v[64:67] offset:0
    ds_write_b128 v2, v[68:71] offset:1024
    v_max3_u32 v14, v64, v65, v66
    v_max3_u32 v15, v67, v68, v69
    v_max3_u32 v14, v14, v70, v71
    v_max_u32 v14, v14, v15
    v_cmp_eq_u32 vcc, -1, v14
    s_cbranch_vccz LokA_21
    s_mov_b64 exec, vcc
    global_load_dwordx4 v[64:67], v2, s[44:45] offset:0 sc1
    global_load_dwordx4 v[68:71], v2, s[44:45] offset:1024 sc1
    s_mov_b64 exec, -1
    s_waitcnt vmcnt(2)
    ds_write_b128 v2, v[104:107] offset:0
    ds_write_b128 v2, v[108:111] offset:1024
    v_max3_u32 v14, v104, v105, v106
    v_max3_u32 v15, v107, v108, v109
    v_max3_u32 v14, v14, v110, v111
    v_max_u32 v14, v14, v15
    v_cmp_eq_u32 vcc, -1, v14
    s_cbranch_vccz LokA_21
    s_add_u32 s77, s77, 1
    s_cmp_lt_u32 s77, 0x80000
    s_cbranch_scc1 LslA_22
    s_branch LokA_21
LlB_23:
    s_mov_b64 exec, vcc
    global_load_dwordx4 v[48:51], v0, s[16:17] offset:0 sc1
    global_load_dwordx4 v[52:55], v0, s[16:17] offset:1024 sc1
    s_mov_b64 exec, -1
    s_waitcnt vmcnt(2)
    v_mfma_f32_16x16x32_bf16 v[100:103], v[20:23], v[64:67], 0
    v_max3_u32 v14, v64, v65, v66
    v_mfma_f32_16x16x32_bf16 v[100:103], v[20:23], v[68:71], v[100:103]
    v_max3_u32 v15, v67, v68, v69
    v_max3_u32 v14, v14, v70, v71
    v_max_u32 v14, v14, v15
    v_cmp_eq_u32 vcc, -1, v14
    s_cbranch_vccz LokB_24
    s_mov_b64 exec, vcc
    global_load_dwordx4 v[64:67], v0, s[16:17] offset:0 sc1
    global_load_dwordx4 v[68:71], v0, s[16:17] offset:1024 sc1
    s_mov_b64 exec, -1
    s_waitcnt vmcnt(2)
    v_mfma_f32_16x16x32_bf16 v[100:103], v[20:23], v[48:51], 0
    v_max3_u32 v14, v48, v49, v50
    v_mfma_f32_16x16x32_bf16 v[100:103], v[20:23], v[52:55], v[100:103]
    v_max3_u32 v15, v51, v52, v53
    v_max3_u32 v14, v14, v54, v55
    v_max_u32 v14, v14, v15
    v_cmp_eq_u32 vcc, -1, v14
    s_cbranch_vccz LokB_24
    s_add_u32 s77, s77, 1
    s_cmp_lt_u32 s77, 0x80000
    s_cbranch_scc1 LlB_23
    s_branch LokB_24
LslA_27:
    s_mov_b64 exec, vcc
    global_load_dwordx4 v[104:107], v2, s[46:47] offset:0 sc1
    global_load_dwordx4 v[108:111], v2, s[46:47] offset:1024 sc1
    s_mov_b64 exec, -1
    s_waitcnt vmcnt(2)
    ds_write_b128 v2, v[64:67] offset:0
    ds_write_b128 v2, v[68:71] offset:1024
    v_max3_u32 v14, v64, v65, v66
    v_max3_u32 v15, v67, v68, v69
    v_max3_u32 v14, v14, v70, v71
    v_max_u32 v14, v14, v15
    v_cmp_eq_u32 vcc, -1, v14
    s_cbranch_vccz LokA_26
    s_mov_b64 exec, vcc
    global_load_dwordx4 v[64:67], v2, s[46:47] offset:0 sc1
    global_load_dwordx4 v[68:71], v2, s[46:47] offset:1024 sc1
    s_mov_b64 exec, -1
    s_waitcnt vmcnt(2)
    ds_write_b128 v2, v[104:107] offset:0
    ds_write_b128 v2, v[108:111] offset:1024
    v_max3_u32 v14, v104, v105, v106
    v_max3_u32 v15, v107, v108, v109
    v_max3_u32 v14, v14, v110, v111
    v_max_u32 v14, v14, v15
    v_cmp_eq_u32 vcc, -1, v14
    s_cbranch_vccz LokA_26
    s_add_u32 s77, s77, 1
    s_cmp_lt_u32 s77, 0x80000
    s_cbranch_scc1 LslA_27
    s_branch LokA_26
LlB_28:
    s_mov_b64 exec, vcc
    global_load_dwordx4 v[48:51], v0, s[18:19] offset:0 sc1
    global_load_dwordx4 v[52:55], v0, s[18:19] offset:1024 sc1
    s_mov_b64 exec, -1
    s_waitcnt vmcnt(2)
    v_mfma_f32_16x16x32_bf16 v[100:103], v[20:23], v[64:67], 0
    v_max3_u32 v14, v64, v65, v66
    v_mfma_f32_16x16x32_bf16 v[100:103], v[20:23], v[68:71], v[100:103]
    v_max3_u32 v15, v67, v68, v69
    v_max3_u32 v14, v14, v70, v71
    v_max_u32 v14, v14, v15
    v_cmp_eq_u32 vcc, -1, v14
    s_cbranch_vccz LokB_29
    s_mov_b64 exec, vcc
    global_load_dwordx4 v[64:67], v0, s[18:19] offset:0 sc1
    global_load_dwordx4 v[68:71], v0, s[18:19] offset:1024 sc1
    s_mov_b64 exec, -1
    s_waitcnt vmcnt(2)
    v_mfma_f32_16x16x32_bf16 v[100:103], v[20:23], v[48:51], 0
    v_max3_u32 v14, v48, v49, v50
    v_mfma_f32_16x16x32_bf16 v[100:103], v[20:23], v[52:55], v[100:103]
    v_max3_u32 v15, v51, v52, v53
    v_max3_u32 v14, v14, v54, v55
    v_max_u32 v14, v14, v15
    v_cmp_eq_u32 vcc, -1, v14
    s_cbranch_vccz LokB_29
    s_add_u32 s77, s77, 1
    s_cmp_lt_u32 s77, 0x80000
    s_cbranch_scc1 LlB_28
    s_branch LokB_29
Lrw_15:
    ds_read_b128 v[72:75], v12 offset:49152
    ds_read_b128 v[76:79], v12 offset:50176
    ds_read_b128 v[80:83], v12 offset:51200
    ds_read_b128 v[84:87], v12 offset:52224
    ds_read_b128 v[88:91], v3 offset:0
    ds_read_b128 v[92:95], v3 offset:1024
    v_mov_b64 v[28:29], 0
    v_mov_b64 v[30:31], 0
    v_mov_b64 v[32:33], 0
    v_mov_b64 v[34:35], 0
    v_mov_b64 v[36:37], 0
    v_mov_b64 v[38:39], 0
    v_mov_b64 v[96:97], -1
    v_mov_b64 v[98:99], -1
Lrec_32:
    s_waitcnt vmcnt(0)
    global_load_dwordx4 v[104:107], v2, s[44:45] offset:0 sc1
    global_load_dwordx4 v[108:111], v2, s[44:45] offset:1024 sc1
    s_sleep 2
    global_load_dwordx4 v[64:67], v2, s[44:45] offset:0 sc1
    global_load_dwordx4 v[68:71], v2, s[44:45] offset:1024 sc1
    s_waitcnt vmcnt(2)
    ds_write_b128 v2, v[104:107] offset:0
    ds_write_b128 v2, v[108:111] offset:1024
    v_max3_u32 v14, v104, v105, v106
    v_max3_u32 v15, v107, v108, v109
    v_max3_u32 v14, v14, v110, v111
    v_max_u32 v14, v14, v15
    v_cmp_eq_u32 vcc, -1, v14
    s_cbranch_vccnz LslA_36
LokA_35:
    ds_read_b128 v[40:43], v1 offset:2048
    ds_read_b128 v[44:47], v1 offset:2560
    ds_read_b128 v[48:51], v1 offset:3072
    ds_read_b128 v[52:55], v1 offset:3584
    s_waitcnt lgkmcnt(4)
    s_barrier
    s_waitcnt lgkmcnt(3)
    v_smfmac_f32_16x16x64_bf16 v[28:31], v[40:43], a[32:39], v6
    ds_read_b128 v[56:59], v1 offset:4096
    v_smfmac_f32_16x16x64_bf16 v[36:39], v[40:43], a[176:183], v6
    ds_read_b128 v[60:63], v1 offset:4608
    v_smfmac_f32_16x16x64_bf16 v[32:35], v[40:43], v[72:79], v6
    ds_read_b128 v[72:75], v3 offset:2048
    s_waitcnt lgkmcnt(5)
    v_smfmac_f32_16x16x64_bf16 v[28:31], v[44:47], a[40:47], v6
    ds_read_b128 v[76:79], v3 offset:3072
    v_smfmac_f32_16x16x64_bf16 v[36:39], v[44:47], a[184:191], v6
    ds_read_b128 v[40:43], v1 offset:6144
    v_smfmac_f32_16x16x64_bf16 v[32:35], v[44:47], v[80:87], v6
    ds_read_b128 v[80:83], v3 offset:16384
    s_waitcnt vmcnt(0)
    s_waitcnt lgkmcnt(7)
    v_smfmac_f32_16x16x64_bf16 v[28:31], v[48:51], a[48:55], v6
    s_mov_b64 exec, 0x00ff00ff
    global_store_dword v11, v96, s[46:47]
    s_mov_b64 exec, -1
    v_smfmac_f32_16x16x64_bf16 v[36:39], v[48:51], a[192:199], v6
    ds_read_b128 v[84:87], v3 offset:17408
    s_add_u32 m0, s78, 8192
    global_load_dwordx4 v[120:123], v0, s[58:59] sc1
    v_smfmac_f32_16x16x64_bf16 v[32:35], v[48:51], v[88:95], v6
    ds_read_b128 v[88:91], v3 offset:18432
    global_load_lds_dwordx4 v0, s[56:57] sc1
    s_waitcnt lgkmcnt(8)
    v_smfmac_f32_16x16x64_bf16 v[28:31], v[52:55], a[56:63], v6
    ds_read_b128 v[92:95], v3 offset:19456
    global_load_lds_dwordx4 v0, s[56:57] offset:1024 sc1
    v_smfmac_f32_16x16x64_bf16 v[36:39], v[52:55], a[200:207], v6
    ds_read_b128 v[64:67], v1 offset:5120
    global_load_dwordx4 v[124:127], v0, s[58:59] offset:1024 sc1
    s_waitcnt lgkmcnt(6)
    v_smfmac_f32_16x16x64_bf16 v[32:35], v[52:55], v[72:79], v6
    ds_read_b128 v[72:75], v3 offset:32768
    s_add_u32 s56, s56, 8192
    s_addc_u32 s57, s57, 0
    v_smfmac_f32_16x16x64_bf16 v[28:31], v[56:59], a[64:71], v6
    ds_read_b128 v[76:79], v3 offset:33792
    s_add_u32 s58, s58, 8192
    s_addc_u32 s59, s59, 0
    v_smfmac_f32_16x16x64_bf16 v[36:39], v[56:59], a[208:215], v6
    s_mov_b64 exec, 1
    global_store_dword v0, v6, s[36:37] sc1
    s_mov_b64 exec, -1
    s_waitcnt lgkmcnt(5)
    v_smfmac_f32_16x16x64_bf16 v[32:35], v[56:59], v[80:87], v6
    ds_read_b128 v[68:71], v1 offset:5632
    s_add_u32 s36, s36, 4096
    s_addc_u32 s37, s37, 0
    v_smfmac_f32_16x16x64_bf16 v[28:31], v[60:63], a[72:79], v6
    ds_read_b128 v[80:83], v3 offset:34816
    v_smfmac_f32_16x16x64_bf16 v[36:39], v[60:63], a[216:223], v6
    ds_read_b128 v[84:87], v3 offset:35840
    s_waitcnt lgkmcnt(6)
    v_smfmac_f32_16x16x64_bf16 v[32:35], v[60:63], v[88:95], v6
    ds_read_b128 v[88:91], v3 offset:49152
    global_store_dwordx4 v0, v[96:99], s[18:19]
    s_waitcnt lgkmcnt(6)
    v_smfmac_f32_16x16x64_bf16 v[28:31], v[64:67], a[80:87], v6
    ds_read_b128 v[92:95], v3 offset:50176
    v_smfmac_f32_16x16x64_bf16 v[36:39], v[64:67], a[224:231], v6
    ds_read_b128 v[44:47], v1 offset:6656
    s_waitcnt lgkmcnt(6)
    v_smfmac_f32_16x16x64_bf16 v[32:35], v[64:67], v[72:79], v6
    ds_read_b128 v[72:75], v3 offset:51200
    s_waitcnt lgkmcnt(6)
    v_smfmac_f32_16x16x64_bf16 v[28:31], v[68:71], a[88:95], v6
    ds_read_b128 v[76:79], v3 offset:52224
    v_smfmac_f32_16x16x64_bf16 v[36:39], v[68:71], a[232:239], v6
    ds_read_b128 v[48:51], v1 offset:7168
    s_waitcnt lgkmcnt(6)
    v_smfmac_f32_16x16x64_bf16 v[32:35], v[68:71], v[80:87], v6
    ds_read_b128 v[52:55], v1 offset:7680
    v_smfmac_f32_16x16x64_bf16 v[28:31], v[40:43], a[96:103], v6
    ds_read_b128 v[56:59], v1 offset:0
    s_waitcnt lgkmcnt(6)
    v_smfmac_f32_16x16x64_bf16 v[32:35], v[40:43], v[88:95], v6
    ds_read_b128 v[80:83], v12 offset:16384
    global_store_dwordx4 v0, v[96:99], s[18:19] offset:1024
    s_waitcnt lgkmcnt(6)
    v_smfmac_f32_16x16x64_bf16 v[28:31], v[44:47], a[104:111], v6
    ds_read_b128 v[84:87], v12 offset:17408
    s_waitcnt lgkmcnt(5)
    v_smfmac_f32_16x16x64_bf16 v[32:35], v[44:47], v[72:79], v6
    ds_read_b128 v[60:63], v1 offset:512
    s_waitcnt lgkmcnt(5)
    v_smfmac_f32_16x16x64_bf16 v[28:31], v[48:51], a[112:119], v6
    ds_read_b128 v[88:91], v12 offset:18432
    v_smfmac_f32_16x16x64_bf16 v[32:35], v[48:51], a[128:135], v6
    ds_read_b128 v[92:95], v12 offset:19456
    s_waitcnt lgkmcnt(6)
    v_smfmac_f32_16x16x64_bf16 v[28:31], v[52:55], a[120:127], v6
    ds_read_b128 v[64:67], v1 offset:1024
    v_smfmac_f32_16x16x64_bf16 v[32:35], v[52:55], a[136:143], v6
    ds_read_b128 v[72:75], v12 offset:32768
    s_waitcnt lgkmcnt(7)
    v_smfmac_f32_16x16x64_bf16 v[28:31], v[56:59], a[0:7], v6
    ds_read_b128 v[76:79], v12 offset:33792
    s_waitcnt lgkmcnt(6)
    v_smfmac_f32_16x16x64_bf16 v[32:35], v[56:59], v[80:87], v6
    ds_read_b128 v[68:71], v1 offset:1536
    s_waitcnt lgkmcnt(6)
    v_smfmac_f32_16x16x64_bf16 v[28:31], v[60:63], a[8:15], v6
    ds_read_b128 v[80:83], v12 offset:34816
    s_waitcnt lgkmcnt(5)
    v_smfmac_f32_16x16x64_bf16 v[32:35], v[60:63], v[88:95], v6
    ds_read_b128 v[84:87], v12 offset:35840
    s_waitcnt lgkmcnt(5)
    v_smfmac_f32_16x16x64_bf16 v[28:31], v[64:67], a[16:23], v6
    ds_read_b128 v[88:91], v0 offset:8192
    s_waitcnt lgkmcnt(4)
    v_smfmac_f32_16x16x64_bf16 v[32:35], v[64:67], v[72:79], v6
    ds_read_b128 v[92:95], v0 offset:12288
    s_waitcnt lgkmcnt(4)
    v_smfmac_f32_16x16x64_bf16 v[28:31], v[68:71], a[24:31], v6
    ds_read_b128 v[72:75], v0 offset:9216
    s_waitcnt lgkmcnt(3)
    v_smfmac_f32_16x16x64_bf16 v[32:35], v[68:71], v[80:87], v6
    ds_read_b128 v[76:79], v0 offset:13312
    v_smfmac_f32_16x16x64_bf16 v[36:39], v[40:43], a[240:247], v6
    ds_read_b128 v[80:83], v0 offset:10240
    v_smfmac_f32_16x16x64_bf16 v[36:39], v[44:47], a[248:255], v6
    ds_read_b128 v[84:87], v0 offset:14336
    v_cvt_pk_bf16_f32 v14, v28, v29
    v_cvt_pk_bf16_f32 v15, v30, v31
    v_cvt_pk_bf16_f32 v16, v32, v33
    v_cvt_pk_bf16_f32 v17, v34, v35
    ds_write_b128 v7, v[14:17]
    ds_read_b64_tr_b16 v[100:101], v8 offset:25600
    ds_read_b64_tr_b16 v[102:103], v8 offset:26112
    v_smfmac_f32_16x16x64_bf16 v[36:39], v[48:51], v[128:135], v6
    ds_read_b128 v[28:31], v0 offset:11264
    v_smfmac_f32_16x16x64_bf16 v[36:39], v[56:59], a[144:151], v6
    ds_read_b128 v[32:35], v0 offset:15360
    v_smfmac_f32_16x16x64_bf16 v[36:39], v[60:63], a[152:159], v6
    v_smfmac_f32_16x16x64_bf16 v[36:39], v[52:55], v[136:143], v6
    s_waitcnt lgkmcnt(4)
    s_barrier
    ds_read_b64_tr_b16 v[96:97], v8 offset:24576
    ds_read_b64_tr_b16 v[98:99], v8 offset:25088
    ds_read_b64_tr_b16 v[104:105], v8 offset:26624
    ds_read_b64_tr_b16 v[106:107], v8 offset:27136
    ds_read_b64_tr_b16 v[108:109], v8 offset:27648
    ds_read_b64_tr_b16 v[110:111], v8 offset:28160
    v_smfmac_f32_16x16x64_bf16 v[36:39], v[64:67], a[160:167], v6
    v_smfmac_f32_16x16x64_bf16 v[36:39], v[68:71], a[168:175], v6
    s_waitcnt lgkmcnt(8)
    v_mfma_f32_16x16x32_bf16 v[48:51], v[100:103], v[100:103], v[24:27]
    v_mov_b64 v[52:53], s[62:63]
    v_mov_b64 v[54:55], s[62:63]
    v_mfma_f32_16x16x32_bf16 v[40:43], v[72:75], v[100:103], 0
    v_mfma_f32_16x16x32_bf16 v[44:47], v[76:79], v[100:103], 0
    v_cvt_pk_bf16_f32 v18, v36, v37
    v_cvt_pk_bf16_f32 v19, v38, v39
    s_waitcnt lgkmcnt(4)
    v_mfma_f32_16x16x32_bf16 v[48:51], v[96:99], v[96:99], v[48:51]
    v_mov_b64 v[36:37], v[18:19]
    v_mov_b64 v[38:39], v[18:19]
    v_mfma_f32_16x16x32_bf16 v[40:43], v[88:91], v[96:99], v[40:43]
    v_mfma_f32_16x16x32_bf16 v[44:47], v[92:95], v[96:99], v[44:47]
    v_permlane32_swap_b32 v36, v38
    s_waitcnt lgkmcnt(2)
    v_mfma_f32_16x16x32_bf16 v[48:51], v[104:107], v[104:107], v[48:51]
    v_permlane32_swap_b32 v37, v39
    v_mfma_f32_16x16x32_bf16 v[40:43], v[80:83], v[104:107], v[40:43]
    v_mfma_f32_16x16x32_bf16 v[44:47], v[84:87], v[104:107], v[44:47]
    global_store_dwordx4 v0, v[16:19], s[60:61] sc1
    s_waitcnt lgkmcnt(0)
    v_mfma_f32_16x16x32_bf16 v[48:51], v[108:111], v[108:111], v[48:51]
    v_mfma_f32_16x16x32_bf16 v[40:43], v[28:31], v[108:111], v[40:43]
    v_mfma_f32_16x16x32_bf16 v[44:47], v[32:35], v[108:111], v[44:47]
    s_add_u32 s60, s60, 4096
    s_addc_u32 s61, s61, 0
    ds_read_b128 v[72:75], v12 offset:0
    v_max3_f32 v14, v48, v49, v50
    v_max3_f32 v14, v14, v51, v40
    v_max3_f32 v15, v41, v42, v43
    s_nop 1
    v_max3_f32 v14, v14, v44, v45
    v_max3_f32 v15, v15, v46, v47
    v_max_f32 v14, v14, v15
    v_mov_b32 v15, v14
    v_mov_b64 v[56:57], 0
    v_mov_b64 v[58:59], 0
    ds_read_b128 v[76:79], v12 offset:1024
    v_permlane32_swap_b32 v14, v15
    v_max_f32 v14, v14, v15
    v_mov_b32 v15, v14
    v_mov_b64 v[60:61], 0
    v_mov_b64 v[62:63], 0
    ds_read_b128 v[80:83], v12 offset:2048
    v_permlane16_swap_b32 v14, v15
    v_max_f32 v14, v14, v15
    v_mul_f32 v14, s69, v14
    v_pk_fma_f32 v[40:41], v[40:41], s[80:81], v[14:15] op_sel_hi:[1,1,0] neg_lo:[0,0,1] neg_hi:[0,0,1]
    v_pk_fma_f32 v[42:43], v[42:43], s[80:81], v[14:15] op_sel_hi:[1,1,0] neg_lo:[0,0,1] neg_hi:[0,0,1]
    v_pk_fma_f32 v[44:45], v[44:45], s[80:81], v[14:15] op_sel_hi:[1,1,0] neg_lo:[0,0,1] neg_hi:[0,0,1]
    v_pk_fma_f32 v[46:47], v[46:47], s[80:81], v[14:15] op_sel_hi:[1,1,0] neg_lo:[0,0,1] neg_hi:[0,0,1]
    v_exp_f32 v40, v40
    v_exp_f32 v41, v41
    v_exp_f32 v42, v42
    v_exp_f32 v43, v43
    v_exp_f32 v44, v44
    v_exp_f32 v45, v45
    v_exp_f32 v46, v46
    v_exp_f32 v47, v47
    v_pk_fma_f32 v[48:49], v[48:49], s[80:81], v[14:15] op_sel_hi:[1,1,0] neg_lo:[0,0,1] neg_hi:[0,0,1]
    v_pk_fma_f32 v[50:51], v[50:51], s[80:81], v[14:15] op_sel_hi:[1,1,0] neg_lo:[0,0,1] neg_hi:[0,0,1]
    v_cvt_pk_bf16_f32 v96, v40, v41
    v_cvt_pk_bf16_f32 v97, v42, v43
    v_cvt_pk_bf16_f32 v98, v44, v45
    v_cvt_pk_bf16_f32 v99, v46, v47
    v_exp_f32 v48, v48
    s_nop 0
    v_mfma_f32_16x16x32_bf16 v[40:43], v[52:55], v[96:99], 0
    ds_read_b128 v[84:87], v12 offset:3072
    v_exp_f32 v49, v49
    v_mfma_f32_16x16x32_bf16 v[28:31], v[112:115], v[96:99], 0
    v_exp_f32 v50, v50
    v_mfma_f32_16x16x32_bf16 v[32:35], v[116:119], v[96:99], 0
    v_exp_f32 v51, v51
    v_cvt_pk_bf16_f32 v100, v48, v49
    v_cvt_pk_bf16_f32 v101, v50, v51
    v_mov_b64 v[64:65], 0
    v_mov_b64 v[66:67], 0
    v_mfma_f32_16x16x16_bf16 v[40:43], v[52:53], v[100:101], v[40:43]
    v_mov_b64 v[68:69], 0
    v_mov_b64 v[70:71], 0
    v_mfma_f32_16x16x16_bf16 v[28:31], v[36:37], v[100:101], v[28:31]
    v_mfma_f32_16x16x16_bf16 v[32:35], v[38:39], v[100:101], v[32:35]
    v_rcp_f32 v14, v40
    s_mov_b32 exec_lo, 0xff00ff00
    s_mov_b32 exec_hi, 0xff00ff00
    s_nop 0
    v_pk_mul_f32 v[28:29], v[28:29], v[14:15] op_sel_hi:[1,0]
    v_pk_mul_f32 v[30:31], v[30:31], v[14:15] op_sel_hi:[1,0]
    v_cvt_pk_bf16_f32 v88, v28, v29
    v_cvt_pk_bf16_f32 v89, v30, v31
    v_pk_mul_f32 v[32:33], v[32:33], v[14:15] op_sel_hi:[1,0]
    v_pk_mul_f32 v[34:35], v[34:35], v[14:15] op_sel_hi:[1,0]
    v_cvt_pk_bf16_f32 v90, v32, v33
    v_cvt_pk_bf16_f32 v91, v34, v35
    ds_write_b128 v9, v[88:91]
    s_mov_b64 exec, -1
    v_mov_b32_dpp v88, v88 row_ror:8 row_mask:0xf bank_mask:0x3
    v_mov_b32_dpp v89, v89 row_ror:8 row_mask:0xf bank_mask:0x3
    v_mov_b32_dpp v90, v90 row_ror:8 row_mask:0xf bank_mask:0x3
    v_mov_b32_dpp v91, v91 row_ror:8 row_mask:0xf bank_mask:0x3
    s_waitcnt lgkmcnt(1)
    s_nop 0
    v_smfmac_f32_16x16x64_bf16 v[56:59], v[88:91], v[80:87], v6
    v_smfmac_f32_16x16x64_bf16 v[60:63], v[88:91], v[152:159], v6
    s_waitcnt vmcnt(8) lgkmcnt(0)
    s_barrier
    ds_read_b128 v[96:99], v1 offset:28672
    ds_read_b128 v[104:107], v1 offset:29696
    ds_read_b128 v[108:111], v1 offset:30208
    v_smfmac_f32_16x16x64_bf16 v[64:67], v[88:91], v[168:175], v6
    v_smfmac_f32_16x16x64_bf16 v[68:71], v[88:91], v[184:191], v6
    s_waitcnt lgkmcnt(2)
    v_smfmac_f32_16x16x64_bf16 v[56:59], v[96:99], v[72:79], v6
    v_smfmac_f32_16x16x64_bf16 v[60:63], v[96:99], v[144:151], v6
    s_waitcnt lgkmcnt(1)
    v_smfmac_f32_16x16x64_bf16 v[56:59], v[104:107], v[192:199], v6
    v_smfmac_f32_16x16x64_bf16 v[60:63], v[104:107], v[208:215], v6
    s_waitcnt lgkmcnt(0)
    v_smfmac_f32_16x16x64_bf16 v[56:59], v[108:111], v[200:207], v6
    v_smfmac_f32_16x16x64_bf16 v[60:63], v[108:111], v[216:223], v6
    v_smfmac_f32_16x16x64_bf16 v[64:67], v[96:99], v[160:167], v6
    v_smfmac_f32_16x16x64_bf16 v[68:71], v[96:99], v[176:183], v6
    v_cvt_pk_bf16_f32 v40, v56, v60
    v_smfmac_f32_16x16x64_bf16 v[64:67], v[104:107], v[224:231], v6
    v_cvt_pk_bf16_f32 v41, v57, v61
    v_smfmac_f32_16x16x64_bf16 v[68:71], v[104:107], v[240:247], v6
    v_cvt_pk_bf16_f32 v42, v58, v62
    v_smfmac_f32_16x16x64_bf16 v[64:67], v[108:111], v[232:239], v6
    v_cvt_pk_bf16_f32 v43, v59, v63
    v_smfmac_f32_16x16x64_bf16 v[68:71], v[108:111], v[248:255], v6
    global_store_dwordx4 v10, v[40:43], s[48:49]
    s_nop 6
    v_cvt_pk_bf16_f32 v44, v64, v68
    v_cvt_pk_bf16_f32 v45, v65, v69
    v_cvt_pk_bf16_f32 v46, v66, v70
    v_cvt_pk_bf16_f32 v47, v67, v71
    global_store_dwordx4 v10, v[44:47], s[52:53]
    s_waitcnt vmcnt(1)
    ds_read_b128 v[72:75], v12 offset:49152
    ds_read_b128 v[76:79], v12 offset:50176
    ds_read_b128 v[80:83], v12 offset:51200
    ds_read_b128 v[84:87], v12 offset:52224
    ds_read_b128 v[88:91], v3 offset:0
    ds_read_b128 v[92:95], v3 offset:1024
    global_load_dwordx4 v[48:51], v0, s[16:17] offset:0 sc1
    global_load_dwordx4 v[52:55], v0, s[16:17] offset:1024 sc1
    s_sleep 2
    global_load_dwordx4 v[64:67], v0, s[16:17] offset:0 sc1
    global_load_dwordx4 v[68:71], v0, s[16:17] offset:1024 sc1
    v_mov_b64 v[28:29], 0
    v_mov_b64 v[30:31], 0
    v_mov_b64 v[32:33], 0
    v_mov_b64 v[34:35], 0
    v_mov_b64 v[36:37], 0
    v_mov_b64 v[38:39], 0
    v_mov_b64 v[96:97], -1
    v_mov_b64 v[98:99], -1
    s_waitcnt vmcnt(2)
    v_mfma_f32_16x16x32_bf16 v[100:103], v[20:23], v[48:51], 0
    v_max3_u32 v14, v48, v49, v50
    v_mfma_f32_16x16x32_bf16 v[100:103], v[20:23], v[52:55], v[100:103]
    v_max3_u32 v15, v51, v52, v53
    v_max3_u32 v14, v14, v54, v55
    v_max_u32 v14, v14, v15
    v_cmp_eq_u32 vcc, -1, v14
    s_cbranch_vccnz LlB_37
LokB_38:
    s_nop 2
    v_add_f32_dpp v100, v100, v100 row_ror:4 row_mask:0xf bank_mask:0xf
    v_add_f32_dpp v101, v101, v101 row_ror:4 row_mask:0xf bank_mask:0xf
    v_add_f32_dpp v102, v102, v102 row_ror:4 row_mask:0xf bank_mask:0xf
    v_add_f32_dpp v103, v103, v103 row_ror:4 row_mask:0xf bank_mask:0xf
    v_add_f32_dpp v100, v100, v100 row_ror:8 row_mask:0xf bank_mask:0xf
    v_add_f32_dpp v101, v101, v101 row_ror:8 row_mask:0xf bank_mask:0xf
    v_add_f32_dpp v102, v102, v102 row_ror:8 row_mask:0xf bank_mask:0xf
    v_add_f32_dpp v103, v103, v103 row_ror:8 row_mask:0xf bank_mask:0xf
    v_cvt_pk_bf16_f32 v100, v100, v101
    v_cvt_pk_bf16_f32 v101, v102, v103
    v_cndmask_b32 v100, v100, v101, s[70:71]
    s_mov_b64 exec, 0x00ff00ff
    global_store_dword v11, v100, s[46:47]
    s_mov_b64 exec, -1
    s_add_u32 s68, s68, 1
    s_waitcnt vmcnt(0)
    global_load_dwordx4 v[104:107], v2, s[46:47] offset:0 sc1
    global_load_dwordx4 v[108:111], v2, s[46:47] offset:1024 sc1
    s_sleep 2
    global_load_dwordx4 v[64:67], v2, s[46:47] offset:0 sc1
    global_load_dwordx4 v[68:71], v2, s[46:47] offset:1024 sc1
    s_waitcnt vmcnt(2)
    ds_write_b128 v2, v[104:107] offset:0
    ds_write_b128 v2, v[108:111] offset:1024
    v_max3_u32 v14, v104, v105, v106
    v_max3_u32 v15, v107, v108, v109
    v_max3_u32 v14, v14, v110, v111
    v_max_u32 v14, v14, v15
    v_cmp_eq_u32 vcc, -1, v14
    s_cbranch_vccnz LslA_41
LokA_40:
    ds_read_b128 v[40:43], v1 offset:2048
    ds_read_b128 v[44:47], v1 offset:2560
    ds_read_b128 v[48:51], v1 offset:3072
    ds_read_b128 v[52:55], v1 offset:3584
    s_waitcnt lgkmcnt(4)
    s_barrier
    s_waitcnt lgkmcnt(3)
    v_smfmac_f32_16x16x64_bf16 v[28:31], v[40:43], a[32:39], v6
    ds_read_b128 v[56:59], v1 offset:4096
    v_smfmac_f32_16x16x64_bf16 v[36:39], v[40:43], a[176:183], v6
    ds_read_b128 v[60:63], v1 offset:4608
    v_smfmac_f32_16x16x64_bf16 v[32:35], v[40:43], v[72:79], v6
    ds_read_b128 v[72:75], v3 offset:2048
    s_waitcnt lgkmcnt(5)
    v_smfmac_f32_16x16x64_bf16 v[28:31], v[44:47], a[40:47], v6
    ds_read_b128 v[76:79], v3 offset:3072
    v_smfmac_f32_16x16x64_bf16 v[36:39], v[44:47], a[184:191], v6
    ds_read_b128 v[40:43], v1 offset:6144
    v_smfmac_f32_16x16x64_bf16 v[32:35], v[44:47], v[80:87], v6
    ds_read_b128 v[80:83], v3 offset:16384
    s_waitcnt vmcnt(0)
    s_waitcnt lgkmcnt(7)
    v_smfmac_f32_16x16x64_bf16 v[28:31], v[48:51], a[48:55], v6
    s_mov_b64 exec, 0x00ff00ff
    global_store_dword v11, v96, s[44:45]
    s_mov_b64 exec, -1
    v_smfmac_f32_16x16x64_bf16 v[36:39], v[48:51], a[192:199], v6
    ds_read_b128 v[84:87], v3 offset:17408
    s_add_u32 m0, s78, 0
    global_load_dwordx4 v[112:115], v0, s[58:59] sc1
    v_smfmac_f32_16x16x64_bf16 v[32:35], v[48:51], v[88:95], v6
    ds_read_b128 v[88:91], v3 offset:18432
    global_load_lds_dwordx4 v0, s[56:57] sc1
    s_waitcnt lgkmcnt(8)
    v_smfmac_f32_16x16x64_bf16 v[28:31], v[52:55], a[56:63], v6
    ds_read_b128 v[92:95], v3 offset:19456
    global_load_lds_dwordx4 v0, s[56:57] offset:1024 sc1
    v_smfmac_f32_16x16x64_bf16 v[36:39], v[52:55], a[200:207], v6
    ds_read_b128 v[64:67], v1 offset:5120
    global_load_dwordx4 v[116:119], v0, s[58:59] offset:1024 sc1
    s_waitcnt lgkmcnt(6)
    v_smfmac_f32_16x16x64_bf16 v[32:35], v[52:55], v[72:79], v6
    ds_read_b128 v[72:75], v3 offset:32768
    s_add_u32 s56, s56, 8192
    s_addc_u32 s57, s57, 0
    v_smfmac_f32_16x16x64_bf16 v[28:31], v[56:59], a[64:71], v6
    ds_read_b128 v[76:79], v3 offset:33792
    s_add_u32 s58, s58, 8192
    s_addc_u32 s59, s59, 0
    v_smfmac_f32_16x16x64_bf16 v[36:39], v[56:59], a[208:215], v6
    s_mov_b64 exec, 1
    global_store_dword v0, v6, s[36:37] sc1
    s_mov_b64 exec, -1
    s_waitcnt lgkmcnt(5)
    v_smfmac_f32_16x16x64_bf16 v[32:35], v[56:59], v[80:87], v6
    ds_read_b128 v[68:71], v1 offset:5632
    s_add_u32 s36, s36, 4096
    s_addc_u32 s37, s37, 0
    v_smfmac_f32_16x16x64_bf16 v[28:31], v[60:63], a[72:79], v6
    ds_read_b128 v[80:83], v3 offset:34816
    v_smfmac_f32_16x16x64_bf16 v[36:39], v[60:63], a[216:223], v6
    ds_read_b128 v[84:87], v3 offset:35840
    s_waitcnt lgkmcnt(6)
    v_smfmac_f32_16x16x64_bf16 v[32:35], v[60:63], v[88:95], v6
    ds_read_b128 v[88:91], v3 offset:49152
    global_store_dwordx4 v0, v[96:99], s[16:17]
    s_waitcnt lgkmcnt(6)
    v_smfmac_f32_16x16x64_bf16 v[28:31], v[64:67], a[80:87], v6
    ds_read_b128 v[92:95], v3 offset:50176
    v_smfmac_f32_16x16x64_bf16 v[36:39], v[64:67], a[224:231], v6
    ds_read_b128 v[44:47], v1 offset:6656
    s_waitcnt lgkmcnt(6)
    v_smfmac_f32_16x16x64_bf16 v[32:35], v[64:67], v[72:79], v6
    ds_read_b128 v[72:75], v3 offset:51200
    s_waitcnt lgkmcnt(6)
    v_smfmac_f32_16x16x64_bf16 v[28:31], v[68:71], a[88:95], v6
    ds_read_b128 v[76:79], v3 offset:52224
    v_smfmac_f32_16x16x64_bf16 v[36:39], v[68:71], a[232:239], v6
    ds_read_b128 v[48:51], v1 offset:7168
    s_waitcnt lgkmcnt(6)
    v_smfmac_f32_16x16x64_bf16 v[32:35], v[68:71], v[80:87], v6
    ds_read_b128 v[52:55], v1 offset:7680
    v_smfmac_f32_16x16x64_bf16 v[28:31], v[40:43], a[96:103], v6
    ds_read_b128 v[56:59], v1 offset:0
    s_waitcnt lgkmcnt(6)
    v_smfmac_f32_16x16x64_bf16 v[32:35], v[40:43], v[88:95], v6
    ds_read_b128 v[80:83], v12 offset:16384
    global_store_dwordx4 v0, v[96:99], s[16:17] offset:1024
    s_waitcnt lgkmcnt(6)
    v_smfmac_f32_16x16x64_bf16 v[28:31], v[44:47], a[104:111], v6
    ds_read_b128 v[84:87], v12 offset:17408
    s_waitcnt lgkmcnt(5)
    v_smfmac_f32_16x16x64_bf16 v[32:35], v[44:47], v[72:79], v6
    ds_read_b128 v[60:63], v1 offset:512
    s_waitcnt lgkmcnt(5)
    v_smfmac_f32_16x16x64_bf16 v[28:31], v[48:51], a[112:119], v6
    ds_read_b128 v[88:91], v12 offset:18432
    v_smfmac_f32_16x16x64_bf16 v[32:35], v[48:51], a[128:135], v6
    ds_read_b128 v[92:95], v12 offset:19456
    s_waitcnt lgkmcnt(6)
    v_smfmac_f32_16x16x64_bf16 v[28:31], v[52:55], a[120:127], v6
    ds_read_b128 v[64:67], v1 offset:1024
    v_smfmac_f32_16x16x64_bf16 v[32:35], v[52:55], a[136:143], v6
    ds_read_b128 v[72:75], v12 offset:32768
    s_waitcnt lgkmcnt(7)
    v_smfmac_f32_16x16x64_bf16 v[28:31], v[56:59], a[0:7], v6
    ds_read_b128 v[76:79], v12 offset:33792
    s_waitcnt lgkmcnt(6)
    v_smfmac_f32_16x16x64_bf16 v[32:35], v[56:59], v[80:87], v6
    ds_read_b128 v[68:71], v1 offset:1536
    s_waitcnt lgkmcnt(6)
    v_smfmac_f32_16x16x64_bf16 v[28:31], v[60:63], a[8:15], v6
    ds_read_b128 v[80:83], v12 offset:34816
    s_waitcnt lgkmcnt(5)
    v_smfmac_f32_16x16x64_bf16 v[32:35], v[60:63], v[88:95], v6
    ds_read_b128 v[84:87], v12 offset:35840
    s_waitcnt lgkmcnt(5)
    v_smfmac_f32_16x16x64_bf16 v[28:31], v[64:67], a[16:23], v6
    ds_read_b128 v[88:91], v0 offset:16384
    s_waitcnt lgkmcnt(4)
    v_smfmac_f32_16x16x64_bf16 v[32:35], v[64:67], v[72:79], v6
    ds_read_b128 v[92:95], v0 offset:20480
    s_waitcnt lgkmcnt(4)
    v_smfmac_f32_16x16x64_bf16 v[28:31], v[68:71], a[24:31], v6
    ds_read_b128 v[72:75], v0 offset:17408
    s_waitcnt lgkmcnt(3)
    v_smfmac_f32_16x16x64_bf16 v[32:35], v[68:71], v[80:87], v6
    ds_read_b128 v[76:79], v0 offset:21504
    v_smfmac_f32_16x16x64_bf16 v[36:39], v[40:43], a[240:247], v6
    ds_read_b128 v[80:83], v0 offset:18432
    v_smfmac_f32_16x16x64_bf16 v[36:39], v[44:47], a[248:255], v6
    ds_read_b128 v[84:87], v0 offset:22528
    v_cvt_pk_bf16_f32 v14, v28, v29
    v_cvt_pk_bf16_f32 v15, v30, v31
    v_cvt_pk_bf16_f32 v16, v32, v33
    v_cvt_pk_bf16_f32 v17, v34, v35
    ds_write_b128 v7, v[14:17]
    ds_read_b64_tr_b16 v[100:101], v8 offset:25600
    ds_read_b64_tr_b16 v[102:103], v8 offset:26112
    v_smfmac_f32_16x16x64_bf16 v[36:39], v[48:51], v[128:135], v6
    ds_read_b128 v[28:31], v0 offset:19456
    v_smfmac_f32_16x16x64_bf16 v[36:39], v[56:59], a[144:151], v6
    ds_read_b128 v[32:35], v0 offset:23552
    v_smfmac_f32_16x16x64_bf16 v[36:39], v[60:63], a[152:159], v6
    v_smfmac_f32_16x16x64_bf16 v[36:39], v[52:55], v[136:143], v6
    s_waitcnt lgkmcnt(4)
    s_barrier
    ds_read_b64_tr_b16 v[96:97], v8 offset:24576
    ds_read_b64_tr_b16 v[98:99], v8 offset:25088
    ds_read_b64_tr_b16 v[104:105], v8 offset:26624
    ds_read_b64_tr_b16 v[106:107], v8 offset:27136
    ds_read_b64_tr_b16 v[108:109], v8 offset:27648
    ds_read_b64_tr_b16 v[110:111], v8 offset:28160
    v_smfmac_f32_16x16x64_bf16 v[36:39], v[64:67], a[160:167], v6
    v_smfmac_f32_16x16x64_bf16 v[36:39], v[68:71], a[168:175], v6
    s_waitcnt lgkmcnt(8)
    v_mfma_f32_16x16x32_bf16 v[48:51], v[100:103], v[100:103], v[24:27]
    v_mov_b64 v[52:53], s[62:63]
    v_mov_b64 v[54:55], s[62:63]
    v_mfma_f32_16x16x32_bf16 v[40:43], v[72:75], v[100:103], 0
    v_mfma_f32_16x16x32_bf16 v[44:47], v[76:79], v[100:103], 0
    v_cvt_pk_bf16_f32 v18, v36, v37
    v_cvt_pk_bf16_f32 v19, v38, v39
    s_waitcnt lgkmcnt(4)
    v_mfma_f32_16x16x32_bf16 v[48:51], v[96:99], v[96:99], v[48:51]
    v_mov_b64 v[36:37], v[18:19]
    v_mov_b64 v[38:39], v[18:19]
    v_mfma_f32_16x16x32_bf16 v[40:43], v[88:91], v[96:99], v[40:43]
    v_mfma_f32_16x16x32_bf16 v[44:47], v[92:95], v[96:99], v[44:47]
    v_permlane32_swap_b32 v36, v38
    s_waitcnt lgkmcnt(2)
    v_mfma_f32_16x16x32_bf16 v[48:51], v[104:107], v[104:107], v[48:51]
    v_permlane32_swap_b32 v37, v39
    v_mfma_f32_16x16x32_bf16 v[40:43], v[80:83], v[104:107], v[40:43]
    v_mfma_f32_16x16x32_bf16 v[44:47], v[84:87], v[104:107], v[44:47]
    global_store_dwordx4 v0, v[16:19], s[60:61] sc1
    s_waitcnt lgkmcnt(0)
    v_mfma_f32_16x16x32_bf16 v[48:51], v[108:111], v[108:111], v[48:51]
    v_mfma_f32_16x16x32_bf16 v[40:43], v[28:31], v[108:111], v[40:43]
    v_mfma_f32_16x16x32_bf16 v[44:47], v[32:35], v[108:111], v[44:47]
    s_add_u32 s60, s60, 4096
    s_addc_u32 s61, s61, 0
    s_cmp_ge_u32 s68, 63
    s_cbranch_scc1 Ldn_33
    ds_read_b128 v[72:75], v12 offset:0
    v_max3_f32 v14, v48, v49, v50
    v_max3_f32 v14, v14, v51, v40
    v_max3_f32 v15, v41, v42, v43
    v_max3_f32 v14, v14, v44, v45
    v_max3_f32 v15, v15, v46, v47
    v_max_f32 v14, v14, v15
    v_mov_b32 v15, v14
    v_mov_b64 v[56:57], 0
    v_mov_b64 v[58:59], 0
    ds_read_b128 v[76:79], v12 offset:1024
    v_permlane32_swap_b32 v14, v15
    v_max_f32 v14, v14, v15
    v_mov_b32 v15, v14
    v_mov_b64 v[60:61], 0
    v_mov_b64 v[62:63], 0
    ds_read_b128 v[80:83], v12 offset:2048
    v_permlane16_swap_b32 v14, v15
    v_max_f32 v14, v14, v15
    v_mul_f32 v14, s69, v14
    v_pk_fma_f32 v[40:41], v[40:41], s[80:81], v[14:15] op_sel_hi:[1,1,0] neg_lo:[0,0,1] neg_hi:[0,0,1]
    v_pk_fma_f32 v[42:43], v[42:43], s[80:81], v[14:15] op_sel_hi:[1,1,0] neg_lo:[0,0,1] neg_hi:[0,0,1]
    v_pk_fma_f32 v[44:45], v[44:45], s[80:81], v[14:15] op_sel_hi:[1,1,0] neg_lo:[0,0,1] neg_hi:[0,0,1]
    v_pk_fma_f32 v[46:47], v[46:47], s[80:81], v[14:15] op_sel_hi:[1,1,0] neg_lo:[0,0,1] neg_hi:[0,0,1]
    v_exp_f32 v40, v40
    v_exp_f32 v41, v41
    v_exp_f32 v42, v42
    v_exp_f32 v43, v43
    v_exp_f32 v44, v44
    v_exp_f32 v45, v45
    v_exp_f32 v46, v46
    v_exp_f32 v47, v47
    v_pk_fma_f32 v[48:49], v[48:49], s[80:81], v[14:15] op_sel_hi:[1,1,0] neg_lo:[0,0,1] neg_hi:[0,0,1]
    v_pk_fma_f32 v[50:51], v[50:51], s[80:81], v[14:15] op_sel_hi:[1,1,0] neg_lo:[0,0,1] neg_hi:[0,0,1]
    v_cvt_pk_bf16_f32 v96, v40, v41
    v_cvt_pk_bf16_f32 v97, v42, v43
    v_cvt_pk_bf16_f32 v98, v44, v45
    v_cvt_pk_bf16_f32 v99, v46, v47
    v_exp_f32 v48, v48
    s_nop 0
    v_mfma_f32_16x16x32_bf16 v[40:43], v[52:55], v[96:99], 0
    ds_read_b128 v[84:87], v12 offset:3072
    v_exp_f32 v49, v49
    v_mfma_f32_16x16x32_bf16 v[28:31], v[120:123], v[96:99], 0
    v_exp_f32 v50, v50
    v_mfma_f32_16x16x32_bf16 v[32:35], v[124:127], v[96:99], 0
    v_exp_f32 v51, v51
    v_cvt_pk_bf16_f32 v100, v48, v49
    v_cvt_pk_bf16_f32 v101, v50, v51
    v_mov_b64 v[64:65], 0
    v_mov_b64 v[66:67], 0
    v_mfma_f32_16x16x16_bf16 v[40:43], v[52:53], v[100:101], v[40:43]
    v_mov_b64 v[68:69], 0
    v_mov_b64 v[70:71], 0
    v_mfma_f32_16x16x16_bf16 v[28:31], v[36:37], v[100:101], v[28:31]
    v_mfma_f32_16x16x16_bf16 v[32:35], v[38:39], v[100:101], v[32:35]
    v_rcp_f32 v14, v40
    s_mov_b32 exec_lo, 0xff00ff00
    s_mov_b32 exec_hi, 0xff00ff00
    s_nop 0
    v_pk_mul_f32 v[28:29], v[28:29], v[14:15] op_sel_hi:[1,0]
    v_pk_mul_f32 v[30:31], v[30:31], v[14:15] op_sel_hi:[1,0]
    v_cvt_pk_bf16_f32 v88, v28, v29
    v_cvt_pk_bf16_f32 v89, v30, v31
    v_pk_mul_f32 v[32:33], v[32:33], v[14:15] op_sel_hi:[1,0]
    v_pk_mul_f32 v[34:35], v[34:35], v[14:15] op_sel_hi:[1,0]
    v_cvt_pk_bf16_f32 v90, v32, v33
    v_cvt_pk_bf16_f32 v91, v34, v35
    ds_write_b128 v9, v[88:91]
    s_mov_b64 exec, -1
    v_mov_b32_dpp v88, v88 row_ror:8 row_mask:0xf bank_mask:0x3
    v_mov_b32_dpp v89, v89 row_ror:8 row_mask:0xf bank_mask:0x3
    v_mov_b32_dpp v90, v90 row_ror:8 row_mask:0xf bank_mask:0x3
    v_mov_b32_dpp v91, v91 row_ror:8 row_mask:0xf bank_mask:0x3
    s_waitcnt lgkmcnt(1)
    s_nop 0
    v_smfmac_f32_16x16x64_bf16 v[56:59], v[88:91], v[80:87], v6
    v_smfmac_f32_16x16x64_bf16 v[60:63], v[88:91], v[152:159], v6
    s_waitcnt vmcnt(8) lgkmcnt(0)
    s_barrier
    ds_read_b128 v[96:99], v1 offset:28672
    ds_read_b128 v[104:107], v1 offset:29696
    ds_read_b128 v[108:111], v1 offset:30208
    v_smfmac_f32_16x16x64_bf16 v[64:67], v[88:91], v[168:175], v6
    v_smfmac_f32_16x16x64_bf16 v[68:71], v[88:91], v[184:191], v6
    s_waitcnt lgkmcnt(2)
    v_smfmac_f32_16x16x64_bf16 v[56:59], v[96:99], v[72:79], v6
    v_smfmac_f32_16x16x64_bf16 v[60:63], v[96:99], v[144:151], v6
    s_waitcnt lgkmcnt(1)
    v_smfmac_f32_16x16x64_bf16 v[56:59], v[104:107], v[192:199], v6
    v_smfmac_f32_16x16x64_bf16 v[60:63], v[104:107], v[208:215], v6
    s_waitcnt lgkmcnt(0)
    v_smfmac_f32_16x16x64_bf16 v[56:59], v[108:111], v[200:207], v6
    v_smfmac_f32_16x16x64_bf16 v[60:63], v[108:111], v[216:223], v6
    v_smfmac_f32_16x16x64_bf16 v[64:67], v[96:99], v[160:167], v6
    v_smfmac_f32_16x16x64_bf16 v[68:71], v[96:99], v[176:183], v6
    v_cvt_pk_bf16_f32 v40, v56, v60
    v_smfmac_f32_16x16x64_bf16 v[64:67], v[104:107], v[224:231], v6
    v_cvt_pk_bf16_f32 v41, v57, v61
    v_smfmac_f32_16x16x64_bf16 v[68:71], v[104:107], v[240:247], v6
    v_cvt_pk_bf16_f32 v42, v58, v62
    v_smfmac_f32_16x16x64_bf16 v[64:67], v[108:111], v[232:239], v6
    v_cvt_pk_bf16_f32 v43, v59, v63
    v_smfmac_f32_16x16x64_bf16 v[68:71], v[108:111], v[248:255], v6
    global_store_dwordx4 v10, v[40:43], s[50:51]
    s_nop 6
    v_cvt_pk_bf16_f32 v44, v64, v68
    v_cvt_pk_bf16_f32 v45, v65, v69
    v_cvt_pk_bf16_f32 v46, v66, v70
    v_cvt_pk_bf16_f32 v47, v67, v71
    global_store_dwordx4 v10, v[44:47], s[54:55]
    s_waitcnt vmcnt(1)
    ds_read_b128 v[72:75], v12 offset:49152
    ds_read_b128 v[76:79], v12 offset:50176
    ds_read_b128 v[80:83], v12 offset:51200
    ds_read_b128 v[84:87], v12 offset:52224
    ds_read_b128 v[88:91], v3 offset:0
    ds_read_b128 v[92:95], v3 offset:1024
    global_load_dwordx4 v[48:51], v0, s[18:19] offset:0 sc1
    global_load_dwordx4 v[52:55], v0, s[18:19] offset:1024 sc1
    s_sleep 2
    global_load_dwordx4 v[64:67], v0, s[18:19] offset:0 sc1
    global_load_dwordx4 v[68:71], v0, s[18:19] offset:1024 sc1
    v_mov_b64 v[28:29], 0
    v_mov_b64 v[30:31], 0
    v_mov_b64 v[32:33], 0
    v_mov_b64 v[34:35], 0
    v_mov_b64 v[36:37], 0
    v_mov_b64 v[38:39], 0
    v_mov_b64 v[96:97], -1
    v_mov_b64 v[98:99], -1
    s_waitcnt vmcnt(2)
    v_mfma_f32_16x16x32_bf16 v[100:103], v[20:23], v[48:51], 0
    v_max3_u32 v14, v48, v49, v50
    v_mfma_f32_16x16x32_bf16 v[100:103], v[20:23], v[52:55], v[100:103]
    v_max3_u32 v15, v51, v52, v53
    v_max3_u32 v14, v14, v54, v55
    v_max_u32 v14, v14, v15
    v_cmp_eq_u32 vcc, -1, v14
    s_cbranch_vccnz LlB_42
LokB_43:
    s_nop 2
    v_add_f32_dpp v100, v100, v100 row_ror:4 row_mask:0xf bank_mask:0xf
    v_add_f32_dpp v101, v101, v101 row_ror:4 row_mask:0xf bank_mask:0xf
    v_add_f32_dpp v102, v102, v102 row_ror:4 row_mask:0xf bank_mask:0xf
    v_add_f32_dpp v103, v103, v103 row_ror:4 row_mask:0xf bank_mask:0xf
    v_add_f32_dpp v100, v100, v100 row_ror:8 row_mask:0xf bank_mask:0xf
    v_add_f32_dpp v101, v101, v101 row_ror:8 row_mask:0xf bank_mask:0xf
    v_add_f32_dpp v102, v102, v102 row_ror:8 row_mask:0xf bank_mask:0xf
    v_add_f32_dpp v103, v103, v103 row_ror:8 row_mask:0xf bank_mask:0xf
    v_cvt_pk_bf16_f32 v100, v100, v101
    v_cvt_pk_bf16_f32 v101, v102, v103
    v_cndmask_b32 v100, v100, v101, s[70:71]
    s_mov_b64 exec, 0x00ff00ff
    global_store_dword v11, v100, s[44:45]
    s_mov_b64 exec, -1
    s_add_u32 s68, s68, 1
    s_add_u32 s64, s68, 2
    s_cmp_lt_u32 s64, s76
    s_cbranch_scc1 Lrec_32
Lrs_44:
Lrdy_45:
    global_load_dword v5, v4, s[42:43] sc1
    s_add_u32 s77, s77, 1
    s_cmp_gt_u32 s77, 0x100000
    s_cbranch_scc1 Lrec_32
    s_waitcnt vmcnt(0)
    v_cmp_le_u32 s[74:75], 32, v5
    s_nop 0
    s_ff0_i32_b64 s76, s[74:75]
    s_add_u32 s64, s68, 2
    s_cmp_lt_u32 s64, s76
    s_cbranch_scc0 Lrdy_45
    s_branch Lrec_32
Ldn_33:
    s_waitcnt vmcnt(0)
    s_mov_b64 exec, 1
    global_store_dword v0, v6, s[36:37] sc1
    s_mov_b64 exec, -1
    s_add_u32 s36, s36, 4096
    s_addc_u32 s37, s37, 0
    s_endpgm
LslA_36:
    s_mov_b64 exec, vcc
    global_load_dwordx4 v[104:107], v2, s[44:45] offset:0 sc1
    global_load_dwordx4 v[108:111], v2, s[44:45] offset:1024 sc1
    s_mov_b64 exec, -1
    s_waitcnt vmcnt(2)
    ds_write_b128 v2, v[64:67] offset:0
    ds_write_b128 v2, v[68:71] offset:1024
    v_max3_u32 v14, v64, v65, v66
    v_max3_u32 v15, v67, v68, v69
    v_max3_u32 v14, v14, v70, v71
    v_max_u32 v14, v14, v15
    v_cmp_eq_u32 vcc, -1, v14
    s_cbranch_vccz LokA_35
    s_mov_b64 exec, vcc
    global_load_dwordx4 v[64:67], v2, s[44:45] offset:0 sc1
    global_load_dwordx4 v[68:71], v2, s[44:45] offset:1024 sc1
    s_mov_b64 exec, -1
    s_waitcnt vmcnt(2)
    ds_write_b128 v2, v[104:107] offset:0
    ds_write_b128 v2, v[108:111] offset:1024
    v_max3_u32 v14, v104, v105, v106
    v_max3_u32 v15, v107, v108, v109
    v_max3_u32 v14, v14, v110, v111
    v_max_u32 v14, v14, v15
    v_cmp_eq_u32 vcc, -1, v14
    s_cbranch_vccz LokA_35
    s_add_u32 s77, s77, 1
    s_cmp_lt_u32 s77, 0x80000
    s_cbranch_scc1 LslA_36
    s_branch LokA_35
LlB_37:
    s_mov_b64 exec, vcc
    global_load_dwordx4 v[48:51], v0, s[16:17] offset:0 sc1
    global_load_dwordx4 v[52:55], v0, s[16:17] offset:1024 sc1
    s_mov_b64 exec, -1
    s_waitcnt vmcnt(2)
    v_mfma_f32_16x16x32_bf16 v[100:103], v[20:23], v[64:67], 0
    v_max3_u32 v14, v64, v65, v66
    v_mfma_f32_16x16x32_bf16 v[100:103], v[20:23], v[68:71], v[100:103]
    v_max3_u32 v15, v67, v68, v69
    v_max3_u32 v14, v14, v70, v71
    v_max_u32 v14, v14, v15
    v_cmp_eq_u32 vcc, -1, v14
    s_cbranch_vccz LokB_38
    s_mov_b64 exec, vcc
    global_load_dwordx4 v[64:67], v0, s[16:17] offset:0 sc1
    global_load_dwordx4 v[68:71], v0, s[16:17] offset:1024 sc1
    s_mov_b64 exec, -1
    s_waitcnt vmcnt(2)
    v_mfma_f32_16x16x32_bf16 v[100:103], v[20:23], v[48:51], 0
    v_max3_u32 v14, v48, v49, v50
    v_mfma_f32_16x16x32_bf16 v[100:103], v[20:23], v[52:55], v[100:103]
    v_max3_u32 v15, v51, v52, v53
    v_max3_u32 v14, v14, v54, v55
    v_max_u32 v14, v14, v15
    v_cmp_eq_u32 vcc, -1, v14
    s_cbranch_vccz LokB_38
    s_add_u32 s77, s77, 1
    s_cmp_lt_u32 s77, 0x80000
    s_cbranch_scc1 LlB_37
    s_branch LokB_38
LslA_41:
    s_mov_b64 exec, vcc
    global_load_dwordx4 v[104:107], v2, s[46:47] offset:0 sc1
    global_load_dwordx4 v[108:111], v2, s[46:47] offset:1024 sc1
    s_mov_b64 exec, -1
    s_waitcnt vmcnt(2)
    ds_write_b128 v2, v[64:67] offset:0
    ds_write_b128 v2, v[68:71] offset:1024
    v_max3_u32 v14, v64, v65, v66
    v_max3_u32 v15, v67, v68, v69
    v_max3_u32 v14, v14, v70, v71
    v_max_u32 v14, v14, v15
    v_cmp_eq_u32 vcc, -1, v14
    s_cbranch_vccz LokA_40
    s_mov_b64 exec, vcc
    global_load_dwordx4 v[64:67], v2, s[46:47] offset:0 sc1
    global_load_dwordx4 v[68:71], v2, s[46:47] offset:1024 sc1
    s_mov_b64 exec, -1
    s_waitcnt vmcnt(2)
    ds_write_b128 v2, v[104:107] offset:0
    ds_write_b128 v2, v[108:111] offset:1024
    v_max3_u32 v14, v104, v105, v106
    v_max3_u32 v15, v107, v108, v109
    v_max3_u32 v14, v14, v110, v111
    v_max_u32 v14, v14, v15
    v_cmp_eq_u32 vcc, -1, v14
    s_cbranch_vccz LokA_40
    s_add_u32 s77, s77, 1
    s_cmp_lt_u32 s77, 0x80000
    s_cbranch_scc1 LslA_41
    s_branch LokA_40
LlB_42:
    s_mov_b64 exec, vcc
    global_load_dwordx4 v[48:51], v0, s[18:19] offset:0 sc1
    global_load_dwordx4 v[52:55], v0, s[18:19] offset:1024 sc1
    s_mov_b64 exec, -1
    s_waitcnt vmcnt(2)
    v_mfma_f32_16x16x32_bf16 v[100:103], v[20:23], v[64:67], 0
    v_max3_u32 v14, v64, v65, v66
    v_mfma_f32_16x16x32_bf16 v[100:103], v[20:23], v[68:71], v[100:103]
    v_max3_u32 v15, v67, v68, v69
    v_max3_u32 v14, v14, v70, v71
    v_max_u32 v14, v14, v15
    v_cmp_eq_u32 vcc, -1, v14
    s_cbranch_vccz LokB_43
    s_mov_b64 exec, vcc
    global_load_dwordx4 v[64:67], v0, s[18:19] offset:0 sc1
    global_load_dwordx4 v[68:71], v0, s[18:19] offset:1024 sc1
    s_mov_b64 exec, -1
    s_waitcnt vmcnt(2)
    v_mfma_f32_16x16x32_bf16 v[100:103], v[20:23], v[48:51], 0
    v_max3_u32 v14, v48, v49, v50
    v_mfma_f32_16x16x32_bf16 v[100:103], v[20:23], v[52:55], v[100:103]
    v_max3_u32 v15, v51, v52, v53
    v_max3_u32 v14, v14, v54, v55
    v_max_u32 v14, v14, v15
    v_cmp_eq_u32 vcc, -1, v14
    s_cbranch_vccz LokB_43
    s_add_u32 s77, s77, 1
    s_cmp_lt_u32 s77, 0x80000
    s_cbranch_scc1 LlB_42
    s_branch LokB_43
Lrw_16:
    ds_read_b128 v[72:75], v3 offset:16384
    ds_read_b128 v[76:79], v3 offset:17408
    ds_read_b128 v[80:83], v3 offset:18432
    ds_read_b128 v[84:87], v3 offset:19456
    ds_read_b128 v[88:91], v3 offset:32768
    ds_read_b128 v[92:95], v3 offset:33792
    v_mov_b64 v[28:29], 0
    v_mov_b64 v[30:31], 0
    v_mov_b64 v[32:33], 0
    v_mov_b64 v[34:35], 0
    v_mov_b64 v[36:37], 0
    v_mov_b64 v[38:39], 0
    v_mov_b64 v[96:97], -1
    v_mov_b64 v[98:99], -1
Lrec_46:
    s_waitcnt vmcnt(0)
    global_load_dwordx4 v[104:107], v2, s[44:45] offset:0 sc1
    global_load_dwordx4 v[108:111], v2, s[44:45] offset:1024 sc1
    s_sleep 2
    global_load_dwordx4 v[64:67], v2, s[44:45] offset:0 sc1
    global_load_dwordx4 v[68:71], v2, s[44:45] offset:1024 sc1
    s_waitcnt vmcnt(2)
    ds_write_b128 v2, v[104:107] offset:0
    ds_write_b128 v2, v[108:111] offset:1024
    v_max3_u32 v14, v104, v105, v106
    v_max3_u32 v15, v107, v108, v109
    v_max3_u32 v14, v14, v110, v111
    v_max_u32 v14, v14, v15
    v_cmp_eq_u32 vcc, -1, v14
    s_cbranch_vccnz LslA_50
LokA_49:
    ds_read_b128 v[40:43], v1 offset:4096
    ds_read_b128 v[44:47], v1 offset:4608
    ds_read_b128 v[48:51], v1 offset:5120
    ds_read_b128 v[52:55], v1 offset:5632
    s_waitcnt lgkmcnt(4)
    s_barrier
    s_waitcnt lgkmcnt(3)
    v_smfmac_f32_16x16x64_bf16 v[28:31], v[40:43], a[64:71], v6
    ds_read_b128 v[56:59], v1 offset:6144
    v_smfmac_f32_16x16x64_bf16 v[36:39], v[40:43], a[208:215], v6
    ds_read_b128 v[60:63], v1 offset:6656
    v_smfmac_f32_16x16x64_bf16 v[32:35], v[40:43], v[72:79], v6
    ds_read_b128 v[72:75], v3 offset:34816
    s_waitcnt lgkmcnt(5)
    v_smfmac_f32_16x16x64_bf16 v[28:31], v[44:47], a[72:79], v6
    ds_read_b128 v[76:79], v3 offset:35840
    v_smfmac_f32_16x16x64_bf16 v[36:39], v[44:47], a[216:223], v6
    ds_read_b128 v[40:43], v1 offset:0
    v_smfmac_f32_16x16x64_bf16 v[32:35], v[44:47], v[80:87], v6
    ds_read_b128 v[80:83], v3 offset:49152
    s_waitcnt vmcnt(0)
    s_waitcnt lgkmcnt(7)
    v_smfmac_f32_16x16x64_bf16 v[28:31], v[48:51], a[80:87], v6
    s_mov_b64 exec, 0x00ff00ff
    global_store_dword v11, v96, s[46:47]
    s_mov_b64 exec, -1
    v_smfmac_f32_16x16x64_bf16 v[36:39], v[48:51], a[224:231], v6
    ds_read_b128 v[84:87], v3 offset:50176
    s_add_u32 m0, s78, 8192
    global_load_dwordx4 v[120:123], v0, s[58:59] sc1
    v_smfmac_f32_16x16x64_bf16 v[32:35], v[48:51], v[88:95], v6
    ds_read_b128 v[88:91], v3 offset:51200
    global_load_lds_dwordx4 v0, s[56:57] sc1
    s_waitcnt lgkmcnt(8)
    v_smfmac_f32_16x16x64_bf16 v[28:31], v[52:55], a[88:95], v6
    ds_read_b128 v[92:95], v3 offset:52224
    global_load_lds_dwordx4 v0, s[56:57] offset:1024 sc1
    v_smfmac_f32_16x16x64_bf16 v[36:39], v[52:55], a[232:239], v6
    ds_read_b128 v[64:67], v1 offset:7168
    global_load_dwordx4 v[124:127], v0, s[58:59] offset:1024 sc1
    s_waitcnt lgkmcnt(6)
    v_smfmac_f32_16x16x64_bf16 v[32:35], v[52:55], v[72:79], v6
    ds_read_b128 v[68:71], v1 offset:7680
    s_add_u32 s56, s56, 8192
    s_addc_u32 s57, s57, 0
    v_smfmac_f32_16x16x64_bf16 v[28:31], v[56:59], a[96:103], v6
    ds_read_b128 v[72:75], v12 offset:16384
    s_add_u32 s58, s58, 8192
    s_addc_u32 s59, s59, 0
    v_smfmac_f32_16x16x64_bf16 v[36:39], v[56:59], a[240:247], v6
    s_mov_b64 exec, 1
    global_store_dword v0, v6, s[36:37] sc1
    s_mov_b64 exec, -1
    s_waitcnt lgkmcnt(5)
    v_smfmac_f32_16x16x64_bf16 v[32:35], v[56:59], v[80:87], v6
    ds_read_b128 v[76:79], v12 offset:17408
    s_add_u32 s36, s36, 4096
    s_addc_u32 s37, s37, 0
    v_smfmac_f32_16x16x64_bf16 v[28:31], v[60:63], a[104:111], v6
    ds_read_b128 v[44:47], v1 offset:512
    v_smfmac_f32_16x16x64_bf16 v[36:39], v[60:63], a[248:255], v6
    ds_read_b128 v[80:83], v12 offset:18432
    s_waitcnt lgkmcnt(6)
    v_smfmac_f32_16x16x64_bf16 v[32:35], v[60:63], v[88:95], v6
    ds_read_b128 v[84:87], v12 offset:19456
    s_waitcnt lgkmcnt(6)
    v_smfmac_f32_16x16x64_bf16 v[28:31], v[64:67], a[112:119], v6
    ds_read_b128 v[48:51], v1 offset:1024
    v_smfmac_f32_16x16x64_bf16 v[36:39], v[64:67], v[128:135], v6
    ds_read_b128 v[88:91], v12 offset:32768
    global_store_dwordx4 v0, v[96:99], s[18:19]
    v_smfmac_f32_16x16x64_bf16 v[32:35], v[64:67], a[128:135], v6
    ds_read_b128 v[92:95], v12 offset:33792
    s_waitcnt lgkmcnt(8)
    v_smfmac_f32_16x16x64_bf16 v[28:31], v[68:71], a[120:127], v6
    ds_read_b128 v[52:55], v1 offset:1536
    v_smfmac_f32_16x16x64_bf16 v[36:39], v[68:71], v[136:143], v6
    ds_read_b128 v[56:59], v1 offset:2048
    v_smfmac_f32_16x16x64_bf16 v[32:35], v[68:71], a[136:143], v6
    ds_read_b128 v[60:63], v1 offset:2560
    v_smfmac_f32_16x16x64_bf16 v[28:31], v[40:43], a[0:7], v6
    ds_read_b128 v[64:67], v1 offset:3072
    s_waitcnt lgkmcnt(10)
    v_smfmac_f32_16x16x64_bf16 v[32:35], v[40:43], v[72:79], v6
    ds_read_b128 v[72:75], v12 offset:34816
    s_waitcnt lgkmcnt(10)
    v_smfmac_f32_16x16x64_bf16 v[28:31], v[44:47], a[8:15], v6
    ds_read_b128 v[76:79], v12 offset:35840
    s_waitcnt lgkmcnt(9)
    v_smfmac_f32_16x16x64_bf16 v[32:35], v[44:47], v[80:87], v6
    ds_read_b128 v[80:83], v12 offset:49152
    global_store_dwordx4 v0, v[96:99], s[18:19] offset:1024
    s_waitcnt lgkmcnt(9)
    v_smfmac_f32_16x16x64_bf16 v[28:31], v[48:51], a[16:23], v6
    ds_read_b128 v[84:87], v12 offset:50176
    s_waitcnt lgkmcnt(8)
    v_smfmac_f32_16x16x64_bf16 v[32:35], v[48:51], v[88:95], v6
    ds_read_b128 v[88:91], v12 offset:51200
    s_waitcnt lgkmcnt(8)
    v_smfmac_f32_16x16x64_bf16 v[28:31], v[52:55], a[24:31], v6
    ds_read_b128 v[92:95], v12 offset:52224
    s_waitcnt lgkmcnt(4)
    v_smfmac_f32_16x16x64_bf16 v[32:35], v[52:55], v[72:79], v6
    ds_read_b128 v[72:75], v3 offset:0
    v_smfmac_f32_16x16x64_bf16 v[28:31], v[56:59], a[32:39], v6
    ds_read_b128 v[76:79], v3 offset:1024
    s_waitcnt lgkmcnt(4)
    v_smfmac_f32_16x16x64_bf16 v[32:35], v[56:59], v[80:87], v6
    ds_read_b128 v[68:71], v1 offset:3584
    v_smfmac_f32_16x16x64_bf16 v[28:31], v[60:63], a[40:47], v6
    ds_read_b128 v[80:83], v3 offset:2048
    s_waitcnt lgkmcnt(4)
    v_smfmac_f32_16x16x64_bf16 v[32:35], v[60:63], v[88:95], v6
    ds_read_b128 v[84:87], v3 offset:3072
    v_smfmac_f32_16x16x64_bf16 v[28:31], v[64:67], a[48:55], v6
    ds_read_b128 v[88:91], v0 offset:8192
    s_waitcnt lgkmcnt(4)
    v_smfmac_f32_16x16x64_bf16 v[32:35], v[64:67], v[72:79], v6
    ds_read_b128 v[92:95], v0 offset:12288
    s_waitcnt lgkmcnt(4)
    v_smfmac_f32_16x16x64_bf16 v[28:31], v[68:71], a[56:63], v6
    ds_read_b128 v[72:75], v0 offset:9216
    s_waitcnt lgkmcnt(3)
    v_smfmac_f32_16x16x64_bf16 v[32:35], v[68:71], v[80:87], v6
    ds_read_b128 v[76:79], v0 offset:13312
    v_smfmac_f32_16x16x64_bf16 v[36:39], v[40:43], a[144:151], v6
    ds_read_b128 v[80:83], v0 offset:10240
    v_smfmac_f32_16x16x64_bf16 v[36:39], v[44:47], a[152:159], v6
    ds_read_b128 v[84:87], v0 offset:14336
    v_cvt_pk_bf16_f32 v14, v28, v29
    v_cvt_pk_bf16_f32 v15, v30, v31
    v_cvt_pk_bf16_f32 v16, v32, v33
    v_cvt_pk_bf16_f32 v17, v34, v35
    ds_write_b128 v7, v[14:17]
    ds_read_b64_tr_b16 v[104:105], v8 offset:26624
    ds_read_b64_tr_b16 v[106:107], v8 offset:27136
    v_smfmac_f32_16x16x64_bf16 v[36:39], v[48:51], a[160:167], v6
    ds_read_b128 v[28:31], v0 offset:11264
    v_smfmac_f32_16x16x64_bf16 v[36:39], v[56:59], a[176:183], v6
    ds_read_b128 v[32:35], v0 offset:15360
    v_smfmac_f32_16x16x64_bf16 v[36:39], v[60:63], a[184:191], v6
    v_smfmac_f32_16x16x64_bf16 v[36:39], v[52:55], a[168:175], v6
    s_waitcnt lgkmcnt(4)
    s_barrier
    ds_read_b64_tr_b16 v[96:97], v8 offset:24576
    ds_read_b64_tr_b16 v[98:99], v8 offset:25088
    ds_read_b64_tr_b16 v[100:101], v8 offset:25600
    ds_read_b64_tr_b16 v[102:103], v8 offset:26112
    ds_read_b64_tr_b16 v[108:109], v8 offset:27648
    ds_read_b64_tr_b16 v[110:111], v8 offset:28160
    v_smfmac_f32_16x16x64_bf16 v[36:39], v[64:67], a[192:199], v6
    v_smfmac_f32_16x16x64_bf16 v[36:39], v[68:71], a[200:207], v6
    s_waitcnt lgkmcnt(8)
    v_mfma_f32_16x16x32_bf16 v[48:51], v[104:107], v[104:107], v[24:27]
    v_mov_b64 v[52:53], s[62:63]
    v_mov_b64 v[54:55], s[62:63]
    v_mfma_f32_16x16x32_bf16 v[40:43], v[80:83], v[104:107], 0
    v_mfma_f32_16x16x32_bf16 v[44:47], v[84:87], v[104:107], 0
    v_cvt_pk_bf16_f32 v18, v36, v37
    v_cvt_pk_bf16_f32 v19, v38, v39
    s_waitcnt lgkmcnt(4)
    v_mfma_f32_16x16x32_bf16 v[48:51], v[96:99], v[96:99], v[48:51]
    v_mov_b64 v[36:37], v[18:19]
    v_mov_b64 v[38:39], v[18:19]
    v_mfma_f32_16x16x32_bf16 v[40:43], v[88:91], v[96:99], v[40:43]
    v_mfma_f32_16x16x32_bf16 v[44:47], v[92:95], v[96:99], v[44:47]
    v_permlane32_swap_b32 v36, v38
    s_waitcnt lgkmcnt(2)
    v_mfma_f32_16x16x32_bf16 v[48:51], v[100:103], v[100:103], v[48:51]
    v_permlane32_swap_b32 v37, v39
    v_mfma_f32_16x16x32_bf16 v[40:43], v[72:75], v[100:103], v[40:43]
    v_mfma_f32_16x16x32_bf16 v[44:47], v[76:79], v[100:103], v[44:47]
    s_waitcnt lgkmcnt(0)
    v_mfma_f32_16x16x32_bf16 v[48:51], v[108:111], v[108:111], v[48:51]
    global_store_dwordx4 v0, v[16:19], s[60:61] sc1
    v_mfma_f32_16x16x32_bf16 v[40:43], v[28:31], v[108:111], v[40:43]
    v_mfma_f32_16x16x32_bf16 v[44:47], v[32:35], v[108:111], v[44:47]
    s_add_u32 s60, s60, 4096
    s_addc_u32 s61, s61, 0
    ds_read_b128 v[72:75], v12 offset:0
    v_max3_f32 v14, v48, v49, v50
    v_max3_f32 v14, v14, v51, v40
    v_max3_f32 v15, v41, v42, v43
    s_nop 1
    v_max3_f32 v14, v14, v44, v45
    v_max3_f32 v15, v15, v46, v47
    v_max_f32 v14, v14, v15
    v_mov_b32 v15, v14
    v_mov_b64 v[56:57], 0
    v_mov_b64 v[58:59], 0
    ds_read_b128 v[76:79], v12 offset:1024
    v_permlane32_swap_b32 v14, v15
    v_max_f32 v14, v14, v15
    v_mov_b32 v15, v14
    v_mov_b64 v[60:61], 0
    v_mov_b64 v[62:63], 0
    ds_read_b128 v[80:83], v12 offset:2048
    v_permlane16_swap_b32 v14, v15
    v_max_f32 v14, v14, v15
    v_mul_f32 v14, s69, v14
    v_pk_fma_f32 v[40:41], v[40:41], s[80:81], v[14:15] op_sel_hi:[1,1,0] neg_lo:[0,0,1] neg_hi:[0,0,1]
    v_pk_fma_f32 v[42:43], v[42:43], s[80:81], v[14:15] op_sel_hi:[1,1,0] neg_lo:[0,0,1] neg_hi:[0,0,1]
    v_pk_fma_f32 v[44:45], v[44:45], s[80:81], v[14:15] op_sel_hi:[1,1,0] neg_lo:[0,0,1] neg_hi:[0,0,1]
    v_pk_fma_f32 v[46:47], v[46:47], s[80:81], v[14:15] op_sel_hi:[1,1,0] neg_lo:[0,0,1] neg_hi:[0,0,1]
    v_exp_f32 v40, v40
    v_exp_f32 v41, v41
    v_exp_f32 v42, v42
    v_exp_f32 v43, v43
    v_exp_f32 v44, v44
    v_exp_f32 v45, v45
    v_exp_f32 v46, v46
    v_exp_f32 v47, v47
    v_pk_fma_f32 v[48:49], v[48:49], s[80:81], v[14:15] op_sel_hi:[1,1,0] neg_lo:[0,0,1] neg_hi:[0,0,1]
    v_pk_fma_f32 v[50:51], v[50:51], s[80:81], v[14:15] op_sel_hi:[1,1,0] neg_lo:[0,0,1] neg_hi:[0,0,1]
    v_cvt_pk_bf16_f32 v96, v40, v41
    v_cvt_pk_bf16_f32 v97, v42, v43
    v_cvt_pk_bf16_f32 v98, v44, v45
    v_cvt_pk_bf16_f32 v99, v46, v47
    v_exp_f32 v48, v48
    s_nop 0
    v_mfma_f32_16x16x32_bf16 v[40:43], v[52:55], v[96:99], 0
    ds_read_b128 v[84:87], v12 offset:3072
    v_exp_f32 v49, v49
    v_mfma_f32_16x16x32_bf16 v[28:31], v[112:115], v[96:99], 0
    v_exp_f32 v50, v50
    v_mfma_f32_16x16x32_bf16 v[32:35], v[116:119], v[96:99], 0
    v_exp_f32 v51, v51
    v_cvt_pk_bf16_f32 v100, v48, v49
    v_cvt_pk_bf16_f32 v101, v50, v51
    v_mov_b64 v[64:65], 0
    v_mov_b64 v[66:67], 0
    v_mfma_f32_16x16x16_bf16 v[40:43], v[52:53], v[100:101], v[40:43]
    v_mov_b64 v[68:69], 0
    v_mov_b64 v[70:71], 0
    v_mfma_f32_16x16x16_bf16 v[28:31], v[36:37], v[100:101], v[28:31]
    v_mfma_f32_16x16x16_bf16 v[32:35], v[38:39], v[100:101], v[32:35]
    v_rcp_f32 v14, v40
    s_mov_b32 exec_lo, 0xff00ff00
    s_mov_b32 exec_hi, 0xff00ff00
    s_nop 0
    v_pk_mul_f32 v[28:29], v[28:29], v[14:15] op_sel_hi:[1,0]
    v_pk_mul_f32 v[30:31], v[30:31], v[14:15] op_sel_hi:[1,0]
    v_cvt_pk_bf16_f32 v88, v28, v29
    v_cvt_pk_bf16_f32 v89, v30, v31
    v_pk_mul_f32 v[32:33], v[32:33], v[14:15] op_sel_hi:[1,0]
    v_pk_mul_f32 v[34:35], v[34:35], v[14:15] op_sel_hi:[1,0]
    v_cvt_pk_bf16_f32 v90, v32, v33
    v_cvt_pk_bf16_f32 v91, v34, v35
    ds_write_b128 v9, v[88:91]
    s_mov_b64 exec, -1
    v_mov_b32_dpp v88, v88 row_ror:8 row_mask:0xf bank_mask:0x3
    v_mov_b32_dpp v89, v89 row_ror:8 row_mask:0xf bank_mask:0x3
    v_mov_b32_dpp v90, v90 row_ror:8 row_mask:0xf bank_mask:0x3
    v_mov_b32_dpp v91, v91 row_ror:8 row_mask:0xf bank_mask:0x3
    s_nop 1
    v_smfmac_f32_16x16x64_bf16 v[56:59], v[88:91], v[192:199], v6
    v_smfmac_f32_16x16x64_bf16 v[60:63], v[88:91], v[208:215], v6
    s_waitcnt vmcnt(8) lgkmcnt(0)
    s_barrier
    ds_read_b128 v[96:99], v1 offset:28672
    ds_read_b128 v[100:103], v1 offset:29184
    ds_read_b128 v[108:111], v1 offset:30208
    v_smfmac_f32_16x16x64_bf16 v[64:67], v[88:91], v[224:231], v6
    v_smfmac_f32_16x16x64_bf16 v[68:71], v[88:91], v[240:247], v6
    s_waitcnt lgkmcnt(2)
    v_smfmac_f32_16x16x64_bf16 v[56:59], v[96:99], v[72:79], v6
    v_smfmac_f32_16x16x64_bf16 v[60:63], v[96:99], v[144:151], v6
    s_waitcnt lgkmcnt(1)
    v_smfmac_f32_16x16x64_bf16 v[56:59], v[100:103], v[80:87], v6
    v_smfmac_f32_16x16x64_bf16 v[60:63], v[100:103], v[152:159], v6
    s_waitcnt lgkmcnt(0)
    v_smfmac_f32_16x16x64_bf16 v[56:59], v[108:111], v[200:207], v6
    v_smfmac_f32_16x16x64_bf16 v[60:63], v[108:111], v[216:223], v6
    v_smfmac_f32_16x16x64_bf16 v[64:67], v[96:99], v[160:167], v6
    v_smfmac_f32_16x16x64_bf16 v[68:71], v[96:99], v[176:183], v6
    v_cvt_pk_bf16_f32 v40, v56, v60
    v_smfmac_f32_16x16x64_bf16 v[64:67], v[100:103], v[168:175], v6
    v_cvt_pk_bf16_f32 v41, v57, v61
    v_smfmac_f32_16x16x64_bf16 v[68:71], v[100:103], v[184:191], v6
    v_cvt_pk_bf16_f32 v42, v58, v62
    v_smfmac_f32_16x16x64_bf16 v[64:67], v[108:111], v[232:239], v6
    v_cvt_pk_bf16_f32 v43, v59, v63
    v_smfmac_f32_16x16x64_bf16 v[68:71], v[108:111], v[248:255], v6
    global_store_dwordx4 v10, v[40:43], s[48:49]
    s_nop 6
    v_cvt_pk_bf16_f32 v44, v64, v68
    v_cvt_pk_bf16_f32 v45, v65, v69
    v_cvt_pk_bf16_f32 v46, v66, v70
    v_cvt_pk_bf16_f32 v47, v67, v71
    global_store_dwordx4 v10, v[44:47], s[52:53]
    s_waitcnt vmcnt(1)
    ds_read_b128 v[72:75], v3 offset:16384
    ds_read_b128 v[76:79], v3 offset:17408
    ds_read_b128 v[80:83], v3 offset:18432
    ds_read_b128 v[84:87], v3 offset:19456
    ds_read_b128 v[88:91], v3 offset:32768
    ds_read_b128 v[92:95], v3 offset:33792
    global_load_dwordx4 v[48:51], v0, s[16:17] offset:0 sc1
    global_load_dwordx4 v[52:55], v0, s[16:17] offset:1024 sc1
    s_sleep 2
    global_load_dwordx4 v[64:67], v0, s[16:17] offset:0 sc1
    global_load_dwordx4 v[68:71], v0, s[16:17] offset:1024 sc1
    v_mov_b64 v[28:29], 0
    v_mov_b64 v[30:31], 0
    v_mov_b64 v[32:33], 0
    v_mov_b64 v[34:35], 0
    v_mov_b64 v[36:37], 0
    v_mov_b64 v[38:39], 0
    v_mov_b64 v[96:97], -1
    v_mov_b64 v[98:99], -1
    s_waitcnt vmcnt(2)
    v_mfma_f32_16x16x32_bf16 v[100:103], v[20:23], v[48:51], 0
    v_max3_u32 v14, v48, v49, v50
    v_mfma_f32_16x16x32_bf16 v[100:103], v[20:23], v[52:55], v[100:103]
    v_max3_u32 v15, v51, v52, v53
    v_max3_u32 v14, v14, v54, v55
    v_max_u32 v14, v14, v15
    v_cmp_eq_u32 vcc, -1, v14
    s_cbranch_vccnz LlB_51
LokB_52:
    s_nop 2
    v_add_f32_dpp v100, v100, v100 row_ror:4 row_mask:0xf bank_mask:0xf
    v_add_f32_dpp v101, v101, v101 row_ror:4 row_mask:0xf bank_mask:0xf
    v_add_f32_dpp v102, v102, v102 row_ror:4 row_mask:0xf bank_mask:0xf
    v_add_f32_dpp v103, v103, v103 row_ror:4 row_mask:0xf bank_mask:0xf
    v_add_f32_dpp v100, v100, v100 row_ror:8 row_mask:0xf bank_mask:0xf
    v_add_f32_dpp v101, v101, v101 row_ror:8 row_mask:0xf bank_mask:0xf
    v_add_f32_dpp v102, v102, v102 row_ror:8 row_mask:0xf bank_mask:0xf
    v_add_f32_dpp v103, v103, v103 row_ror:8 row_mask:0xf bank_mask:0xf
    v_cvt_pk_bf16_f32 v100, v100, v101
    v_cvt_pk_bf16_f32 v101, v102, v103
    v_cndmask_b32 v100, v100, v101, s[70:71]
    s_mov_b64 exec, 0x00ff00ff
    global_store_dword v11, v100, s[46:47]
    s_mov_b64 exec, -1
    s_add_u32 s68, s68, 1
    s_waitcnt vmcnt(0)
    global_load_dwordx4 v[104:107], v2, s[46:47] offset:0 sc1
    global_load_dwordx4 v[108:111], v2, s[46:47] offset:1024 sc1
    s_sleep 2
    global_load_dwordx4 v[64:67], v2, s[46:47] offset:0 sc1
    global_load_dwordx4 v[68:71], v2, s[46:47] offset:1024 sc1
    s_waitcnt vmcnt(2)
    ds_write_b128 v2, v[104:107] offset:0
    ds_write_b128 v2, v[108:111] offset:1024
    v_max3_u32 v14, v104, v105, v106
    v_max3_u32 v15, v107, v108, v109
    v_max3_u32 v14, v14, v110, v111
    v_max_u32 v14, v14, v15
    v_cmp_eq_u32 vcc, -1, v14
    s_cbranch_vccnz LslA_55
LokA_54:
    ds_read_b128 v[40:43], v1 offset:4096
    ds_read_b128 v[44:47], v1 offset:4608
    ds_read_b128 v[48:51], v1 offset:5120
    ds_read_b128 v[52:55], v1 offset:5632
    s_waitcnt lgkmcnt(4)
    s_barrier
    s_waitcnt lgkmcnt(3)
    v_smfmac_f32_16x16x64_bf16 v[28:31], v[40:43], a[64:71], v6
    ds_read_b128 v[56:59], v1 offset:6144
    v_smfmac_f32_16x16x64_bf16 v[36:39], v[40:43], a[208:215], v6
    ds_read_b128 v[60:63], v1 offset:6656
    v_smfmac_f32_16x16x64_bf16 v[32:35], v[40:43], v[72:79], v6
    ds_read_b128 v[72:75], v3 offset:34816
    s_waitcnt lgkmcnt(5)
    v_smfmac_f32_16x16x64_bf16 v[28:31], v[44:47], a[72:79], v6
    ds_read_b128 v[76:79], v3 offset:35840
    v_smfmac_f32_16x16x64_bf16 v[36:39], v[44:47], a[216:223], v6
    ds_read_b128 v[40:43], v1 offset:0
    v_smfmac_f32_16x16x64_bf16 v[32:35], v[44:47], v[80:87], v6
    ds_read_b128 v[80:83], v3 offset:49152
    s_waitcnt vmcnt(0)
    s_waitcnt lgkmcnt(7)
    v_smfmac_f32_16x16x64_bf16 v[28:31], v[48:51], a[80:87], v6
    s_mov_b64 exec, 0x00ff00ff
    global_store_dword v11, v96, s[44:45]
    s_mov_b64 exec, -1
    v_smfmac_f32_16x16x64_bf16 v[36:39], v[48:51], a[224:231], v6
    ds_read_b128 v[84:87], v3 offset:50176
    s_add_u32 m0, s78, 0
    global_load_dwordx4 v[112:115], v0, s[58:59] sc1
    v_smfmac_f32_16x16x64_bf16 v[32:35], v[48:51], v[88:95], v6
    ds_read_b128 v[88:91], v3 offset:51200
    global_load_lds_dwordx4 v0, s[56:57] sc1
    s_waitcnt lgkmcnt(8)
    v_smfmac_f32_16x16x64_bf16 v[28:31], v[52:55], a[88:95], v6
    ds_read_b128 v[92:95], v3 offset:52224
    global_load_lds_dwordx4 v0, s[56:57] offset:1024 sc1
    v_smfmac_f32_16x16x64_bf16 v[36:39], v[52:55], a[232:239], v6
    ds_read_b128 v[64:67], v1 offset:7168
    global_load_dwordx4 v[116:119], v0, s[58:59] offset:1024 sc1
    s_waitcnt lgkmcnt(6)
    v_smfmac_f32_16x16x64_bf16 v[32:35], v[52:55], v[72:79], v6
    ds_read_b128 v[68:71], v1 offset:7680
    s_add_u32 s56, s56, 8192
    s_addc_u32 s57, s57, 0
    v_smfmac_f32_16x16x64_bf16 v[28:31], v[56:59], a[96:103], v6
    ds_read_b128 v[72:75], v12 offset:16384
    s_add_u32 s58, s58, 8192
    s_addc_u32 s59, s59, 0
    v_smfmac_f32_16x16x64_bf16 v[36:39], v[56:59], a[240:247], v6
    s_mov_b64 exec, 1
    global_store_dword v0, v6, s[36:37] sc1
    s_mov_b64 exec, -1
    s_waitcnt lgkmcnt(5)
    v_smfmac_f32_16x16x64_bf16 v[32:35], v[56:59], v[80:87], v6
    ds_read_b128 v[76:79], v12 offset:17408
    s_add_u32 s36, s36, 4096
    s_addc_u32 s37, s37, 0
    v_smfmac_f32_16x16x64_bf16 v[28:31], v[60:63], a[104:111], v6
    ds_read_b128 v[44:47], v1 offset:512
    v_smfmac_f32_16x16x64_bf16 v[36:39], v[60:63], a[248:255], v6
    ds_read_b128 v[80:83], v12 offset:18432
    s_waitcnt lgkmcnt(6)
    v_smfmac_f32_16x16x64_bf16 v[32:35], v[60:63], v[88:95], v6
    ds_read_b128 v[84:87], v12 offset:19456
    s_waitcnt lgkmcnt(6)
    v_smfmac_f32_16x16x64_bf16 v[28:31], v[64:67], a[112:119], v6
    ds_read_b128 v[48:51], v1 offset:1024
    v_smfmac_f32_16x16x64_bf16 v[36:39], v[64:67], v[128:135], v6
    ds_read_b128 v[88:91], v12 offset:32768
    global_store_dwordx4 v0, v[96:99], s[16:17]
    v_smfmac_f32_16x16x64_bf16 v[32:35], v[64:67], a[128:135], v6
    ds_read_b128 v[92:95], v12 offset:33792
    s_waitcnt lgkmcnt(8)
    v_smfmac_f32_16x16x64_bf16 v[28:31], v[68:71], a[120:127], v6
    ds_read_b128 v[52:55], v1 offset:1536
    v_smfmac_f32_16x16x64_bf16 v[36:39], v[68:71], v[136:143], v6
    ds_read_b128 v[56:59], v1 offset:2048
    v_smfmac_f32_16x16x64_bf16 v[32:35], v[68:71], a[136:143], v6
    ds_read_b128 v[60:63], v1 offset:2560
    v_smfmac_f32_16x16x64_bf16 v[28:31], v[40:43], a[0:7], v6
    ds_read_b128 v[64:67], v1 offset:3072
    s_waitcnt lgkmcnt(10)
    v_smfmac_f32_16x16x64_bf16 v[32:35], v[40:43], v[72:79], v6
    ds_read_b128 v[72:75], v12 offset:34816
    s_waitcnt lgkmcnt(10)
    v_smfmac_f32_16x16x64_bf16 v[28:31], v[44:47], a[8:15], v6
    ds_read_b128 v[76:79], v12 offset:35840
    s_waitcnt lgkmcnt(9)
    v_smfmac_f32_16x16x64_bf16 v[32:35], v[44:47], v[80:87], v6
    ds_read_b128 v[80:83], v12 offset:49152
    global_store_dwordx4 v0, v[96:99], s[16:17] offset:1024
    s_waitcnt lgkmcnt(9)
    v_smfmac_f32_16x16x64_bf16 v[28:31], v[48:51], a[16:23], v6
    ds_read_b128 v[84:87], v12 offset:50176
    s_waitcnt lgkmcnt(8)
    v_smfmac_f32_16x16x64_bf16 v[32:35], v[48:51], v[88:95], v6
    ds_read_b128 v[88:91], v12 offset:51200
    s_waitcnt lgkmcnt(8)
    v_smfmac_f32_16x16x64_bf16 v[28:31], v[52:55], a[24:31], v6
    ds_read_b128 v[92:95], v12 offset:52224
    s_waitcnt lgkmcnt(4)
    v_smfmac_f32_16x16x64_bf16 v[32:35], v[52:55], v[72:79], v6
    ds_read_b128 v[72:75], v3 offset:0
    v_smfmac_f32_16x16x64_bf16 v[28:31], v[56:59], a[32:39], v6
    ds_read_b128 v[76:79], v3 offset:1024
    s_waitcnt lgkmcnt(4)
    v_smfmac_f32_16x16x64_bf16 v[32:35], v[56:59], v[80:87], v6
    ds_read_b128 v[68:71], v1 offset:3584
    v_smfmac_f32_16x16x64_bf16 v[28:31], v[60:63], a[40:47], v6
    ds_read_b128 v[80:83], v3 offset:2048
    s_waitcnt lgkmcnt(4)
    v_smfmac_f32_16x16x64_bf16 v[32:35], v[60:63], v[88:95], v6
    ds_read_b128 v[84:87], v3 offset:3072
    v_smfmac_f32_16x16x64_bf16 v[28:31], v[64:67], a[48:55], v6
    ds_read_b128 v[88:91], v0 offset:16384
    s_waitcnt lgkmcnt(4)
    v_smfmac_f32_16x16x64_bf16 v[32:35], v[64:67], v[72:79], v6
    ds_read_b128 v[92:95], v0 offset:20480
    s_waitcnt lgkmcnt(4)
    v_smfmac_f32_16x16x64_bf16 v[28:31], v[68:71], a[56:63], v6
    ds_read_b128 v[72:75], v0 offset:17408
    s_waitcnt lgkmcnt(3)
    v_smfmac_f32_16x16x64_bf16 v[32:35], v[68:71], v[80:87], v6
    ds_read_b128 v[76:79], v0 offset:21504
    v_smfmac_f32_16x16x64_bf16 v[36:39], v[40:43], a[144:151], v6
    ds_read_b128 v[80:83], v0 offset:18432
    v_smfmac_f32_16x16x64_bf16 v[36:39], v[44:47], a[152:159], v6
    ds_read_b128 v[84:87], v0 offset:22528
    v_cvt_pk_bf16_f32 v14, v28, v29
    v_cvt_pk_bf16_f32 v15, v30, v31
    v_cvt_pk_bf16_f32 v16, v32, v33
    v_cvt_pk_bf16_f32 v17, v34, v35
    ds_write_b128 v7, v[14:17]
    ds_read_b64_tr_b16 v[104:105], v8 offset:26624
    ds_read_b64_tr_b16 v[106:107], v8 offset:27136
    v_smfmac_f32_16x16x64_bf16 v[36:39], v[48:51], a[160:167], v6
    ds_read_b128 v[28:31], v0 offset:19456
    v_smfmac_f32_16x16x64_bf16 v[36:39], v[56:59], a[176:183], v6
    ds_read_b128 v[32:35], v0 offset:23552
    v_smfmac_f32_16x16x64_bf16 v[36:39], v[60:63], a[184:191], v6
    v_smfmac_f32_16x16x64_bf16 v[36:39], v[52:55], a[168:175], v6
    s_waitcnt lgkmcnt(4)
    s_barrier
    ds_read_b64_tr_b16 v[96:97], v8 offset:24576
    ds_read_b64_tr_b16 v[98:99], v8 offset:25088
    ds_read_b64_tr_b16 v[100:101], v8 offset:25600
    ds_read_b64_tr_b16 v[102:103], v8 offset:26112
    ds_read_b64_tr_b16 v[108:109], v8 offset:27648
    ds_read_b64_tr_b16 v[110:111], v8 offset:28160
    v_smfmac_f32_16x16x64_bf16 v[36:39], v[64:67], a[192:199], v6
    v_smfmac_f32_16x16x64_bf16 v[36:39], v[68:71], a[200:207], v6
    s_waitcnt lgkmcnt(8)
    v_mfma_f32_16x16x32_bf16 v[48:51], v[104:107], v[104:107], v[24:27]
    v_mov_b64 v[52:53], s[62:63]
    v_mov_b64 v[54:55], s[62:63]
    v_mfma_f32_16x16x32_bf16 v[40:43], v[80:83], v[104:107], 0
    v_mfma_f32_16x16x32_bf16 v[44:47], v[84:87], v[104:107], 0
    v_cvt_pk_bf16_f32 v18, v36, v37
    v_cvt_pk_bf16_f32 v19, v38, v39
    s_waitcnt lgkmcnt(4)
    v_mfma_f32_16x16x32_bf16 v[48:51], v[96:99], v[96:99], v[48:51]
    v_mov_b64 v[36:37], v[18:19]
    v_mov_b64 v[38:39], v[18:19]
    v_mfma_f32_16x16x32_bf16 v[40:43], v[88:91], v[96:99], v[40:43]
    v_mfma_f32_16x16x32_bf16 v[44:47], v[92:95], v[96:99], v[44:47]
    v_permlane32_swap_b32 v36, v38
    s_waitcnt lgkmcnt(2)
    v_mfma_f32_16x16x32_bf16 v[48:51], v[100:103], v[100:103], v[48:51]
    v_permlane32_swap_b32 v37, v39
    v_mfma_f32_16x16x32_bf16 v[40:43], v[72:75], v[100:103], v[40:43]
    v_mfma_f32_16x16x32_bf16 v[44:47], v[76:79], v[100:103], v[44:47]
    s_waitcnt lgkmcnt(0)
    v_mfma_f32_16x16x32_bf16 v[48:51], v[108:111], v[108:111], v[48:51]
    global_store_dwordx4 v0, v[16:19], s[60:61] sc1
    v_mfma_f32_16x16x32_bf16 v[40:43], v[28:31], v[108:111], v[40:43]
    v_mfma_f32_16x16x32_bf16 v[44:47], v[32:35], v[108:111], v[44:47]
    s_add_u32 s60, s60, 4096
    s_addc_u32 s61, s61, 0
    s_cmp_ge_u32 s68, 63
    s_cbranch_scc1 Ldn_47
    ds_read_b128 v[72:75], v12 offset:0
    v_max3_f32 v14, v48, v49, v50
    v_max3_f32 v14, v14, v51, v40
    v_max3_f32 v15, v41, v42, v43
    v_max3_f32 v14, v14, v44, v45
    v_max3_f32 v15, v15, v46, v47
    v_max_f32 v14, v14, v15
    v_mov_b32 v15, v14
    v_mov_b64 v[56:57], 0
    v_mov_b64 v[58:59], 0
    ds_read_b128 v[76:79], v12 offset:1024
    v_permlane32_swap_b32 v14, v15
    v_max_f32 v14, v14, v15
    v_mov_b32 v15, v14
    v_mov_b64 v[60:61], 0
    v_mov_b64 v[62:63], 0
    ds_read_b128 v[80:83], v12 offset:2048
    v_permlane16_swap_b32 v14, v15
    v_max_f32 v14, v14, v15
    v_mul_f32 v14, s69, v14
    v_pk_fma_f32 v[40:41], v[40:41], s[80:81], v[14:15] op_sel_hi:[1,1,0] neg_lo:[0,0,1] neg_hi:[0,0,1]
    v_pk_fma_f32 v[42:43], v[42:43], s[80:81], v[14:15] op_sel_hi:[1,1,0] neg_lo:[0,0,1] neg_hi:[0,0,1]
    v_pk_fma_f32 v[44:45], v[44:45], s[80:81], v[14:15] op_sel_hi:[1,1,0] neg_lo:[0,0,1] neg_hi:[0,0,1]
    v_pk_fma_f32 v[46:47], v[46:47], s[80:81], v[14:15] op_sel_hi:[1,1,0] neg_lo:[0,0,1] neg_hi:[0,0,1]
    v_exp_f32 v40, v40
    v_exp_f32 v41, v41
    v_exp_f32 v42, v42
    v_exp_f32 v43, v43
    v_exp_f32 v44, v44
    v_exp_f32 v45, v45
    v_exp_f32 v46, v46
    v_exp_f32 v47, v47
    v_pk_fma_f32 v[48:49], v[48:49], s[80:81], v[14:15] op_sel_hi:[1,1,0] neg_lo:[0,0,1] neg_hi:[0,0,1]
    v_pk_fma_f32 v[50:51], v[50:51], s[80:81], v[14:15] op_sel_hi:[1,1,0] neg_lo:[0,0,1] neg_hi:[0,0,1]
    v_cvt_pk_bf16_f32 v96, v40, v41
    v_cvt_pk_bf16_f32 v97, v42, v43
    v_cvt_pk_bf16_f32 v98, v44, v45
    v_cvt_pk_bf16_f32 v99, v46, v47
    v_exp_f32 v48, v48
    s_nop 0
    v_mfma_f32_16x16x32_bf16 v[40:43], v[52:55], v[96:99], 0
    ds_read_b128 v[84:87], v12 offset:3072
    v_exp_f32 v49, v49
    v_mfma_f32_16x16x32_bf16 v[28:31], v[120:123], v[96:99], 0
    v_exp_f32 v50, v50
    v_mfma_f32_16x16x32_bf16 v[32:35], v[124:127], v[96:99], 0
    v_exp_f32 v51, v51
    v_cvt_pk_bf16_f32 v100, v48, v49
    v_cvt_pk_bf16_f32 v101, v50, v51
    v_mov_b64 v[64:65], 0
    v_mov_b64 v[66:67], 0
    v_mfma_f32_16x16x16_bf16 v[40:43], v[52:53], v[100:101], v[40:43]
    v_mov_b64 v[68:69], 0
    v_mov_b64 v[70:71], 0
    v_mfma_f32_16x16x16_bf16 v[28:31], v[36:37], v[100:101], v[28:31]
    v_mfma_f32_16x16x16_bf16 v[32:35], v[38:39], v[100:101], v[32:35]
    v_rcp_f32 v14, v40
    s_mov_b32 exec_lo, 0xff00ff00
    s_mov_b32 exec_hi, 0xff00ff00
    s_nop 0
    v_pk_mul_f32 v[28:29], v[28:29], v[14:15] op_sel_hi:[1,0]
    v_pk_mul_f32 v[30:31], v[30:31], v[14:15] op_sel_hi:[1,0]
    v_cvt_pk_bf16_f32 v88, v28, v29
    v_cvt_pk_bf16_f32 v89, v30, v31
    v_pk_mul_f32 v[32:33], v[32:33], v[14:15] op_sel_hi:[1,0]
    v_pk_mul_f32 v[34:35], v[34:35], v[14:15] op_sel_hi:[1,0]
    v_cvt_pk_bf16_f32 v90, v32, v33
    v_cvt_pk_bf16_f32 v91, v34, v35
    ds_write_b128 v9, v[88:91]
    s_mov_b64 exec, -1
    v_mov_b32_dpp v88, v88 row_ror:8 row_mask:0xf bank_mask:0x3
    v_mov_b32_dpp v89, v89 row_ror:8 row_mask:0xf bank_mask:0x3
    v_mov_b32_dpp v90, v90 row_ror:8 row_mask:0xf bank_mask:0x3
    v_mov_b32_dpp v91, v91 row_ror:8 row_mask:0xf bank_mask:0x3
    s_nop 1
    v_smfmac_f32_16x16x64_bf16 v[56:59], v[88:91], v[192:199], v6
    v_smfmac_f32_16x16x64_bf16 v[60:63], v[88:91], v[208:215], v6
    s_waitcnt vmcnt(8) lgkmcnt(0)
    s_barrier
    ds_read_b128 v[96:99], v1 offset:28672
    ds_read_b128 v[100:103], v1 offset:29184
    ds_read_b128 v[108:111], v1 offset:30208
    v_smfmac_f32_16x16x64_bf16 v[64:67], v[88:91], v[224:231], v6
    v_smfmac_f32_16x16x64_bf16 v[68:71], v[88:91], v[240:247], v6
    s_waitcnt lgkmcnt(2)
    v_smfmac_f32_16x16x64_bf16 v[56:59], v[96:99], v[72:79], v6
    v_smfmac_f32_16x16x64_bf16 v[60:63], v[96:99], v[144:151], v6
    s_waitcnt lgkmcnt(1)
    v_smfmac_f32_16x16x64_bf16 v[56:59], v[100:103], v[80:87], v6
    v_smfmac_f32_16x16x64_bf16 v[60:63], v[100:103], v[152:159], v6
    s_waitcnt lgkmcnt(0)
    v_smfmac_f32_16x16x64_bf16 v[56:59], v[108:111], v[200:207], v6
    v_smfmac_f32_16x16x64_bf16 v[60:63], v[108:111], v[216:223], v6
    v_smfmac_f32_16x16x64_bf16 v[64:67], v[96:99], v[160:167], v6
    v_smfmac_f32_16x16x64_bf16 v[68:71], v[96:99], v[176:183], v6
    v_cvt_pk_bf16_f32 v40, v56, v60
    v_smfmac_f32_16x16x64_bf16 v[64:67], v[100:103], v[168:175], v6
    v_cvt_pk_bf16_f32 v41, v57, v61
    v_smfmac_f32_16x16x64_bf16 v[68:71], v[100:103], v[184:191], v6
    v_cvt_pk_bf16_f32 v42, v58, v62
    v_smfmac_f32_16x16x64_bf16 v[64:67], v[108:111], v[232:239], v6
    v_cvt_pk_bf16_f32 v43, v59, v63
    v_smfmac_f32_16x16x64_bf16 v[68:71], v[108:111], v[248:255], v6
    global_store_dwordx4 v10, v[40:43], s[50:51]
    s_nop 6
    v_cvt_pk_bf16_f32 v44, v64, v68
    v_cvt_pk_bf16_f32 v45, v65, v69
    v_cvt_pk_bf16_f32 v46, v66, v70
    v_cvt_pk_bf16_f32 v47, v67, v71
    global_store_dwordx4 v10, v[44:47], s[54:55]
    s_waitcnt vmcnt(1)
    ds_read_b128 v[72:75], v3 offset:16384
    ds_read_b128 v[76:79], v3 offset:17408
    ds_read_b128 v[80:83], v3 offset:18432
    ds_read_b128 v[84:87], v3 offset:19456
    ds_read_b128 v[88:91], v3 offset:32768
    ds_read_b128 v[92:95], v3 offset:33792
    global_load_dwordx4 v[48:51], v0, s[18:19] offset:0 sc1
    global_load_dwordx4 v[52:55], v0, s[18:19] offset:1024 sc1
    s_sleep 2
    global_load_dwordx4 v[64:67], v0, s[18:19] offset:0 sc1
    global_load_dwordx4 v[68:71], v0, s[18:19] offset:1024 sc1
    v_mov_b64 v[28:29], 0
    v_mov_b64 v[30:31], 0
    v_mov_b64 v[32:33], 0
    v_mov_b64 v[34:35], 0
    v_mov_b64 v[36:37], 0
    v_mov_b64 v[38:39], 0
    v_mov_b64 v[96:97], -1
    v_mov_b64 v[98:99], -1
    s_waitcnt vmcnt(2)
    v_mfma_f32_16x16x32_bf16 v[100:103], v[20:23], v[48:51], 0
    v_max3_u32 v14, v48, v49, v50
    v_mfma_f32_16x16x32_bf16 v[100:103], v[20:23], v[52:55], v[100:103]
    v_max3_u32 v15, v51, v52, v53
    v_max3_u32 v14, v14, v54, v55
    v_max_u32 v14, v14, v15
    v_cmp_eq_u32 vcc, -1, v14
    s_cbranch_vccnz LlB_56
LokB_57:
    s_nop 2
    v_add_f32_dpp v100, v100, v100 row_ror:4 row_mask:0xf bank_mask:0xf
    v_add_f32_dpp v101, v101, v101 row_ror:4 row_mask:0xf bank_mask:0xf
    v_add_f32_dpp v102, v102, v102 row_ror:4 row_mask:0xf bank_mask:0xf
    v_add_f32_dpp v103, v103, v103 row_ror:4 row_mask:0xf bank_mask:0xf
    v_add_f32_dpp v100, v100, v100 row_ror:8 row_mask:0xf bank_mask:0xf
    v_add_f32_dpp v101, v101, v101 row_ror:8 row_mask:0xf bank_mask:0xf
    v_add_f32_dpp v102, v102, v102 row_ror:8 row_mask:0xf bank_mask:0xf
    v_add_f32_dpp v103, v103, v103 row_ror:8 row_mask:0xf bank_mask:0xf
    v_cvt_pk_bf16_f32 v100, v100, v101
    v_cvt_pk_bf16_f32 v101, v102, v103
    v_cndmask_b32 v100, v100, v101, s[70:71]
    s_mov_b64 exec, 0x00ff00ff
    global_store_dword v11, v100, s[44:45]
    s_mov_b64 exec, -1
    s_add_u32 s68, s68, 1
    s_add_u32 s64, s68, 2
    s_cmp_lt_u32 s64, s76
    s_cbranch_scc1 Lrec_46
Lrs_58:
Lrdy_59:
    global_load_dword v5, v4, s[42:43] sc1
    s_add_u32 s77, s77, 1
    s_cmp_gt_u32 s77, 0x100000
    s_cbranch_scc1 Lrec_46
    s_waitcnt vmcnt(0)
    v_cmp_le_u32 s[74:75], 32, v5
    s_nop 0
    s_ff0_i32_b64 s76, s[74:75]
    s_add_u32 s64, s68, 2
    s_cmp_lt_u32 s64, s76
    s_cbranch_scc0 Lrdy_59
    s_branch Lrec_46
Ldn_47:
    s_waitcnt vmcnt(0)
    s_mov_b64 exec, 1
    global_store_dword v0, v6, s[36:37] sc1
    s_mov_b64 exec, -1
    s_add_u32 s36, s36, 4096
    s_addc_u32 s37, s37, 0
    s_endpgm
LslA_50:
    s_mov_b64 exec, vcc
    global_load_dwordx4 v[104:107], v2, s[44:45] offset:0 sc1
    global_load_dwordx4 v[108:111], v2, s[44:45] offset:1024 sc1
    s_mov_b64 exec, -1
    s_waitcnt vmcnt(2)
    ds_write_b128 v2, v[64:67] offset:0
    ds_write_b128 v2, v[68:71] offset:1024
    v_max3_u32 v14, v64, v65, v66
    v_max3_u32 v15, v67, v68, v69
    v_max3_u32 v14, v14, v70, v71
    v_max_u32 v14, v14, v15
    v_cmp_eq_u32 vcc, -1, v14
    s_cbranch_vccz LokA_49
    s_mov_b64 exec, vcc
    global_load_dwordx4 v[64:67], v2, s[44:45] offset:0 sc1
    global_load_dwordx4 v[68:71], v2, s[44:45] offset:1024 sc1
    s_mov_b64 exec, -1
    s_waitcnt vmcnt(2)
    ds_write_b128 v2, v[104:107] offset:0
    ds_write_b128 v2, v[108:111] offset:1024
    v_max3_u32 v14, v104, v105, v106
    v_max3_u32 v15, v107, v108, v109
    v_max3_u32 v14, v14, v110, v111
    v_max_u32 v14, v14, v15
    v_cmp_eq_u32 vcc, -1, v14
    s_cbranch_vccz LokA_49
    s_add_u32 s77, s77, 1
    s_cmp_lt_u32 s77, 0x80000
    s_cbranch_scc1 LslA_50
    s_branch LokA_49
LlB_51:
    s_mov_b64 exec, vcc
    global_load_dwordx4 v[48:51], v0, s[16:17] offset:0 sc1
    global_load_dwordx4 v[52:55], v0, s[16:17] offset:1024 sc1
    s_mov_b64 exec, -1
    s_waitcnt vmcnt(2)
    v_mfma_f32_16x16x32_bf16 v[100:103], v[20:23], v[64:67], 0
    v_max3_u32 v14, v64, v65, v66
    v_mfma_f32_16x16x32_bf16 v[100:103], v[20:23], v[68:71], v[100:103]
    v_max3_u32 v15, v67, v68, v69
    v_max3_u32 v14, v14, v70, v71
    v_max_u32 v14, v14, v15
    v_cmp_eq_u32 vcc, -1, v14
    s_cbranch_vccz LokB_52
    s_mov_b64 exec, vcc
    global_load_dwordx4 v[64:67], v0, s[16:17] offset:0 sc1
    global_load_dwordx4 v[68:71], v0, s[16:17] offset:1024 sc1
    s_mov_b64 exec, -1
    s_waitcnt vmcnt(2)
    v_mfma_f32_16x16x32_bf16 v[100:103], v[20:23], v[48:51], 0
    v_max3_u32 v14, v48, v49, v50
    v_mfma_f32_16x16x32_bf16 v[100:103], v[20:23], v[52:55], v[100:103]
    v_max3_u32 v15, v51, v52, v53
    v_max3_u32 v14, v14, v54, v55
    v_max_u32 v14, v14, v15
    v_cmp_eq_u32 vcc, -1, v14
    s_cbranch_vccz LokB_52
    s_add_u32 s77, s77, 1
    s_cmp_lt_u32 s77, 0x80000
    s_cbranch_scc1 LlB_51
    s_branch LokB_52
LslA_55:
    s_mov_b64 exec, vcc
    global_load_dwordx4 v[104:107], v2, s[46:47] offset:0 sc1
    global_load_dwordx4 v[108:111], v2, s[46:47] offset:1024 sc1
    s_mov_b64 exec, -1
    s_waitcnt vmcnt(2)
    ds_write_b128 v2, v[64:67] offset:0
    ds_write_b128 v2, v[68:71] offset:1024
    v_max3_u32 v14, v64, v65, v66
    v_max3_u32 v15, v67, v68, v69
    v_max3_u32 v14, v14, v70, v71
    v_max_u32 v14, v14, v15
    v_cmp_eq_u32 vcc, -1, v14
    s_cbranch_vccz LokA_54
    s_mov_b64 exec, vcc
    global_load_dwordx4 v[64:67], v2, s[46:47] offset:0 sc1
    global_load_dwordx4 v[68:71], v2, s[46:47] offset:1024 sc1
    s_mov_b64 exec, -1
    s_waitcnt vmcnt(2)
    ds_write_b128 v2, v[104:107] offset:0
    ds_write_b128 v2, v[108:111] offset:1024
    v_max3_u32 v14, v104, v105, v106
    v_max3_u32 v15, v107, v108, v109
    v_max3_u32 v14, v14, v110, v111
    v_max_u32 v14, v14, v15
    v_cmp_eq_u32 vcc, -1, v14
    s_cbranch_vccz LokA_54
    s_add_u32 s77, s77, 1
    s_cmp_lt_u32 s77, 0x80000
    s_cbranch_scc1 LslA_55
    s_branch LokA_54
LlB_56:
    s_mov_b64 exec, vcc
    global_load_dwordx4 v[48:51], v0, s[18:19] offset:0 sc1
    global_load_dwordx4 v[52:55], v0, s[18:19] offset:1024 sc1
    s_mov_b64 exec, -1
    s_waitcnt vmcnt(2)
    v_mfma_f32_16x16x32_bf16 v[100:103], v[20:23], v[64:67], 0
    v_max3_u32 v14, v64, v65, v66
    v_mfma_f32_16x16x32_bf16 v[100:103], v[20:23], v[68:71], v[100:103]
    v_max3_u32 v15, v67, v68, v69
    v_max3_u32 v14, v14, v70, v71
    v_max_u32 v14, v14, v15
    v_cmp_eq_u32 vcc, -1, v14
    s_cbranch_vccz LokB_57
    s_mov_b64 exec, vcc
    global_load_dwordx4 v[64:67], v0, s[18:19] offset:0 sc1
    global_load_dwordx4 v[68:71], v0, s[18:19] offset:1024 sc1
    s_mov_b64 exec, -1
    s_waitcnt vmcnt(2)
    v_mfma_f32_16x16x32_bf16 v[100:103], v[20:23], v[48:51], 0
    v_max3_u32 v14, v48, v49, v50
    v_mfma_f32_16x16x32_bf16 v[100:103], v[20:23], v[52:55], v[100:103]
    v_max3_u32 v15, v51, v52, v53
    v_max3_u32 v14, v14, v54, v55
    v_max_u32 v14, v14, v15
    v_cmp_eq_u32 vcc, -1, v14
    s_cbranch_vccz LokB_57
    s_add_u32 s77, s77, 1
    s_cmp_lt_u32 s77, 0x80000
    s_cbranch_scc1 LlB_56
    s_branch LokB_57
Lrw_17:
    ds_read_b128 v[72:75], v3 offset:49152
    ds_read_b128 v[76:79], v3 offset:50176
    ds_read_b128 v[80:83], v3 offset:51200
    ds_read_b128 v[84:87], v3 offset:52224
    ds_read_b128 v[88:91], v12 offset:16384
    ds_read_b128 v[92:95], v12 offset:17408
    v_mov_b64 v[28:29], 0
    v_mov_b64 v[30:31], 0
    v_mov_b64 v[32:33], 0
    v_mov_b64 v[34:35], 0
    v_mov_b64 v[36:37], 0
    v_mov_b64 v[38:39], 0
    v_mov_b64 v[96:97], -1
    v_mov_b64 v[98:99], -1
Lrec_60:
    s_waitcnt vmcnt(0)
    global_load_dwordx4 v[104:107], v2, s[44:45] offset:0 sc1
    global_load_dwordx4 v[108:111], v2, s[44:45] offset:1024 sc1
    s_sleep 2
    global_load_dwordx4 v[64:67], v2, s[44:45] offset:0 sc1
    global_load_dwordx4 v[68:71], v2, s[44:45] offset:1024 sc1
    s_waitcnt vmcnt(2)
    ds_write_b128 v2, v[104:107] offset:0
    ds_write_b128 v2, v[108:111] offset:1024
    v_max3_u32 v14, v104, v105, v106
    v_max3_u32 v15, v107, v108, v109
    v_max3_u32 v14, v14, v110, v111
    v_max_u32 v14, v14, v15
    v_cmp_eq_u32 vcc, -1, v14
    s_cbranch_vccnz LslA_64
LokA_63:
    ds_read_b128 v[40:43], v1 offset:6144
    ds_read_b128 v[44:47], v1 offset:6656
    ds_read_b128 v[48:51], v1 offset:7168
    ds_read_b128 v[52:55], v1 offset:7680
    s_waitcnt lgkmcnt(4)
    s_barrier
    s_waitcnt lgkmcnt(3)
    v_smfmac_f32_16x16x64_bf16 v[28:31], v[40:43], a[96:103], v6
    ds_read_b128 v[56:59], v1 offset:0
    v_smfmac_f32_16x16x64_bf16 v[36:39], v[40:43], a[240:247], v6
    ds_read_b128 v[60:63], v1 offset:512
    v_smfmac_f32_16x16x64_bf16 v[32:35], v[40:43], v[72:79], v6
    ds_read_b128 v[72:75], v12 offset:18432
    s_waitcnt lgkmcnt(5)
    v_smfmac_f32_16x16x64_bf16 v[28:31], v[44:47], a[104:111], v6
    ds_read_b128 v[76:79], v12 offset:19456
    v_smfmac_f32_16x16x64_bf16 v[36:39], v[44:47], a[248:255], v6
    ds_read_b128 v[40:43], v1 offset:2048
    v_smfmac_f32_16x16x64_bf16 v[32:35], v[44:47], v[80:87], v6
    ds_read_b128 v[80:83], v12 offset:32768
    s_waitcnt vmcnt(0)
    s_waitcnt lgkmcnt(7)
    v_smfmac_f32_16x16x64_bf16 v[28:31], v[48:51], a[112:119], v6
    s_mov_b64 exec, 0x00ff00ff
    global_store_dword v11, v96, s[46:47]
    s_mov_b64 exec, -1
    v_smfmac_f32_16x16x64_bf16 v[36:39], v[48:51], v[128:135], v6
    ds_read_b128 v[64:67], v1 offset:1024
    s_add_u32 m0, s78, 8192
    global_load_dwordx4 v[120:123], v0, s[58:59] sc1
    v_smfmac_f32_16x16x64_bf16 v[32:35], v[48:51], a[128:135], v6
    ds_read_b128 v[84:87], v12 offset:33792
    global_load_lds_dwordx4 v0, s[56:57] sc1
    s_waitcnt lgkmcnt(8)
    v_smfmac_f32_16x16x64_bf16 v[28:31], v[52:55], a[120:127], v6
    ds_read_b128 v[68:71], v1 offset:1536
    global_load_lds_dwordx4 v0, s[56:57] offset:1024 sc1
    v_smfmac_f32_16x16x64_bf16 v[36:39], v[52:55], v[136:143], v6
    ds_read_b128 v[44:47], v1 offset:2560
    global_load_dwordx4 v[124:127], v0, s[58:59] offset:1024 sc1
    v_smfmac_f32_16x16x64_bf16 v[32:35], v[52:55], a[136:143], v6
    ds_read_b128 v[48:51], v1 offset:3072
    s_add_u32 s56, s56, 8192
    s_addc_u32 s57, s57, 0
    s_waitcnt lgkmcnt(10)
    v_smfmac_f32_16x16x64_bf16 v[28:31], v[56:59], a[0:7], v6
    ds_read_b128 v[52:55], v1 offset:3584
    s_add_u32 s58, s58, 8192
    s_addc_u32 s59, s59, 0
    v_smfmac_f32_16x16x64_bf16 v[36:39], v[56:59], a[144:151], v6
    s_mov_b64 exec, 1
    global_store_dword v0, v6, s[36:37] sc1
    s_mov_b64 exec, -1
    v_smfmac_f32_16x16x64_bf16 v[32:35], v[56:59], v[88:95], v6
    ds_read_b128 v[88:91], v12 offset:34816
    s_add_u32 s36, s36, 4096
    s_addc_u32 s37, s37, 0
    s_waitcnt lgkmcnt(11)
    v_smfmac_f32_16x16x64_bf16 v[28:31], v[60:63], a[8:15], v6
    ds_read_b128 v[92:95], v12 offset:35840
    v_smfmac_f32_16x16x64_bf16 v[36:39], v[60:63], a[152:159], v6
    ds_read_b128 v[56:59], v1 offset:4096
    s_waitcnt lgkmcnt(11)
    v_smfmac_f32_16x16x64_bf16 v[32:35], v[60:63], v[72:79], v6
    ds_read_b128 v[72:75], v12 offset:49152
    s_waitcnt lgkmcnt(9)
    v_smfmac_f32_16x16x64_bf16 v[28:31], v[64:67], a[16:23], v6
    ds_read_b128 v[76:79], v12 offset:50176
    v_smfmac_f32_16x16x64_bf16 v[36:39], v[64:67], a[160:167], v6
    ds_read_b128 v[60:63], v1 offset:4608
    s_waitcnt lgkmcnt(10)
    v_smfmac_f32_16x16x64_bf16 v[32:35], v[64:67], v[80:87], v6
    ds_read_b128 v[80:83], v12 offset:51200
    s_waitcnt lgkmcnt(10)
    v_smfmac_f32_16x16x64_bf16 v[28:31], v[68:71], a[24:31], v6
    ds_read_b128 v[84:87], v12 offset:52224
    global_store_dwordx4 v0, v[96:99], s[18:19]
    v_smfmac_f32_16x16x64_bf16 v[36:39], v[68:71], a[168:175], v6
    ds_read_b128 v[64:67], v1 offset:5120
    s_waitcnt lgkmcnt(7)
    v_smfmac_f32_16x16x64_bf16 v[32:35], v[68:71], v[88:95], v6
    ds_read_b128 v[88:91], v3 offset:0
    v_smfmac_f32_16x16x64_bf16 v[28:31], v[40:43], a[32:39], v6
    ds_read_b128 v[92:95], v3 offset:1024
    s_waitcnt lgkmcnt(6)
    v_smfmac_f32_16x16x64_bf16 v[32:35], v[40:43], v[72:79], v6
    ds_read_b128 v[72:75], v3 offset:2048
    v_smfmac_f32_16x16x64_bf16 v[28:31], v[44:47], a[40:47], v6
    ds_read_b128 v[76:79], v3 offset:3072
    s_waitcnt lgkmcnt(5)
    v_smfmac_f32_16x16x64_bf16 v[32:35], v[44:47], v[80:87], v6
    ds_read_b128 v[80:83], v3 offset:16384
    v_smfmac_f32_16x16x64_bf16 v[28:31], v[48:51], a[48:55], v6
    ds_read_b128 v[84:87], v3 offset:17408
    s_waitcnt lgkmcnt(4)
    v_smfmac_f32_16x16x64_bf16 v[32:35], v[48:51], v[88:95], v6
    ds_read_b128 v[88:91], v3 offset:18432
    global_store_dwordx4 v0, v[96:99], s[18:19] offset:1024
    v_smfmac_f32_16x16x64_bf16 v[28:31], v[52:55], a[56:63], v6
    ds_read_b128 v[92:95], v3 offset:19456
    s_waitcnt lgkmcnt(4)
    v_smfmac_f32_16x16x64_bf16 v[32:35], v[52:55], v[72:79], v6
    ds_read_b128 v[72:75], v3 offset:32768
    v_smfmac_f32_16x16x64_bf16 v[28:31], v[56:59], a[64:71], v6
    ds_read_b128 v[76:79], v3 offset:33792
    s_waitcnt lgkmcnt(4)
    v_smfmac_f32_16x16x64_bf16 v[32:35], v[56:59], v[80:87], v6
    ds_read_b128 v[68:71], v1 offset:5632
    v_smfmac_f32_16x16x64_bf16 v[28:31], v[60:63], a[72:79], v6
    ds_read_b128 v[80:83], v3 offset:34816
    s_waitcnt lgkmcnt(4)
    v_smfmac_f32_16x16x64_bf16 v[32:35], v[60:63], v[88:95], v6
    ds_read_b128 v[84:87], v3 offset:35840
    v_smfmac_f32_16x16x64_bf16 v[28:31], v[64:67], a[80:87], v6
    ds_read_b128 v[88:91], v0 offset:8192
    s_waitcnt lgkmcnt(4)
    v_smfmac_f32_16x16x64_bf16 v[32:35], v[64:67], v[72:79], v6
    ds_read_b128 v[92:95], v0 offset:12288
    s_waitcnt lgkmcnt(4)
    v_smfmac_f32_16x16x64_bf16 v[28:31], v[68:71], a[88:95], v6
    ds_read_b128 v[72:75], v0 offset:9216
    s_waitcnt lgkmcnt(3)
    v_smfmac_f32_16x16x64_bf16 v[32:35], v[68:71], v[80:87], v6
    ds_read_b128 v[76:79], v0 offset:13312
    v_smfmac_f32_16x16x64_bf16 v[36:39], v[40:43], a[176:183], v6
    ds_read_b128 v[80:83], v0 offset:10240
    v_smfmac_f32_16x16x64_bf16 v[36:39], v[44:47], a[184:191], v6
    ds_read_b128 v[84:87], v0 offset:14336
    v_cvt_pk_bf16_f32 v14, v28, v29
    v_cvt_pk_bf16_f32 v15, v30, v31
    v_cvt_pk_bf16_f32 v16, v32, v33
    v_cvt_pk_bf16_f32 v17, v34, v35
    ds_write_b128 v7, v[14:17]
    ds_read_b64_tr_b16 v[108:109], v8 offset:27648
    ds_read_b64_tr_b16 v[110:111], v8 offset:28160
    v_smfmac_f32_16x16x64_bf16 v[36:39], v[48:51], a[192:199], v6
    ds_read_b128 v[28:31], v0 offset:11264
    v_smfmac_f32_16x16x64_bf16 v[36:39], v[56:59], a[208:215], v6
    ds_read_b128 v[32:35], v0 offset:15360
    v_smfmac_f32_16x16x64_bf16 v[36:39], v[60:63], a[216:223], v6
    v_smfmac_f32_16x16x64_bf16 v[36:39], v[52:55], a[200:207], v6
    s_waitcnt lgkmcnt(4)
    s_barrier
    ds_read_b64_tr_b16 v[96:97], v8 offset:24576
    ds_read_b64_tr_b16 v[98:99], v8 offset:25088
    ds_read_b64_tr_b16 v[100:101], v8 offset:25600
    ds_read_b64_tr_b16 v[102:103], v8 offset:26112
    ds_read_b64_tr_b16 v[104:105], v8 offset:26624
    ds_read_b64_tr_b16 v[106:107], v8 offset:27136
    v_smfmac_f32_16x16x64_bf16 v[36:39], v[64:67], a[224:231], v6
    v_smfmac_f32_16x16x64_bf16 v[36:39], v[68:71], a[232:239], v6
    s_waitcnt lgkmcnt(8)
    v_mfma_f32_16x16x32_bf16 v[48:51], v[108:111], v[108:111], v[24:27]
    v_mov_b64 v[52:53], s[62:63]
    v_mov_b64 v[54:55], s[62:63]
    s_waitcnt lgkmcnt(7)
    v_mfma_f32_16x16x32_bf16 v[40:43], v[28:31], v[108:111], 0
    s_waitcnt lgkmcnt(6)
    v_mfma_f32_16x16x32_bf16 v[44:47], v[32:35], v[108:111], 0
    v_cvt_pk_bf16_f32 v18, v36, v37
    v_cvt_pk_bf16_f32 v19, v38, v39
    s_waitcnt lgkmcnt(4)
    v_mfma_f32_16x16x32_bf16 v[48:51], v[96:99], v[96:99], v[48:51]
    v_mov_b64 v[36:37], v[18:19]
    v_mov_b64 v[38:39], v[18:19]
    v_mfma_f32_16x16x32_bf16 v[40:43], v[88:91], v[96:99], v[40:43]
    v_mfma_f32_16x16x32_bf16 v[44:47], v[92:95], v[96:99], v[44:47]
    v_permlane32_swap_b32 v36, v38
    s_waitcnt lgkmcnt(2)
    v_mfma_f32_16x16x32_bf16 v[48:51], v[100:103], v[100:103], v[48:51]
    v_permlane32_swap_b32 v37, v39
    v_mfma_f32_16x16x32_bf16 v[40:43], v[72:75], v[100:103], v[40:43]
    v_mfma_f32_16x16x32_bf16 v[44:47], v[76:79], v[100:103], v[44:47]
    s_waitcnt lgkmcnt(0)
    v_mfma_f32_16x16x32_bf16 v[48:51], v[104:107], v[104:107], v[48:51]
    v_mfma_f32_16x16x32_bf16 v[40:43], v[80:83], v[104:107], v[40:43]
    global_store_dwordx4 v0, v[16:19], s[60:61] sc1
    v_mfma_f32_16x16x32_bf16 v[44:47], v[84:87], v[104:107], v[44:47]
    s_add_u32 s60, s60, 4096
    s_addc_u32 s61, s61, 0
    ds_read_b128 v[72:75], v12 offset:0
    v_max3_f32 v14, v48, v49, v50
    v_max3_f32 v14, v14, v51, v40
    v_max3_f32 v15, v41, v42, v43
    s_nop 1
    v_max3_f32 v14, v14, v44, v45
    v_max3_f32 v15, v15, v46, v47
    v_max_f32 v14, v14, v15
    v_mov_b32 v15, v14
    v_mov_b64 v[56:57], 0
    v_mov_b64 v[58:59], 0
    ds_read_b128 v[76:79], v12 offset:1024
    v_permlane32_swap_b32 v14, v15
    v_max_f32 v14, v14, v15
    v_mov_b32 v15, v14
    v_mov_b64 v[60:61], 0
    v_mov_b64 v[62:63], 0
    ds_read_b128 v[80:83], v12 offset:2048
    v_permlane16_swap_b32 v14, v15
    v_max_f32 v14, v14, v15
    v_mul_f32 v14, s69, v14
    v_pk_fma_f32 v[40:41], v[40:41], s[80:81], v[14:15] op_sel_hi:[1,1,0] neg_lo:[0,0,1] neg_hi:[0,0,1]
    v_pk_fma_f32 v[42:43], v[42:43], s[80:81], v[14:15] op_sel_hi:[1,1,0] neg_lo:[0,0,1] neg_hi:[0,0,1]
    v_pk_fma_f32 v[44:45], v[44:45], s[80:81], v[14:15] op_sel_hi:[1,1,0] neg_lo:[0,0,1] neg_hi:[0,0,1]
    v_pk_fma_f32 v[46:47], v[46:47], s[80:81], v[14:15] op_sel_hi:[1,1,0] neg_lo:[0,0,1] neg_hi:[0,0,1]
    v_exp_f32 v40, v40
    v_exp_f32 v41, v41
    v_exp_f32 v42, v42
    v_exp_f32 v43, v43
    v_exp_f32 v44, v44
    v_exp_f32 v45, v45
    v_exp_f32 v46, v46
    v_exp_f32 v47, v47
    v_pk_fma_f32 v[48:49], v[48:49], s[80:81], v[14:15] op_sel_hi:[1,1,0] neg_lo:[0,0,1] neg_hi:[0,0,1]
    v_pk_fma_f32 v[50:51], v[50:51], s[80:81], v[14:15] op_sel_hi:[1,1,0] neg_lo:[0,0,1] neg_hi:[0,0,1]
    v_cvt_pk_bf16_f32 v96, v40, v41
    v_cvt_pk_bf16_f32 v97, v42, v43
    v_cvt_pk_bf16_f32 v98, v44, v45
    v_cvt_pk_bf16_f32 v99, v46, v47
    v_exp_f32 v48, v48
    s_nop 0
    v_mfma_f32_16x16x32_bf16 v[40:43], v[52:55], v[96:99], 0
    ds_read_b128 v[84:87], v12 offset:3072
    v_exp_f32 v49, v49
    v_mfma_f32_16x16x32_bf16 v[28:31], v[112:115], v[96:99], 0
    v_exp_f32 v50, v50
    v_mfma_f32_16x16x32_bf16 v[32:35], v[116:119], v[96:99], 0
    v_exp_f32 v51, v51
    v_cvt_pk_bf16_f32 v100, v48, v49
    v_cvt_pk_bf16_f32 v101, v50, v51
    v_mov_b64 v[64:65], 0
    v_mov_b64 v[66:67], 0
    v_mfma_f32_16x16x16_bf16 v[40:43], v[52:53], v[100:101], v[40:43]
    v_mov_b64 v[68:69], 0
    v_mov_b64 v[70:71], 0
    v_mfma_f32_16x16x16_bf16 v[28:31], v[36:37], v[100:101], v[28:31]
    v_mfma_f32_16x16x16_bf16 v[32:35], v[38:39], v[100:101], v[32:35]
    v_rcp_f32 v14, v40
    s_mov_b32 exec_lo, 0xff00ff00
    s_mov_b32 exec_hi, 0xff00ff00
    s_nop 0
    v_pk_mul_f32 v[28:29], v[28:29], v[14:15] op_sel_hi:[1,0]
    v_pk_mul_f32 v[30:31], v[30:31], v[14:15] op_sel_hi:[1,0]
    v_cvt_pk_bf16_f32 v88, v28, v29
    v_cvt_pk_bf16_f32 v89, v30, v31
    v_pk_mul_f32 v[32:33], v[32:33], v[14:15] op_sel_hi:[1,0]
    v_pk_mul_f32 v[34:35], v[34:35], v[14:15] op_sel_hi:[1,0]
    v_cvt_pk_bf16_f32 v90, v32, v33
    v_cvt_pk_bf16_f32 v91, v34, v35
    ds_write_b128 v9, v[88:91]
    s_mov_b64 exec, -1
    v_mov_b32_dpp v88, v88 row_ror:8 row_mask:0xf bank_mask:0x3
    v_mov_b32_dpp v89, v89 row_ror:8 row_mask:0xf bank_mask:0x3
    v_mov_b32_dpp v90, v90 row_ror:8 row_mask:0xf bank_mask:0x3
    v_mov_b32_dpp v91, v91 row_ror:8 row_mask:0xf bank_mask:0x3
    s_nop 1
    v_smfmac_f32_16x16x64_bf16 v[56:59], v[88:91], v[200:207], v6
    v_smfmac_f32_16x16x64_bf16 v[60:63], v[88:91], v[216:223], v6
    s_waitcnt vmcnt(8) lgkmcnt(0)
    s_barrier
    ds_read_b128 v[96:99], v1 offset:28672
    ds_read_b128 v[100:103], v1 offset:29184
    ds_read_b128 v[104:107], v1 offset:29696
    v_smfmac_f32_16x16x64_bf16 v[64:67], v[88:91], v[232:239], v6
    v_smfmac_f32_16x16x64_bf16 v[68:71], v[88:91], v[248:255], v6
    s_waitcnt lgkmcnt(2)
    v_smfmac_f32_16x16x64_bf16 v[56:59], v[96:99], v[72:79], v6
    v_smfmac_f32_16x16x64_bf16 v[60:63], v[96:99], v[144:151], v6
    s_waitcnt lgkmcnt(1)
    v_smfmac_f32_16x16x64_bf16 v[56:59], v[100:103], v[80:87], v6
    v_smfmac_f32_16x16x64_bf16 v[60:63], v[100:103], v[152:159], v6
    s_waitcnt lgkmcnt(0)
    v_smfmac_f32_16x16x64_bf16 v[56:59], v[104:107], v[192:199], v6
    v_smfmac_f32_16x16x64_bf16 v[60:63], v[104:107], v[208:215], v6
    v_smfmac_f32_16x16x64_bf16 v[64:67], v[96:99], v[160:167], v6
    v_smfmac_f32_16x16x64_bf16 v[68:71], v[96:99], v[176:183], v6
    v_cvt_pk_bf16_f32 v40, v56, v60
    v_smfmac_f32_16x16x64_bf16 v[64:67], v[100:103], v[168:175], v6
    v_cvt_pk_bf16_f32 v41, v57, v61
    v_smfmac_f32_16x16x64_bf16 v[68:71], v[100:103], v[184:191], v6
    v_cvt_pk_bf16_f32 v42, v58, v62
    v_smfmac_f32_16x16x64_bf16 v[64:67], v[104:107], v[224:231], v6
    v_cvt_pk_bf16_f32 v43, v59, v63
    v_smfmac_f32_16x16x64_bf16 v[68:71], v[104:107], v[240:247], v6
    global_store_dwordx4 v10, v[40:43], s[48:49]
    s_nop 6
    v_cvt_pk_bf16_f32 v44, v64, v68
    v_cvt_pk_bf16_f32 v45, v65, v69
    v_cvt_pk_bf16_f32 v46, v66, v70
    v_cvt_pk_bf16_f32 v47, v67, v71
    global_store_dwordx4 v10, v[44:47], s[52:53]
    s_waitcnt vmcnt(1)
    ds_read_b128 v[72:75], v3 offset:49152
    ds_read_b128 v[76:79], v3 offset:50176
    ds_read_b128 v[80:83], v3 offset:51200
    ds_read_b128 v[84:87], v3 offset:52224
    ds_read_b128 v[88:91], v12 offset:16384
    ds_read_b128 v[92:95], v12 offset:17408
    global_load_dwordx4 v[48:51], v0, s[16:17] offset:0 sc1
    global_load_dwordx4 v[52:55], v0, s[16:17] offset:1024 sc1
    s_sleep 2
    global_load_dwordx4 v[64:67], v0, s[16:17] offset:0 sc1
    global_load_dwordx4 v[68:71], v0, s[16:17] offset:1024 sc1
    v_mov_b64 v[28:29], 0
    v_mov_b64 v[30:31], 0
    v_mov_b64 v[32:33], 0
    v_mov_b64 v[34:35], 0
    v_mov_b64 v[36:37], 0
    v_mov_b64 v[38:39], 0
    v_mov_b64 v[96:97], -1
    v_mov_b64 v[98:99], -1
    s_waitcnt vmcnt(2)
    v_mfma_f32_16x16x32_bf16 v[100:103], v[20:23], v[48:51], 0
    v_max3_u32 v14, v48, v49, v50
    v_mfma_f32_16x16x32_bf16 v[100:103], v[20:23], v[52:55], v[100:103]
    v_max3_u32 v15, v51, v52, v53
    v_max3_u32 v14, v14, v54, v55
    v_max_u32 v14, v14, v15
    v_cmp_eq_u32 vcc, -1, v14
    s_cbranch_vccnz LlB_65
LokB_66:
    s_nop 2
    v_add_f32_dpp v100, v100, v100 row_ror:4 row_mask:0xf bank_mask:0xf
    v_add_f32_dpp v101, v101, v101 row_ror:4 row_mask:0xf bank_mask:0xf
    v_add_f32_dpp v102, v102, v102 row_ror:4 row_mask:0xf bank_mask:0xf
    v_add_f32_dpp v103, v103, v103 row_ror:4 row_mask:0xf bank_mask:0xf
    v_add_f32_dpp v100, v100, v100 row_ror:8 row_mask:0xf bank_mask:0xf
    v_add_f32_dpp v101, v101, v101 row_ror:8 row_mask:0xf bank_mask:0xf
    v_add_f32_dpp v102, v102, v102 row_ror:8 row_mask:0xf bank_mask:0xf
    v_add_f32_dpp v103, v103, v103 row_ror:8 row_mask:0xf bank_mask:0xf
    v_cvt_pk_bf16_f32 v100, v100, v101
    v_cvt_pk_bf16_f32 v101, v102, v103
    v_cndmask_b32 v100, v100, v101, s[70:71]
    s_mov_b64 exec, 0x00ff00ff
    global_store_dword v11, v100, s[46:47]
    s_mov_b64 exec, -1
    s_add_u32 s68, s68, 1
    s_waitcnt vmcnt(0)
    global_load_dwordx4 v[104:107], v2, s[46:47] offset:0 sc1
    global_load_dwordx4 v[108:111], v2, s[46:47] offset:1024 sc1
    s_sleep 2
    global_load_dwordx4 v[64:67], v2, s[46:47] offset:0 sc1
    global_load_dwordx4 v[68:71], v2, s[46:47] offset:1024 sc1
    s_waitcnt vmcnt(2)
    ds_write_b128 v2, v[104:107] offset:0
    ds_write_b128 v2, v[108:111] offset:1024
    v_max3_u32 v14, v104, v105, v106
    v_max3_u32 v15, v107, v108, v109
    v_max3_u32 v14, v14, v110, v111
    v_max_u32 v14, v14, v15
    v_cmp_eq_u32 vcc, -1, v14
    s_cbranch_vccnz LslA_69
LokA_68:
    ds_read_b128 v[40:43], v1 offset:6144
    ds_read_b128 v[44:47], v1 offset:6656
    ds_read_b128 v[48:51], v1 offset:7168
    ds_read_b128 v[52:55], v1 offset:7680
    s_waitcnt lgkmcnt(4)
    s_barrier
    s_waitcnt lgkmcnt(3)
    v_smfmac_f32_16x16x64_bf16 v[28:31], v[40:43], a[96:103], v6
    ds_read_b128 v[56:59], v1 offset:0
    v_smfmac_f32_16x16x64_bf16 v[36:39], v[40:43], a[240:247], v6
    ds_read_b128 v[60:63], v1 offset:512
    v_smfmac_f32_16x16x64_bf16 v[32:35], v[40:43], v[72:79], v6
    ds_read_b128 v[72:75], v12 offset:18432
    s_waitcnt lgkmcnt(5)
    v_smfmac_f32_16x16x64_bf16 v[28:31], v[44:47], a[104:111], v6
    ds_read_b128 v[76:79], v12 offset:19456
    v_smfmac_f32_16x16x64_bf16 v[36:39], v[44:47], a[248:255], v6
    ds_read_b128 v[40:43], v1 offset:2048
    v_smfmac_f32_16x16x64_bf16 v[32:35], v[44:47], v[80:87], v6
    ds_read_b128 v[80:83], v12 offset:32768
    s_waitcnt vmcnt(0)
    s_waitcnt lgkmcnt(7)
    v_smfmac_f32_16x16x64_bf16 v[28:31], v[48:51], a[112:119], v6
    s_mov_b64 exec, 0x00ff00ff
    global_store_dword v11, v96, s[44:45]
    s_mov_b64 exec, -1
    v_smfmac_f32_16x16x64_bf16 v[36:39], v[48:51], v[128:135], v6
    ds_read_b128 v[64:67], v1 offset:1024
    s_add_u32 m0, s78, 0
    global_load_dwordx4 v[112:115], v0, s[58:59] sc1
    v_smfmac_f32_16x16x64_bf16 v[32:35], v[48:51], a[128:135], v6
    ds_read_b128 v[84:87], v12 offset:33792
    global_load_lds_dwordx4 v0, s[56:57] sc1
    s_waitcnt lgkmcnt(8)
    v_smfmac_f32_16x16x64_bf16 v[28:31], v[52:55], a[120:127], v6
    ds_read_b128 v[68:71], v1 offset:1536
    global_load_lds_dwordx4 v0, s[56:57] offset:1024 sc1
    v_smfmac_f32_16x16x64_bf16 v[36:39], v[52:55], v[136:143], v6
    ds_read_b128 v[44:47], v1 offset:2560
    global_load_dwordx4 v[116:119], v0, s[58:59] offset:1024 sc1
    v_smfmac_f32_16x16x64_bf16 v[32:35], v[52:55], a[136:143], v6
    ds_read_b128 v[48:51], v1 offset:3072
    s_add_u32 s56, s56, 8192
    s_addc_u32 s57, s57, 0
    s_waitcnt lgkmcnt(10)
    v_smfmac_f32_16x16x64_bf16 v[28:31], v[56:59], a[0:7], v6
    ds_read_b128 v[52:55], v1 offset:3584
    s_add_u32 s58, s58, 8192
    s_addc_u32 s59, s59, 0
    v_smfmac_f32_16x16x64_bf16 v[36:39], v[56:59], a[144:151], v6
    s_mov_b64 exec, 1
    global_store_dword v0, v6, s[36:37] sc1
    s_mov_b64 exec, -1
    v_smfmac_f32_16x16x64_bf16 v[32:35], v[56:59], v[88:95], v6
    ds_read_b128 v[88:91], v12 offset:34816
    s_add_u32 s36, s36, 4096
    s_addc_u32 s37, s37, 0
    s_waitcnt lgkmcnt(11)
    v_smfmac_f32_16x16x64_bf16 v[28:31], v[60:63], a[8:15], v6
    ds_read_b128 v[92:95], v12 offset:35840
    v_smfmac_f32_16x16x64_bf16 v[36:39], v[60:63], a[152:159], v6
    ds_read_b128 v[56:59], v1 offset:4096
    s_waitcnt lgkmcnt(11)
    v_smfmac_f32_16x16x64_bf16 v[32:35], v[60:63], v[72:79], v6
    ds_read_b128 v[72:75], v12 offset:49152
    s_waitcnt lgkmcnt(9)
    v_smfmac_f32_16x16x64_bf16 v[28:31], v[64:67], a[16:23], v6
    ds_read_b128 v[76:79], v12 offset:50176
    v_smfmac_f32_16x16x64_bf16 v[36:39], v[64:67], a[160:167], v6
    ds_read_b128 v[60:63], v1 offset:4608
    s_waitcnt lgkmcnt(10)
    v_smfmac_f32_16x16x64_bf16 v[32:35], v[64:67], v[80:87], v6
    ds_read_b128 v[80:83], v12 offset:51200
    s_waitcnt lgkmcnt(10)
    v_smfmac_f32_16x16x64_bf16 v[28:31], v[68:71], a[24:31], v6
    ds_read_b128 v[84:87], v12 offset:52224
    global_store_dwordx4 v0, v[96:99], s[16:17]
    v_smfmac_f32_16x16x64_bf16 v[36:39], v[68:71], a[168:175], v6
    ds_read_b128 v[64:67], v1 offset:5120
    s_waitcnt lgkmcnt(7)
    v_smfmac_f32_16x16x64_bf16 v[32:35], v[68:71], v[88:95], v6
    ds_read_b128 v[88:91], v3 offset:0
    v_smfmac_f32_16x16x64_bf16 v[28:31], v[40:43], a[32:39], v6
    ds_read_b128 v[92:95], v3 offset:1024
    s_waitcnt lgkmcnt(6)
    v_smfmac_f32_16x16x64_bf16 v[32:35], v[40:43], v[72:79], v6
    ds_read_b128 v[72:75], v3 offset:2048
    v_smfmac_f32_16x16x64_bf16 v[28:31], v[44:47], a[40:47], v6
    ds_read_b128 v[76:79], v3 offset:3072
    s_waitcnt lgkmcnt(5)
    v_smfmac_f32_16x16x64_bf16 v[32:35], v[44:47], v[80:87], v6
    ds_read_b128 v[80:83], v3 offset:16384
    v_smfmac_f32_16x16x64_bf16 v[28:31], v[48:51], a[48:55], v6
    ds_read_b128 v[84:87], v3 offset:17408
    s_waitcnt lgkmcnt(4)
    v_smfmac_f32_16x16x64_bf16 v[32:35], v[48:51], v[88:95], v6
    ds_read_b128 v[88:91], v3 offset:18432
    global_store_dwordx4 v0, v[96:99], s[16:17] offset:1024
    v_smfmac_f32_16x16x64_bf16 v[28:31], v[52:55], a[56:63], v6
    ds_read_b128 v[92:95], v3 offset:19456
    s_waitcnt lgkmcnt(4)
    v_smfmac_f32_16x16x64_bf16 v[32:35], v[52:55], v[72:79], v6
    ds_read_b128 v[72:75], v3 offset:32768
    v_smfmac_f32_16x16x64_bf16 v[28:31], v[56:59], a[64:71], v6
    ds_read_b128 v[76:79], v3 offset:33792
    s_waitcnt lgkmcnt(4)
    v_smfmac_f32_16x16x64_bf16 v[32:35], v[56:59], v[80:87], v6
    ds_read_b128 v[68:71], v1 offset:5632
    v_smfmac_f32_16x16x64_bf16 v[28:31], v[60:63], a[72:79], v6
    ds_read_b128 v[80:83], v3 offset:34816
    s_waitcnt lgkmcnt(4)
    v_smfmac_f32_16x16x64_bf16 v[32:35], v[60:63], v[88:95], v6
    ds_read_b128 v[84:87], v3 offset:35840
    v_smfmac_f32_16x16x64_bf16 v[28:31], v[64:67], a[80:87], v6
    ds_read_b128 v[88:91], v0 offset:16384
    s_waitcnt lgkmcnt(4)
    v_smfmac_f32_16x16x64_bf16 v[32:35], v[64:67], v[72:79], v6
    ds_read_b128 v[92:95], v0 offset:20480
    s_waitcnt lgkmcnt(4)
    v_smfmac_f32_16x16x64_bf16 v[28:31], v[68:71], a[88:95], v6
    ds_read_b128 v[72:75], v0 offset:17408
    s_waitcnt lgkmcnt(3)
    v_smfmac_f32_16x16x64_bf16 v[32:35], v[68:71], v[80:87], v6
    ds_read_b128 v[76:79], v0 offset:21504
    v_smfmac_f32_16x16x64_bf16 v[36:39], v[40:43], a[176:183], v6
    ds_read_b128 v[80:83], v0 offset:18432
    v_smfmac_f32_16x16x64_bf16 v[36:39], v[44:47], a[184:191], v6
    ds_read_b128 v[84:87], v0 offset:22528
    v_cvt_pk_bf16_f32 v14, v28, v29
    v_cvt_pk_bf16_f32 v15, v30, v31
    v_cvt_pk_bf16_f32 v16, v32, v33
    v_cvt_pk_bf16_f32 v17, v34, v35
    ds_write_b128 v7, v[14:17]
    ds_read_b64_tr_b16 v[108:109], v8 offset:27648
    ds_read_b64_tr_b16 v[110:111], v8 offset:28160
    v_smfmac_f32_16x16x64_bf16 v[36:39], v[48:51], a[192:199], v6
    ds_read_b128 v[28:31], v0 offset:19456
    v_smfmac_f32_16x16x64_bf16 v[36:39], v[56:59], a[208:215], v6
    ds_read_b128 v[32:35], v0 offset:23552
    v_smfmac_f32_16x16x64_bf16 v[36:39], v[60:63], a[216:223], v6
    v_smfmac_f32_16x16x64_bf16 v[36:39], v[52:55], a[200:207], v6
    s_waitcnt lgkmcnt(4)
    s_barrier
    ds_read_b64_tr_b16 v[96:97], v8 offset:24576
    ds_read_b64_tr_b16 v[98:99], v8 offset:25088
    ds_read_b64_tr_b16 v[100:101], v8 offset:25600
    ds_read_b64_tr_b16 v[102:103], v8 offset:26112
    ds_read_b64_tr_b16 v[104:105], v8 offset:26624
    ds_read_b64_tr_b16 v[106:107], v8 offset:27136
    v_smfmac_f32_16x16x64_bf16 v[36:39], v[64:67], a[224:231], v6
    v_smfmac_f32_16x16x64_bf16 v[36:39], v[68:71], a[232:239], v6
    s_waitcnt lgkmcnt(8)
    v_mfma_f32_16x16x32_bf16 v[48:51], v[108:111], v[108:111], v[24:27]
    v_mov_b64 v[52:53], s[62:63]
    v_mov_b64 v[54:55], s[62:63]
    s_waitcnt lgkmcnt(7)
    v_mfma_f32_16x16x32_bf16 v[40:43], v[28:31], v[108:111], 0
    s_waitcnt lgkmcnt(6)
    v_mfma_f32_16x16x32_bf16 v[44:47], v[32:35], v[108:111], 0
    v_cvt_pk_bf16_f32 v18, v36, v37
    v_cvt_pk_bf16_f32 v19, v38, v39
    s_waitcnt lgkmcnt(4)
    v_mfma_f32_16x16x32_bf16 v[48:51], v[96:99], v[96:99], v[48:51]
    v_mov_b64 v[36:37], v[18:19]
    v_mov_b64 v[38:39], v[18:19]
    v_mfma_f32_16x16x32_bf16 v[40:43], v[88:91], v[96:99], v[40:43]
    v_mfma_f32_16x16x32_bf16 v[44:47], v[92:95], v[96:99], v[44:47]
    v_permlane32_swap_b32 v36, v38
    s_waitcnt lgkmcnt(2)
    v_mfma_f32_16x16x32_bf16 v[48:51], v[100:103], v[100:103], v[48:51]
    v_permlane32_swap_b32 v37, v39
    v_mfma_f32_16x16x32_bf16 v[40:43], v[72:75], v[100:103], v[40:43]
    v_mfma_f32_16x16x32_bf16 v[44:47], v[76:79], v[100:103], v[44:47]
    s_waitcnt lgkmcnt(0)
    v_mfma_f32_16x16x32_bf16 v[48:51], v[104:107], v[104:107], v[48:51]
    v_mfma_f32_16x16x32_bf16 v[40:43], v[80:83], v[104:107], v[40:43]
    global_store_dwordx4 v0, v[16:19], s[60:61] sc1
    v_mfma_f32_16x16x32_bf16 v[44:47], v[84:87], v[104:107], v[44:47]
    s_add_u32 s60, s60, 4096
    s_addc_u32 s61, s61, 0
    s_cmp_ge_u32 s68, 63
    s_cbranch_scc1 Ldn_61
    ds_read_b128 v[72:75], v12 offset:0
    v_max3_f32 v14, v48, v49, v50
    v_max3_f32 v14, v14, v51, v40
    v_max3_f32 v15, v41, v42, v43
    v_max3_f32 v14, v14, v44, v45
    v_max3_f32 v15, v15, v46, v47
    v_max_f32 v14, v14, v15
    v_mov_b32 v15, v14
    v_mov_b64 v[56:57], 0
    v_mov_b64 v[58:59], 0
    ds_read_b128 v[76:79], v12 offset:1024
    v_permlane32_swap_b32 v14, v15
    v_max_f32 v14, v14, v15
    v_mov_b32 v15, v14
    v_mov_b64 v[60:61], 0
    v_mov_b64 v[62:63], 0
    ds_read_b128 v[80:83], v12 offset:2048
    v_permlane16_swap_b32 v14, v15
    v_max_f32 v14, v14, v15
    v_mul_f32 v14, s69, v14
    v_pk_fma_f32 v[40:41], v[40:41], s[80:81], v[14:15] op_sel_hi:[1,1,0] neg_lo:[0,0,1] neg_hi:[0,0,1]
    v_pk_fma_f32 v[42:43], v[42:43], s[80:81], v[14:15] op_sel_hi:[1,1,0] neg_lo:[0,0,1] neg_hi:[0,0,1]
    v_pk_fma_f32 v[44:45], v[44:45], s[80:81], v[14:15] op_sel_hi:[1,1,0] neg_lo:[0,0,1] neg_hi:[0,0,1]
    v_pk_fma_f32 v[46:47], v[46:47], s[80:81], v[14:15] op_sel_hi:[1,1,0] neg_lo:[0,0,1] neg_hi:[0,0,1]
    v_exp_f32 v40, v40
    v_exp_f32 v41, v41
    v_exp_f32 v42, v42
    v_exp_f32 v43, v43
    v_exp_f32 v44, v44
    v_exp_f32 v45, v45
    v_exp_f32 v46, v46
    v_exp_f32 v47, v47
    v_pk_fma_f32 v[48:49], v[48:49], s[80:81], v[14:15] op_sel_hi:[1,1,0] neg_lo:[0,0,1] neg_hi:[0,0,1]
    v_pk_fma_f32 v[50:51], v[50:51], s[80:81], v[14:15] op_sel_hi:[1,1,0] neg_lo:[0,0,1] neg_hi:[0,0,1]
    v_cvt_pk_bf16_f32 v96, v40, v41
    v_cvt_pk_bf16_f32 v97, v42, v43
    v_cvt_pk_bf16_f32 v98, v44, v45
    v_cvt_pk_bf16_f32 v99, v46, v47
    v_exp_f32 v48, v48
    s_nop 0
    v_mfma_f32_16x16x32_bf16 v[40:43], v[52:55], v[96:99], 0
    ds_read_b128 v[84:87], v12 offset:3072
    v_exp_f32 v49, v49
    v_mfma_f32_16x16x32_bf16 v[28:31], v[120:123], v[96:99], 0
    v_exp_f32 v50, v50
    v_mfma_f32_16x16x32_bf16 v[32:35], v[124:127], v[96:99], 0
    v_exp_f32 v51, v51
    v_cvt_pk_bf16_f32 v100, v48, v49
    v_cvt_pk_bf16_f32 v101, v50, v51
    v_mov_b64 v[64:65], 0
    v_mov_b64 v[66:67], 0
    v_mfma_f32_16x16x16_bf16 v[40:43], v[52:53], v[100:101], v[40:43]
    v_mov_b64 v[68:69], 0
    v_mov_b64 v[70:71], 0
    v_mfma_f32_16x16x16_bf16 v[28:31], v[36:37], v[100:101], v[28:31]
    v_mfma_f32_16x16x16_bf16 v[32:35], v[38:39], v[100:101], v[32:35]
    v_rcp_f32 v14, v40
    s_mov_b32 exec_lo, 0xff00ff00
    s_mov_b32 exec_hi, 0xff00ff00
    s_nop 0
    v_pk_mul_f32 v[28:29], v[28:29], v[14:15] op_sel_hi:[1,0]
    v_pk_mul_f32 v[30:31], v[30:31], v[14:15] op_sel_hi:[1,0]
    v_cvt_pk_bf16_f32 v88, v28, v29
    v_cvt_pk_bf16_f32 v89, v30, v31
    v_pk_mul_f32 v[32:33], v[32:33], v[14:15] op_sel_hi:[1,0]
    v_pk_mul_f32 v[34:35], v[34:35], v[14:15] op_sel_hi:[1,0]
    v_cvt_pk_bf16_f32 v90, v32, v33
    v_cvt_pk_bf16_f32 v91, v34, v35
    ds_write_b128 v9, v[88:91]
    s_mov_b64 exec, -1
    v_mov_b32_dpp v88, v88 row_ror:8 row_mask:0xf bank_mask:0x3
    v_mov_b32_dpp v89, v89 row_ror:8 row_mask:0xf bank_mask:0x3
    v_mov_b32_dpp v90, v90 row_ror:8 row_mask:0xf bank_mask:0x3
    v_mov_b32_dpp v91, v91 row_ror:8 row_mask:0xf bank_mask:0x3
    s_nop 1
    v_smfmac_f32_16x16x64_bf16 v[56:59], v[88:91], v[200:207], v6
    v_smfmac_f32_16x16x64_bf16 v[60:63], v[88:91], v[216:223], v6
    s_waitcnt vmcnt(8) lgkmcnt(0)
    s_barrier
    ds_read_b128 v[96:99], v1 offset:28672
    ds_read_b128 v[100:103], v1 offset:29184
    ds_read_b128 v[104:107], v1 offset:29696
    v_smfmac_f32_16x16x64_bf16 v[64:67], v[88:91], v[232:239], v6
    v_smfmac_f32_16x16x64_bf16 v[68:71], v[88:91], v[248:255], v6
    s_waitcnt lgkmcnt(2)
    v_smfmac_f32_16x16x64_bf16 v[56:59], v[96:99], v[72:79], v6
    v_smfmac_f32_16x16x64_bf16 v[60:63], v[96:99], v[144:151], v6
    s_waitcnt lgkmcnt(1)
    v_smfmac_f32_16x16x64_bf16 v[56:59], v[100:103], v[80:87], v6
    v_smfmac_f32_16x16x64_bf16 v[60:63], v[100:103], v[152:159], v6
    s_waitcnt lgkmcnt(0)
    v_smfmac_f32_16x16x64_bf16 v[56:59], v[104:107], v[192:199], v6
    v_smfmac_f32_16x16x64_bf16 v[60:63], v[104:107], v[208:215], v6
    v_smfmac_f32_16x16x64_bf16 v[64:67], v[96:99], v[160:167], v6
    v_smfmac_f32_16x16x64_bf16 v[68:71], v[96:99], v[176:183], v6
    v_cvt_pk_bf16_f32 v40, v56, v60
    v_smfmac_f32_16x16x64_bf16 v[64:67], v[100:103], v[168:175], v6
    v_cvt_pk_bf16_f32 v41, v57, v61
    v_smfmac_f32_16x16x64_bf16 v[68:71], v[100:103], v[184:191], v6
    v_cvt_pk_bf16_f32 v42, v58, v62
    v_smfmac_f32_16x16x64_bf16 v[64:67], v[104:107], v[224:231], v6
    v_cvt_pk_bf16_f32 v43, v59, v63
    v_smfmac_f32_16x16x64_bf16 v[68:71], v[104:107], v[240:247], v6
    global_store_dwordx4 v10, v[40:43], s[50:51]
    s_nop 6
    v_cvt_pk_bf16_f32 v44, v64, v68
    v_cvt_pk_bf16_f32 v45, v65, v69
    v_cvt_pk_bf16_f32 v46, v66, v70
    v_cvt_pk_bf16_f32 v47, v67, v71
    global_store_dwordx4 v10, v[44:47], s[54:55]
    s_waitcnt vmcnt(1)
    ds_read_b128 v[72:75], v3 offset:49152
    ds_read_b128 v[76:79], v3 offset:50176
    ds_read_b128 v[80:83], v3 offset:51200
    ds_read_b128 v[84:87], v3 offset:52224
    ds_read_b128 v[88:91], v12 offset:16384
    ds_read_b128 v[92:95], v12 offset:17408
    global_load_dwordx4 v[48:51], v0, s[18:19] offset:0 sc1
    global_load_dwordx4 v[52:55], v0, s[18:19] offset:1024 sc1
    s_sleep 2
    global_load_dwordx4 v[64:67], v0, s[18:19] offset:0 sc1
    global_load_dwordx4 v[68:71], v0, s[18:19] offset:1024 sc1
    v_mov_b64 v[28:29], 0
    v_mov_b64 v[30:31], 0
    v_mov_b64 v[32:33], 0
    v_mov_b64 v[34:35], 0
    v_mov_b64 v[36:37], 0
    v_mov_b64 v[38:39], 0
    v_mov_b64 v[96:97], -1
    v_mov_b64 v[98:99], -1
    s_waitcnt vmcnt(2)
    v_mfma_f32_16x16x32_bf16 v[100:103], v[20:23], v[48:51], 0
    v_max3_u32 v14, v48, v49, v50
    v_mfma_f32_16x16x32_bf16 v[100:103], v[20:23], v[52:55], v[100:103]
    v_max3_u32 v15, v51, v52, v53
    v_max3_u32 v14, v14, v54, v55
    v_max_u32 v14, v14, v15
    v_cmp_eq_u32 vcc, -1, v14
    s_cbranch_vccnz LlB_70
LokB_71:
    s_nop 2
    v_add_f32_dpp v100, v100, v100 row_ror:4 row_mask:0xf bank_mask:0xf
    v_add_f32_dpp v101, v101, v101 row_ror:4 row_mask:0xf bank_mask:0xf
    v_add_f32_dpp v102, v102, v102 row_ror:4 row_mask:0xf bank_mask:0xf
    v_add_f32_dpp v103, v103, v103 row_ror:4 row_mask:0xf bank_mask:0xf
    v_add_f32_dpp v100, v100, v100 row_ror:8 row_mask:0xf bank_mask:0xf
    v_add_f32_dpp v101, v101, v101 row_ror:8 row_mask:0xf bank_mask:0xf
    v_add_f32_dpp v102, v102, v102 row_ror:8 row_mask:0xf bank_mask:0xf
    v_add_f32_dpp v103, v103, v103 row_ror:8 row_mask:0xf bank_mask:0xf
    v_cvt_pk_bf16_f32 v100, v100, v101
    v_cvt_pk_bf16_f32 v101, v102, v103
    v_cndmask_b32 v100, v100, v101, s[70:71]
    s_mov_b64 exec, 0x00ff00ff
    global_store_dword v11, v100, s[44:45]
    s_mov_b64 exec, -1
    s_add_u32 s68, s68, 1
    s_add_u32 s64, s68, 2
    s_cmp_lt_u32 s64, s76
    s_cbranch_scc1 Lrec_60
Lrs_72:
Lrdy_73:
    global_load_dword v5, v4, s[42:43] sc1
    s_add_u32 s77, s77, 1
    s_cmp_gt_u32 s77, 0x100000
    s_cbranch_scc1 Lrec_60
    s_waitcnt vmcnt(0)
    v_cmp_le_u32 s[74:75], 32, v5
    s_nop 0
    s_ff0_i32_b64 s76, s[74:75]
    s_add_u32 s64, s68, 2
    s_cmp_lt_u32 s64, s76
    s_cbranch_scc0 Lrdy_73
    s_branch Lrec_60
Ldn_61:
    s_waitcnt vmcnt(0)
    s_mov_b64 exec, 1
    global_store_dword v0, v6, s[36:37] sc1
    s_mov_b64 exec, -1
    s_add_u32 s36, s36, 4096
    s_addc_u32 s37, s37, 0
    s_endpgm
LslA_64:
    s_mov_b64 exec, vcc
    global_load_dwordx4 v[104:107], v2, s[44:45] offset:0 sc1
    global_load_dwordx4 v[108:111], v2, s[44:45] offset:1024 sc1
    s_mov_b64 exec, -1
    s_waitcnt vmcnt(2)
    ds_write_b128 v2, v[64:67] offset:0
    ds_write_b128 v2, v[68:71] offset:1024
    v_max3_u32 v14, v64, v65, v66
    v_max3_u32 v15, v67, v68, v69
    v_max3_u32 v14, v14, v70, v71
    v_max_u32 v14, v14, v15
    v_cmp_eq_u32 vcc, -1, v14
    s_cbranch_vccz LokA_63
    s_mov_b64 exec, vcc
    global_load_dwordx4 v[64:67], v2, s[44:45] offset:0 sc1
    global_load_dwordx4 v[68:71], v2, s[44:45] offset:1024 sc1
    s_mov_b64 exec, -1
    s_waitcnt vmcnt(2)
    ds_write_b128 v2, v[104:107] offset:0
    ds_write_b128 v2, v[108:111] offset:1024
    v_max3_u32 v14, v104, v105, v106
    v_max3_u32 v15, v107, v108, v109
    v_max3_u32 v14, v14, v110, v111
    v_max_u32 v14, v14, v15
    v_cmp_eq_u32 vcc, -1, v14
    s_cbranch_vccz LokA_63
    s_add_u32 s77, s77, 1
    s_cmp_lt_u32 s77, 0x80000
    s_cbranch_scc1 LslA_64
    s_branch LokA_63
LlB_65:
    s_mov_b64 exec, vcc
    global_load_dwordx4 v[48:51], v0, s[16:17] offset:0 sc1
    global_load_dwordx4 v[52:55], v0, s[16:17] offset:1024 sc1
    s_mov_b64 exec, -1
    s_waitcnt vmcnt(2)
    v_mfma_f32_16x16x32_bf16 v[100:103], v[20:23], v[64:67], 0
    v_max3_u32 v14, v64, v65, v66
    v_mfma_f32_16x16x32_bf16 v[100:103], v[20:23], v[68:71], v[100:103]
    v_max3_u32 v15, v67, v68, v69
    v_max3_u32 v14, v14, v70, v71
    v_max_u32 v14, v14, v15
    v_cmp_eq_u32 vcc, -1, v14
    s_cbranch_vccz LokB_66
    s_mov_b64 exec, vcc
    global_load_dwordx4 v[64:67], v0, s[16:17] offset:0 sc1
    global_load_dwordx4 v[68:71], v0, s[16:17] offset:1024 sc1
    s_mov_b64 exec, -1
    s_waitcnt vmcnt(2)
    v_mfma_f32_16x16x32_bf16 v[100:103], v[20:23], v[48:51], 0
    v_max3_u32 v14, v48, v49, v50
    v_mfma_f32_16x16x32_bf16 v[100:103], v[20:23], v[52:55], v[100:103]
    v_max3_u32 v15, v51, v52, v53
    v_max3_u32 v14, v14, v54, v55
    v_max_u32 v14, v14, v15
    v_cmp_eq_u32 vcc, -1, v14
    s_cbranch_vccz LokB_66
    s_add_u32 s77, s77, 1
    s_cmp_lt_u32 s77, 0x80000
    s_cbranch_scc1 LlB_65
    s_branch LokB_66
LslA_69:
    s_mov_b64 exec, vcc
    global_load_dwordx4 v[104:107], v2, s[46:47] offset:0 sc1
    global_load_dwordx4 v[108:111], v2, s[46:47] offset:1024 sc1
    s_mov_b64 exec, -1
    s_waitcnt vmcnt(2)
    ds_write_b128 v2, v[64:67] offset:0
    ds_write_b128 v2, v[68:71] offset:1024
    v_max3_u32 v14, v64, v65, v66
    v_max3_u32 v15, v67, v68, v69
    v_max3_u32 v14, v14, v70, v71
    v_max_u32 v14, v14, v15
    v_cmp_eq_u32 vcc, -1, v14
    s_cbranch_vccz LokA_68
    s_mov_b64 exec, vcc
    global_load_dwordx4 v[64:67], v2, s[46:47] offset:0 sc1
    global_load_dwordx4 v[68:71], v2, s[46:47] offset:1024 sc1
    s_mov_b64 exec, -1
    s_waitcnt vmcnt(2)
    ds_write_b128 v2, v[104:107] offset:0
    ds_write_b128 v2, v[108:111] offset:1024
    v_max3_u32 v14, v104, v105, v106
    v_max3_u32 v15, v107, v108, v109
    v_max3_u32 v14, v14, v110, v111
    v_max_u32 v14, v14, v15
    v_cmp_eq_u32 vcc, -1, v14
    s_cbranch_vccz LokA_68
    s_add_u32 s77, s77, 1
    s_cmp_lt_u32 s77, 0x80000
    s_cbranch_scc1 LslA_69
    s_branch LokA_68
LlB_70:
    s_mov_b64 exec, vcc
    global_load_dwordx4 v[48:51], v0, s[18:19] offset:0 sc1
    global_load_dwordx4 v[52:55], v0, s[18:19] offset:1024 sc1
    s_mov_b64 exec, -1
    s_waitcnt vmcnt(2)
    v_mfma_f32_16x16x32_bf16 v[100:103], v[20:23], v[64:67], 0
    v_max3_u32 v14, v64, v65, v66
    v_mfma_f32_16x16x32_bf16 v[100:103], v[20:23], v[68:71], v[100:103]
    v_max3_u32 v15, v67, v68, v69
    v_max3_u32 v14, v14, v70, v71
    v_max_u32 v14, v14, v15
    v_cmp_eq_u32 vcc, -1, v14
    s_cbranch_vccz LokB_71
    s_mov_b64 exec, vcc
    global_load_dwordx4 v[64:67], v0, s[18:19] offset:0 sc1
    global_load_dwordx4 v[68:71], v0, s[18:19] offset:1024 sc1
    s_mov_b64 exec, -1
    s_waitcnt vmcnt(2)
    v_mfma_f32_16x16x32_bf16 v[100:103], v[20:23], v[48:51], 0
    v_max3_u32 v14, v48, v49, v50
    v_mfma_f32_16x16x32_bf16 v[100:103], v[20:23], v[52:55], v[100:103]
    v_max3_u32 v15, v51, v52, v53
    v_max3_u32 v14, v14, v54, v55
    v_max_u32 v14, v14, v15
    v_cmp_eq_u32 vcc, -1, v14
    s_cbranch_vccz LokB_71
    s_add_u32 s77, s77, 1
    s_cmp_lt_u32 s77, 0x80000
    s_cbranch_scc1 LlB_70
    s_branch LokB_71
Lremote_10:
    ds_read_b128 v[72:75], v12 offset:16384
    ds_read_b128 v[76:79], v12 offset:17408
    ds_read_b128 v[80:83], v12 offset:18432
    ds_read_b128 v[84:87], v12 offset:19456
    ds_read_b128 v[88:91], v12 offset:32768
    ds_read_b128 v[92:95], v12 offset:33792
    v_mov_b64 v[28:29], 0
    v_mov_b64 v[30:31], 0
    v_mov_b64 v[32:33], 0
    v_mov_b64 v[34:35], 0
    v_mov_b64 v[36:37], 0
    v_mov_b64 v[38:39], 0
    v_mov_b64 v[96:97], -1
    v_mov_b64 v[98:99], -1
Lrec_74:
    s_waitcnt vmcnt(0)
    global_load_dwordx4 v[104:107], v2, s[44:45] offset:0 sc1
    global_load_dwordx4 v[108:111], v2, s[44:45] offset:1024 sc1
    s_sleep 2
    global_load_dwordx4 v[64:67], v2, s[44:45] offset:0 sc1
    global_load_dwordx4 v[68:71], v2, s[44:45] offset:1024 sc1
    s_waitcnt vmcnt(2)
    ds_write_b128 v2, v[104:107] offset:0
    ds_write_b128 v2, v[108:111] offset:1024
    v_max3_u32 v14, v104, v105, v106
    v_max3_u32 v15, v107, v108, v109
    v_max3_u32 v14, v14, v110, v111
    v_max_u32 v14, v14, v15
    v_cmp_eq_u32 vcc, -1, v14
    s_cbranch_vccnz LslA_77
LokA_76:
    s_waitcnt lgkmcnt(0)
    s_barrier
    ds_read_b128 v[40:43], v1 offset:0
    ds_read_b128 v[44:47], v1 offset:512
    ds_read_b128 v[48:51], v1 offset:1024
    ds_read_b128 v[52:55], v1 offset:1536
    s_waitcnt vmcnt(0)
    ds_read_b128 v[56:59], v1 offset:2048
    ds_read_b128 v[60:63], v1 offset:2560
    ds_read_b128 v[64:67], v1 offset:3072
    ds_read_b128 v[68:71], v1 offset:3584
    s_mov_b64 exec, 0x00ff00ff
    global_store_dword v11, v96, s[46:47] sc1
    s_mov_b64 exec, -1
    s_waitcnt lgkmcnt(7)
    v_smfmac_f32_16x16x64_bf16 v[28:31], v[40:43], a[0:7], v6
    s_add_u32 m0, s78, 8192
    global_load_dwordx4 v[120:123], v0, s[58:59] sc1
    v_smfmac_f32_16x16x64_bf16 v[36:39], v[40:43], a[144:151], v6
    global_load_lds_dwordx4 v0, s[56:57] sc1
    v_smfmac_f32_16x16x64_bf16 v[32:35], v[40:43], v[72:79], v6
    ds_read_b128 v[72:75], v12 offset:34816
    global_load_lds_dwordx4 v0, s[56:57] offset:1024 sc1
    s_waitcnt lgkmcnt(7)
    v_smfmac_f32_16x16x64_bf16 v[28:31], v[44:47], a[8:15], v6
    ds_read_b128 v[76:79], v12 offset:35840
    global_load_dwordx4 v[124:127], v0, s[58:59] offset:1024 sc1
    v_smfmac_f32_16x16x64_bf16 v[36:39], v[44:47], a[152:159], v6
    ds_read_b128 v[40:43], v1 offset:4096
    s_add_u32 s56, s56, 8192
    s_addc_u32 s57, s57, 0
    v_smfmac_f32_16x16x64_bf16 v[32:35], v[44:47], v[80:87], v6
    ds_read_b128 v[80:83], v12 offset:49152
    s_add_u32 s58, s58, 8192
    s_addc_u32 s59, s59, 0
    s_waitcnt lgkmcnt(9)
    v_smfmac_f32_16x16x64_bf16 v[28:31], v[48:51], a[16:23], v6
    s_mov_b64 exec, 1
    global_store_dword v0, v6, s[36:37] sc1
    s_mov_b64 exec, -1
    v_smfmac_f32_16x16x64_bf16 v[36:39], v[48:51], a[160:167], v6
    ds_read_b128 v[84:87], v12 offset:50176
    s_add_u32 s36, s36, 4096
    s_addc_u32 s37, s37, 0
    v_smfmac_f32_16x16x64_bf16 v[32:35], v[48:51], v[88:95], v6
    ds_read_b128 v[88:91], v12 offset:51200
    global_store_dwordx4 v0, v[96:99], s[18:19] sc1
    s_waitcnt lgkmcnt(10)
    v_smfmac_f32_16x16x64_bf16 v[28:31], v[52:55], a[24:31], v6
    ds_read_b128 v[92:95], v12 offset:52224
    v_smfmac_f32_16x16x64_bf16 v[36:39], v[52:55], a[168:175], v6
    ds_read_b128 v[44:47], v1 offset:4608
    s_waitcnt lgkmcnt(6)
    v_smfmac_f32_16x16x64_bf16 v[32:35], v[52:55], v[72:79], v6
    ds_read_b128 v[72:75], v3 offset:0
    v_smfmac_f32_16x16x64_bf16 v[28:31], v[56:59], a[32:39], v6
    ds_read_b128 v[76:79], v3 offset:1024
    v_smfmac_f32_16x16x64_bf16 v[36:39], v[56:59], a[176:183], v6
    ds_read_b128 v[48:51], v1 offset:5120
    s_waitcnt lgkmcnt(6)
    v_smfmac_f32_16x16x64_bf16 v[32:35], v[56:59], v[80:87], v6
    ds_read_b128 v[80:83], v3 offset:2048
    v_smfmac_f32_16x16x64_bf16 v[28:31], v[60:63], a[40:47], v6
    ds_read_b128 v[84:87], v3 offset:3072
    v_smfmac_f32_16x16x64_bf16 v[36:39], v[60:63], a[184:191], v6
    ds_read_b128 v[52:55], v1 offset:5632
    global_store_dwordx4 v0, v[96:99], s[18:19] offset:1024 sc1
    s_waitcnt lgkmcnt(7)
    v_smfmac_f32_16x16x64_bf16 v[32:35], v[60:63], v[88:95], v6
    ds_read_b128 v[88:91], v3 offset:16384
    v_smfmac_f32_16x16x64_bf16 v[28:31], v[64:67], a[48:55], v6
    ds_read_b128 v[92:95], v3 offset:17408
    v_smfmac_f32_16x16x64_bf16 v[36:39], v[64:67], a[192:199], v6
    ds_read_b128 v[56:59], v1 offset:6144
    s_waitcnt lgkmcnt(7)
    v_smfmac_f32_16x16x64_bf16 v[32:35], v[64:67], v[72:79], v6
    ds_read_b128 v[72:75], v3 offset:18432
    v_smfmac_f32_16x16x64_bf16 v[28:31], v[68:71], a[56:63], v6
    ds_read_b128 v[76:79], v3 offset:19456
    v_smfmac_f32_16x16x64_bf16 v[36:39], v[68:71], a[200:207], v6
    ds_read_b128 v[60:63], v1 offset:6656
    s_waitcnt lgkmcnt(7)
    v_smfmac_f32_16x16x64_bf16 v[32:35], v[68:71], v[80:87], v6
    ds_read_b128 v[80:83], v3 offset:32768
    v_smfmac_f32_16x16x64_bf16 v[28:31], v[40:43], a[64:71], v6
    ds_read_b128 v[84:87], v3 offset:33792
    s_waitcnt lgkmcnt(6)
    v_smfmac_f32_16x16x64_bf16 v[32:35], v[40:43], v[88:95], v6
    ds_read_b128 v[88:91], v3 offset:34816
    v_smfmac_f32_16x16x64_bf16 v[28:31], v[44:47], a[72:79], v6
    ds_read_b128 v[92:95], v3 offset:35840
    s_waitcnt lgkmcnt(5)
    v_smfmac_f32_16x16x64_bf16 v[32:35], v[44:47], v[72:79], v6
    ds_read_b128 v[72:75], v3 offset:49152
    v_smfmac_f32_16x16x64_bf16 v[28:31], v[48:51], a[80:87], v6
    ds_read_b128 v[76:79], v3 offset:50176
    s_waitcnt lgkmcnt(4)
    v_smfmac_f32_16x16x64_bf16 v[32:35], v[48:51], v[80:87], v6
    ds_read_b128 v[80:83], v3 offset:51200
    v_smfmac_f32_16x16x64_bf16 v[28:31], v[52:55], a[88:95], v6
    ds_read_b128 v[84:87], v3 offset:52224
    s_waitcnt lgkmcnt(4)
    v_smfmac_f32_16x16x64_bf16 v[32:35], v[52:55], v[88:95], v6
    ds_read_b128 v[64:67], v1 offset:7168
    v_smfmac_f32_16x16x64_bf16 v[28:31], v[56:59], a[96:103], v6
    ds_read_b128 v[68:71], v1 offset:7680
    s_waitcnt lgkmcnt(4)
    v_smfmac_f32_16x16x64_bf16 v[32:35], v[56:59], v[72:79], v6
    ds_read_b128 v[88:91], v0 offset:8192
    v_smfmac_f32_16x16x64_bf16 v[28:31], v[60:63], a[104:111], v6
    ds_read_b128 v[92:95], v0 offset:12288
    s_waitcnt lgkmcnt(4)
    v_smfmac_f32_16x16x64_bf16 v[32:35], v[60:63], v[80:87], v6
    ds_read_b128 v[72:75], v0 offset:9216
    s_waitcnt lgkmcnt(4)
    v_smfmac_f32_16x16x64_bf16 v[28:31], v[64:67], a[112:119], v6
    ds_read_b128 v[76:79], v0 offset:13312
    v_smfmac_f32_16x16x64_bf16 v[32:35], v[64:67], a[128:135], v6
    ds_read_b128 v[80:83], v0 offset:10240
    s_waitcnt lgkmcnt(5)
    v_smfmac_f32_16x16x64_bf16 v[28:31], v[68:71], a[120:127], v6
    ds_read_b128 v[84:87], v0 offset:14336
    v_smfmac_f32_16x16x64_bf16 v[32:35], v[68:71], a[136:143], v6
    v_smfmac_f32_16x16x64_bf16 v[36:39], v[40:43], a[208:215], v6
    v_smfmac_f32_16x16x64_bf16 v[36:39], v[44:47], a[216:223], v6
    v_cvt_pk_bf16_f32 v14, v28, v29
    v_cvt_pk_bf16_f32 v15, v30, v31
    v_cvt_pk_bf16_f32 v16, v32, v33
    v_cvt_pk_bf16_f32 v17, v34, v35
    ds_write_b128 v7, v[14:17]
    v_smfmac_f32_16x16x64_bf16 v[36:39], v[48:51], a[224:231], v6
    ds_read_b128 v[28:31], v0 offset:11264
    v_smfmac_f32_16x16x64_bf16 v[36:39], v[56:59], a[240:247], v6
    ds_read_b128 v[32:35], v0 offset:15360
    v_smfmac_f32_16x16x64_bf16 v[36:39], v[60:63], a[248:255], v6
    s_waitcnt lgkmcnt(2)
    s_barrier
    ds_read_b64_tr_b16 v[96:97], v8 offset:24576
    ds_read_b64_tr_b16 v[98:99], v8 offset:25088
    ds_read_b64_tr_b16 v[100:101], v8 offset:25600
    ds_read_b64_tr_b16 v[102:103], v8 offset:26112
    ds_read_b64_tr_b16 v[104:105], v8 offset:26624
    ds_read_b64_tr_b16 v[106:107], v8 offset:27136
    ds_read_b64_tr_b16 v[108:109], v8 offset:27648
    ds_read_b64_tr_b16 v[110:111], v8 offset:28160
    v_smfmac_f32_16x16x64_bf16 v[36:39], v[52:55], a[232:239], v6
    v_smfmac_f32_16x16x64_bf16 v[36:39], v[64:67], v[128:135], v6
    v_smfmac_f32_16x16x64_bf16 v[36:39], v[68:71], v[136:143], v6
    s_waitcnt lgkmcnt(6)
    v_mfma_f32_16x16x32_bf16 v[48:51], v[96:99], v[96:99], v[24:27]
    v_mov_b64 v[52:53], s[62:63]
    v_mov_b64 v[54:55], s[62:63]
    v_mfma_f32_16x16x32_bf16 v[40:43], v[88:91], v[96:99], 0
    v_mfma_f32_16x16x32_bf16 v[44:47], v[92:95], v[96:99], 0
    v_cvt_pk_bf16_f32 v18, v36, v37
    v_cvt_pk_bf16_f32 v19, v38, v39
    s_waitcnt lgkmcnt(4)
    v_mfma_f32_16x16x32_bf16 v[48:51], v[100:103], v[100:103], v[48:51]
    v_mov_b64 v[36:37], v[18:19]
    v_mov_b64 v[38:39], v[18:19]
    v_mfma_f32_16x16x32_bf16 v[40:43], v[72:75], v[100:103], v[40:43]
    v_mfma_f32_16x16x32_bf16 v[44:47], v[76:79], v[100:103], v[44:47]
    v_permlane32_swap_b32 v36, v38
    s_waitcnt lgkmcnt(2)
    v_mfma_f32_16x16x32_bf16 v[48:51], v[104:107], v[104:107], v[48:51]
    v_permlane32_swap_b32 v37, v39
    v_mfma_f32_16x16x32_bf16 v[40:43], v[80:83], v[104:107], v[40:43]
    global_store_dwordx4 v0, v[16:19], s[60:61] sc1
    v_mfma_f32_16x16x32_bf16 v[44:47], v[84:87], v[104:107], v[44:47]
    s_waitcnt lgkmcnt(0)
    v_mfma_f32_16x16x32_bf16 v[48:51], v[108:111], v[108:111], v[48:51]
    v_mfma_f32_16x16x32_bf16 v[40:43], v[28:31], v[108:111], v[40:43]
    v_mfma_f32_16x16x32_bf16 v[44:47], v[32:35], v[108:111], v[44:47]
    s_add_u32 s60, s60, 4096
    s_addc_u32 s61, s61, 0
    ds_read_b128 v[72:75], v12 offset:0
    v_max3_f32 v14, v48, v49, v50
    v_max3_f32 v14, v14, v51, v40
    v_max3_f32 v15, v41, v42, v43
    s_nop 1
    v_max3_f32 v14, v14, v44, v45
    v_max3_f32 v15, v15, v46, v47
    v_max_f32 v14, v14, v15
    v_mov_b32 v15, v14
    v_mov_b64 v[56:57], 0
    v_mov_b64 v[58:59], 0
    ds_read_b128 v[76:79], v12 offset:1024
    v_permlane32_swap_b32 v14, v15
    v_max_f32 v14, v14, v15
    v_mov_b32 v15, v14
    v_mov_b64 v[60:61], 0
    v_mov_b64 v[62:63], 0
    ds_read_b128 v[80:83], v12 offset:2048
    v_permlane16_swap_b32 v14, v15
    v_max_f32 v14, v14, v15
    v_mul_f32 v14, s69, v14
    v_pk_fma_f32 v[40:41], v[40:41], s[80:81], v[14:15] op_sel_hi:[1,1,0] neg_lo:[0,0,1] neg_hi:[0,0,1]
    v_pk_fma_f32 v[42:43], v[42:43], s[80:81], v[14:15] op_sel_hi:[1,1,0] neg_lo:[0,0,1] neg_hi:[0,0,1]
    v_pk_fma_f32 v[44:45], v[44:45], s[80:81], v[14:15] op_sel_hi:[1,1,0] neg_lo:[0,0,1] neg_hi:[0,0,1]
    v_pk_fma_f32 v[46:47], v[46:47], s[80:81], v[14:15] op_sel_hi:[1,1,0] neg_lo:[0,0,1] neg_hi:[0,0,1]
    v_exp_f32 v40, v40
    v_exp_f32 v41, v41
    v_exp_f32 v42, v42
    v_exp_f32 v43, v43
    v_exp_f32 v44, v44
    v_exp_f32 v45, v45
    v_exp_f32 v46, v46
    v_exp_f32 v47, v47
    v_pk_fma_f32 v[48:49], v[48:49], s[80:81], v[14:15] op_sel_hi:[1,1,0] neg_lo:[0,0,1] neg_hi:[0,0,1]
    v_pk_fma_f32 v[50:51], v[50:51], s[80:81], v[14:15] op_sel_hi:[1,1,0] neg_lo:[0,0,1] neg_hi:[0,0,1]
    v_cvt_pk_bf16_f32 v96, v40, v41
    v_cvt_pk_bf16_f32 v97, v42, v43
    v_cvt_pk_bf16_f32 v98, v44, v45
    v_cvt_pk_bf16_f32 v99, v46, v47
    v_exp_f32 v48, v48
    s_nop 0
    v_mfma_f32_16x16x32_bf16 v[40:43], v[52:55], v[96:99], 0
    ds_read_b128 v[84:87], v12 offset:3072
    v_exp_f32 v49, v49
    v_mfma_f32_16x16x32_bf16 v[28:31], v[112:115], v[96:99], 0
    v_exp_f32 v50, v50
    v_mfma_f32_16x16x32_bf16 v[32:35], v[116:119], v[96:99], 0
    v_exp_f32 v51, v51
    v_cvt_pk_bf16_f32 v100, v48, v49
    v_cvt_pk_bf16_f32 v101, v50, v51
    v_mov_b64 v[64:65], 0
    v_mov_b64 v[66:67], 0
    v_mfma_f32_16x16x16_bf16 v[40:43], v[52:53], v[100:101], v[40:43]
    v_mov_b64 v[68:69], 0
    v_mov_b64 v[70:71], 0
    v_mfma_f32_16x16x16_bf16 v[28:31], v[36:37], v[100:101], v[28:31]
    v_mfma_f32_16x16x16_bf16 v[32:35], v[38:39], v[100:101], v[32:35]
    v_rcp_f32 v14, v40
    s_mov_b32 exec_lo, 0xff00ff00
    s_mov_b32 exec_hi, 0xff00ff00
    s_nop 0
    v_pk_mul_f32 v[28:29], v[28:29], v[14:15] op_sel_hi:[1,0]
    v_pk_mul_f32 v[30:31], v[30:31], v[14:15] op_sel_hi:[1,0]
    v_cvt_pk_bf16_f32 v88, v28, v29
    v_cvt_pk_bf16_f32 v89, v30, v31
    v_pk_mul_f32 v[32:33], v[32:33], v[14:15] op_sel_hi:[1,0]
    v_pk_mul_f32 v[34:35], v[34:35], v[14:15] op_sel_hi:[1,0]
    v_cvt_pk_bf16_f32 v90, v32, v33
    v_cvt_pk_bf16_f32 v91, v34, v35
    ds_write_b128 v9, v[88:91]
    s_mov_b64 exec, -1
    s_waitcnt vmcnt(8) lgkmcnt(0)
    s_barrier
    ds_read_b128 v[96:99], v1 offset:28672
    ds_read_b128 v[100:103], v1 offset:29184
    ds_read_b128 v[104:107], v1 offset:29696
    ds_read_b128 v[108:111], v1 offset:30208
    s_waitcnt lgkmcnt(3)
    v_smfmac_f32_16x16x64_bf16 v[56:59], v[96:99], v[72:79], v6
    v_smfmac_f32_16x16x64_bf16 v[60:63], v[96:99], v[144:151], v6
    s_waitcnt lgkmcnt(2)
    v_smfmac_f32_16x16x64_bf16 v[56:59], v[100:103], v[80:87], v6
    v_smfmac_f32_16x16x64_bf16 v[60:63], v[100:103], v[152:159], v6
    s_waitcnt lgkmcnt(1)
    v_smfmac_f32_16x16x64_bf16 v[56:59], v[104:107], v[192:199], v6
    v_smfmac_f32_16x16x64_bf16 v[60:63], v[104:107], v[208:215], v6
    s_waitcnt lgkmcnt(0)
    v_smfmac_f32_16x16x64_bf16 v[56:59], v[108:111], v[200:207], v6
    v_smfmac_f32_16x16x64_bf16 v[60:63], v[108:111], v[216:223], v6
    v_smfmac_f32_16x16x64_bf16 v[64:67], v[96:99], v[160:167], v6
    v_smfmac_f32_16x16x64_bf16 v[68:71], v[96:99], v[176:183], v6
    v_cvt_pk_bf16_f32 v40, v56, v60
    v_smfmac_f32_16x16x64_bf16 v[64:67], v[100:103], v[168:175], v6
    v_cvt_pk_bf16_f32 v41, v57, v61
    v_smfmac_f32_16x16x64_bf16 v[68:71], v[100:103], v[184:191], v6
    v_cvt_pk_bf16_f32 v42, v58, v62
    v_smfmac_f32_16x16x64_bf16 v[64:67], v[104:107], v[224:231], v6
    v_cvt_pk_bf16_f32 v43, v59, v63
    v_smfmac_f32_16x16x64_bf16 v[68:71], v[104:107], v[240:247], v6
    global_store_dwordx4 v10, v[40:43], s[48:49] sc1
    v_smfmac_f32_16x16x64_bf16 v[64:67], v[108:111], v[232:239], v6
    v_smfmac_f32_16x16x64_bf16 v[68:71], v[108:111], v[248:255], v6
    s_nop 7
    v_cvt_pk_bf16_f32 v44, v64, v68
    v_cvt_pk_bf16_f32 v45, v65, v69
    v_cvt_pk_bf16_f32 v46, v66, v70
    v_cvt_pk_bf16_f32 v47, v67, v71
    global_store_dwordx4 v10, v[44:47], s[52:53] sc1
    s_waitcnt vmcnt(1)
    ds_read_b128 v[72:75], v12 offset:16384
    ds_read_b128 v[76:79], v12 offset:17408
    ds_read_b128 v[80:83], v12 offset:18432
    ds_read_b128 v[84:87], v12 offset:19456
    ds_read_b128 v[88:91], v12 offset:32768
    ds_read_b128 v[92:95], v12 offset:33792
    global_load_dwordx4 v[48:51], v0, s[16:17] offset:0 sc1
    global_load_dwordx4 v[52:55], v0, s[16:17] offset:1024 sc1
    s_sleep 2
    global_load_dwordx4 v[64:67], v0, s[16:17] offset:0 sc1
    global_load_dwordx4 v[68:71], v0, s[16:17] offset:1024 sc1
    v_mov_b64 v[28:29], 0
    v_mov_b64 v[30:31], 0
    v_mov_b64 v[32:33], 0
    v_mov_b64 v[34:35], 0
    v_mov_b64 v[36:37], 0
    v_mov_b64 v[38:39], 0
    v_mov_b64 v[96:97], -1
    v_mov_b64 v[98:99], -1
    s_waitcnt vmcnt(2)
    v_mfma_f32_16x16x32_bf16 v[100:103], v[20:23], v[48:51], 0
    v_max3_u32 v14, v48, v49, v50
    v_mfma_f32_16x16x32_bf16 v[100:103], v[20:23], v[52:55], v[100:103]
    v_max3_u32 v15, v51, v52, v53
    v_max3_u32 v14, v14, v54, v55
    v_max_u32 v14, v14, v15
    v_cmp_eq_u32 vcc, -1, v14
    s_cbranch_vccnz LlB_78
LokB_79:
    s_nop 2
    v_add_f32_dpp v100, v100, v100 row_ror:4 row_mask:0xf bank_mask:0xf
    v_add_f32_dpp v101, v101, v101 row_ror:4 row_mask:0xf bank_mask:0xf
    v_add_f32_dpp v102, v102, v102 row_ror:4 row_mask:0xf bank_mask:0xf
    v_add_f32_dpp v103, v103, v103 row_ror:4 row_mask:0xf bank_mask:0xf
    v_add_f32_dpp v100, v100, v100 row_ror:8 row_mask:0xf bank_mask:0xf
    v_add_f32_dpp v101, v101, v101 row_ror:8 row_mask:0xf bank_mask:0xf
    v_add_f32_dpp v102, v102, v102 row_ror:8 row_mask:0xf bank_mask:0xf
    v_add_f32_dpp v103, v103, v103 row_ror:8 row_mask:0xf bank_mask:0xf
    v_cvt_pk_bf16_f32 v100, v100, v101
    v_cvt_pk_bf16_f32 v101, v102, v103
    v_cndmask_b32 v100, v100, v101, s[70:71]
    s_mov_b64 exec, 0x00ff00ff
    global_store_dword v11, v100, s[46:47] sc1
    s_mov_b64 exec, -1
    s_add_u32 s68, s68, 1
    s_waitcnt vmcnt(0)
    global_load_dwordx4 v[104:107], v2, s[46:47] offset:0 sc1
    global_load_dwordx4 v[108:111], v2, s[46:47] offset:1024 sc1
    s_sleep 2
    global_load_dwordx4 v[64:67], v2, s[46:47] offset:0 sc1
    global_load_dwordx4 v[68:71], v2, s[46:47] offset:1024 sc1
    s_waitcnt vmcnt(2)
    ds_write_b128 v2, v[104:107] offset:0
    ds_write_b128 v2, v[108:111] offset:1024
    v_max3_u32 v14, v104, v105, v106
    v_max3_u32 v15, v107, v108, v109
    v_max3_u32 v14, v14, v110, v111
    v_max_u32 v14, v14, v15
    v_cmp_eq_u32 vcc, -1, v14
    s_cbranch_vccnz LslA_82
LokA_81:
    s_waitcnt lgkmcnt(0)
    s_barrier
    ds_read_b128 v[40:43], v1 offset:0
    ds_read_b128 v[44:47], v1 offset:512
    ds_read_b128 v[48:51], v1 offset:1024
    ds_read_b128 v[52:55], v1 offset:1536
    s_waitcnt vmcnt(0)
    ds_read_b128 v[56:59], v1 offset:2048
    ds_read_b128 v[60:63], v1 offset:2560
    ds_read_b128 v[64:67], v1 offset:3072
    ds_read_b128 v[68:71], v1 offset:3584
    s_mov_b64 exec, 0x00ff00ff
    global_store_dword v11, v96, s[44:45] sc1
    s_mov_b64 exec, -1
    s_waitcnt lgkmcnt(7)
    v_smfmac_f32_16x16x64_bf16 v[28:31], v[40:43], a[0:7], v6
    s_add_u32 m0, s78, 0
    global_load_dwordx4 v[112:115], v0, s[58:59] sc1
    v_smfmac_f32_16x16x64_bf16 v[36:39], v[40:43], a[144:151], v6
    global_load_lds_dwordx4 v0, s[56:57] sc1
    v_smfmac_f32_16x16x64_bf16 v[32:35], v[40:43], v[72:79], v6
    ds_read_b128 v[72:75], v12 offset:34816
    global_load_lds_dwordx4 v0, s[56:57] offset:1024 sc1
    s_waitcnt lgkmcnt(7)
    v_smfmac_f32_16x16x64_bf16 v[28:31], v[44:47], a[8:15], v6
    ds_read_b128 v[76:79], v12 offset:35840
    global_load_dwordx4 v[116:119], v0, s[58:59] offset:1024 sc1
    v_smfmac_f32_16x16x64_bf16 v[36:39], v[44:47], a[152:159], v6
    ds_read_b128 v[40:43], v1 offset:4096
    s_add_u32 s56, s56, 8192
    s_addc_u32 s57, s57, 0
    v_smfmac_f32_16x16x64_bf16 v[32:35], v[44:47], v[80:87], v6
    ds_read_b128 v[80:83], v12 offset:49152
    s_add_u32 s58, s58, 8192
    s_addc_u32 s59, s59, 0
    s_waitcnt lgkmcnt(9)
    v_smfmac_f32_16x16x64_bf16 v[28:31], v[48:51], a[16:23], v6
    s_mov_b64 exec, 1
    global_store_dword v0, v6, s[36:37] sc1
    s_mov_b64 exec, -1
    v_smfmac_f32_16x16x64_bf16 v[36:39], v[48:51], a[160:167], v6
    ds_read_b128 v[84:87], v12 offset:50176
    s_add_u32 s36, s36, 4096
    s_addc_u32 s37, s37, 0
    v_smfmac_f32_16x16x64_bf16 v[32:35], v[48:51], v[88:95], v6
    ds_read_b128 v[88:91], v12 offset:51200
    global_store_dwordx4 v0, v[96:99], s[16:17] sc1
    s_waitcnt lgkmcnt(10)
    v_smfmac_f32_16x16x64_bf16 v[28:31], v[52:55], a[24:31], v6
    ds_read_b128 v[92:95], v12 offset:52224
    v_smfmac_f32_16x16x64_bf16 v[36:39], v[52:55], a[168:175], v6
    ds_read_b128 v[44:47], v1 offset:4608
    s_waitcnt lgkmcnt(6)
    v_smfmac_f32_16x16x64_bf16 v[32:35], v[52:55], v[72:79], v6
    ds_read_b128 v[72:75], v3 offset:0
    v_smfmac_f32_16x16x64_bf16 v[28:31], v[56:59], a[32:39], v6
    ds_read_b128 v[76:79], v3 offset:1024
    v_smfmac_f32_16x16x64_bf16 v[36:39], v[56:59], a[176:183], v6
    ds_read_b128 v[48:51], v1 offset:5120
    s_waitcnt lgkmcnt(6)
    v_smfmac_f32_16x16x64_bf16 v[32:35], v[56:59], v[80:87], v6
    ds_read_b128 v[80:83], v3 offset:2048
    v_smfmac_f32_16x16x64_bf16 v[28:31], v[60:63], a[40:47], v6
    ds_read_b128 v[84:87], v3 offset:3072
    v_smfmac_f32_16x16x64_bf16 v[36:39], v[60:63], a[184:191], v6
    ds_read_b128 v[52:55], v1 offset:5632
    global_store_dwordx4 v0, v[96:99], s[16:17] offset:1024 sc1
    s_waitcnt lgkmcnt(7)
    v_smfmac_f32_16x16x64_bf16 v[32:35], v[60:63], v[88:95], v6
    ds_read_b128 v[88:91], v3 offset:16384
    v_smfmac_f32_16x16x64_bf16 v[28:31], v[64:67], a[48:55], v6
    ds_read_b128 v[92:95], v3 offset:17408
    v_smfmac_f32_16x16x64_bf16 v[36:39], v[64:67], a[192:199], v6
    ds_read_b128 v[56:59], v1 offset:6144
    s_waitcnt lgkmcnt(7)
    v_smfmac_f32_16x16x64_bf16 v[32:35], v[64:67], v[72:79], v6
    ds_read_b128 v[72:75], v3 offset:18432
    v_smfmac_f32_16x16x64_bf16 v[28:31], v[68:71], a[56:63], v6
    ds_read_b128 v[76:79], v3 offset:19456
    v_smfmac_f32_16x16x64_bf16 v[36:39], v[68:71], a[200:207], v6
    ds_read_b128 v[60:63], v1 offset:6656
    s_waitcnt lgkmcnt(7)
    v_smfmac_f32_16x16x64_bf16 v[32:35], v[68:71], v[80:87], v6
    ds_read_b128 v[80:83], v3 offset:32768
    v_smfmac_f32_16x16x64_bf16 v[28:31], v[40:43], a[64:71], v6
    ds_read_b128 v[84:87], v3 offset:33792
    s_waitcnt lgkmcnt(6)
    v_smfmac_f32_16x16x64_bf16 v[32:35], v[40:43], v[88:95], v6
    ds_read_b128 v[88:91], v3 offset:34816
    v_smfmac_f32_16x16x64_bf16 v[28:31], v[44:47], a[72:79], v6
    ds_read_b128 v[92:95], v3 offset:35840
    s_waitcnt lgkmcnt(5)
    v_smfmac_f32_16x16x64_bf16 v[32:35], v[44:47], v[72:79], v6
    ds_read_b128 v[72:75], v3 offset:49152
    v_smfmac_f32_16x16x64_bf16 v[28:31], v[48:51], a[80:87], v6
    ds_read_b128 v[76:79], v3 offset:50176
    s_waitcnt lgkmcnt(4)
    v_smfmac_f32_16x16x64_bf16 v[32:35], v[48:51], v[80:87], v6
    ds_read_b128 v[80:83], v3 offset:51200
    v_smfmac_f32_16x16x64_bf16 v[28:31], v[52:55], a[88:95], v6
    ds_read_b128 v[84:87], v3 offset:52224
    s_waitcnt lgkmcnt(4)
    v_smfmac_f32_16x16x64_bf16 v[32:35], v[52:55], v[88:95], v6
    ds_read_b128 v[64:67], v1 offset:7168
    v_smfmac_f32_16x16x64_bf16 v[28:31], v[56:59], a[96:103], v6
    ds_read_b128 v[68:71], v1 offset:7680
    s_waitcnt lgkmcnt(4)
    v_smfmac_f32_16x16x64_bf16 v[32:35], v[56:59], v[72:79], v6
    ds_read_b128 v[88:91], v0 offset:16384
    v_smfmac_f32_16x16x64_bf16 v[28:31], v[60:63], a[104:111], v6
    ds_read_b128 v[92:95], v0 offset:20480
    s_waitcnt lgkmcnt(4)
    v_smfmac_f32_16x16x64_bf16 v[32:35], v[60:63], v[80:87], v6
    ds_read_b128 v[72:75], v0 offset:17408
    s_waitcnt lgkmcnt(4)
    v_smfmac_f32_16x16x64_bf16 v[28:31], v[64:67], a[112:119], v6
    ds_read_b128 v[76:79], v0 offset:21504
    v_smfmac_f32_16x16x64_bf16 v[32:35], v[64:67], a[128:135], v6
    ds_read_b128 v[80:83], v0 offset:18432
    s_waitcnt lgkmcnt(5)
    v_smfmac_f32_16x16x64_bf16 v[28:31], v[68:71], a[120:127], v6
    ds_read_b128 v[84:87], v0 offset:22528
    v_smfmac_f32_16x16x64_bf16 v[32:35], v[68:71], a[136:143], v6
    v_smfmac_f32_16x16x64_bf16 v[36:39], v[40:43], a[208:215], v6
    v_smfmac_f32_16x16x64_bf16 v[36:39], v[44:47], a[216:223], v6
    v_cvt_pk_bf16_f32 v14, v28, v29
    v_cvt_pk_bf16_f32 v15, v30, v31
    v_cvt_pk_bf16_f32 v16, v32, v33
    v_cvt_pk_bf16_f32 v17, v34, v35
    ds_write_b128 v7, v[14:17]
    v_smfmac_f32_16x16x64_bf16 v[36:39], v[48:51], a[224:231], v6
    ds_read_b128 v[28:31], v0 offset:19456
    v_smfmac_f32_16x16x64_bf16 v[36:39], v[56:59], a[240:247], v6
    ds_read_b128 v[32:35], v0 offset:23552
    v_smfmac_f32_16x16x64_bf16 v[36:39], v[60:63], a[248:255], v6
    s_waitcnt lgkmcnt(2)
    s_barrier
    ds_read_b64_tr_b16 v[96:97], v8 offset:24576
    ds_read_b64_tr_b16 v[98:99], v8 offset:25088
    ds_read_b64_tr_b16 v[100:101], v8 offset:25600
    ds_read_b64_tr_b16 v[102:103], v8 offset:26112
    ds_read_b64_tr_b16 v[104:105], v8 offset:26624
    ds_read_b64_tr_b16 v[106:107], v8 offset:27136
    ds_read_b64_tr_b16 v[108:109], v8 offset:27648
    ds_read_b64_tr_b16 v[110:111], v8 offset:28160
    v_smfmac_f32_16x16x64_bf16 v[36:39], v[52:55], a[232:239], v6
    v_smfmac_f32_16x16x64_bf16 v[36:39], v[64:67], v[128:135], v6
    v_smfmac_f32_16x16x64_bf16 v[36:39], v[68:71], v[136:143], v6
    s_waitcnt lgkmcnt(6)
    v_mfma_f32_16x16x32_bf16 v[48:51], v[96:99], v[96:99], v[24:27]
    v_mov_b64 v[52:53], s[62:63]
    v_mov_b64 v[54:55], s[62:63]
    v_mfma_f32_16x16x32_bf16 v[40:43], v[88:91], v[96:99], 0
    v_mfma_f32_16x16x32_bf16 v[44:47], v[92:95], v[96:99], 0
    v_cvt_pk_bf16_f32 v18, v36, v37
    v_cvt_pk_bf16_f32 v19, v38, v39
    s_waitcnt lgkmcnt(4)
    v_mfma_f32_16x16x32_bf16 v[48:51], v[100:103], v[100:103], v[48:51]
    v_mov_b64 v[36:37], v[18:19]
    v_mov_b64 v[38:39], v[18:19]
    v_mfma_f32_16x16x32_bf16 v[40:43], v[72:75], v[100:103], v[40:43]
    v_mfma_f32_16x16x32_bf16 v[44:47], v[76:79], v[100:103], v[44:47]
    v_permlane32_swap_b32 v36, v38
    s_waitcnt lgkmcnt(2)
    v_mfma_f32_16x16x32_bf16 v[48:51], v[104:107], v[104:107], v[48:51]
    v_permlane32_swap_b32 v37, v39
    v_mfma_f32_16x16x32_bf16 v[40:43], v[80:83], v[104:107], v[40:43]
    global_store_dwordx4 v0, v[16:19], s[60:61] sc1
    v_mfma_f32_16x16x32_bf16 v[44:47], v[84:87], v[104:107], v[44:47]
    s_waitcnt lgkmcnt(0)
    v_mfma_f32_16x16x32_bf16 v[48:51], v[108:111], v[108:111], v[48:51]
    v_mfma_f32_16x16x32_bf16 v[40:43], v[28:31], v[108:111], v[40:43]
    v_mfma_f32_16x16x32_bf16 v[44:47], v[32:35], v[108:111], v[44:47]
    s_add_u32 s60, s60, 4096
    s_addc_u32 s61, s61, 0
    s_cmp_ge_u32 s68, 63
    s_cbranch_scc1 Ldone_9
    ds_read_b128 v[72:75], v12 offset:0
    v_max3_f32 v14, v48, v49, v50
    v_max3_f32 v14, v14, v51, v40
    v_max3_f32 v15, v41, v42, v43
    v_max3_f32 v14, v14, v44, v45
    v_max3_f32 v15, v15, v46, v47
    v_max_f32 v14, v14, v15
    v_mov_b32 v15, v14
    v_mov_b64 v[56:57], 0
    v_mov_b64 v[58:59], 0
    ds_read_b128 v[76:79], v12 offset:1024
    v_permlane32_swap_b32 v14, v15
    v_max_f32 v14, v14, v15
    v_mov_b32 v15, v14
    v_mov_b64 v[60:61], 0
    v_mov_b64 v[62:63], 0
    ds_read_b128 v[80:83], v12 offset:2048
    v_permlane16_swap_b32 v14, v15
    v_max_f32 v14, v14, v15
    v_mul_f32 v14, s69, v14
    v_pk_fma_f32 v[40:41], v[40:41], s[80:81], v[14:15] op_sel_hi:[1,1,0] neg_lo:[0,0,1] neg_hi:[0,0,1]
    v_pk_fma_f32 v[42:43], v[42:43], s[80:81], v[14:15] op_sel_hi:[1,1,0] neg_lo:[0,0,1] neg_hi:[0,0,1]
    v_pk_fma_f32 v[44:45], v[44:45], s[80:81], v[14:15] op_sel_hi:[1,1,0] neg_lo:[0,0,1] neg_hi:[0,0,1]
    v_pk_fma_f32 v[46:47], v[46:47], s[80:81], v[14:15] op_sel_hi:[1,1,0] neg_lo:[0,0,1] neg_hi:[0,0,1]
    v_exp_f32 v40, v40
    v_exp_f32 v41, v41
    v_exp_f32 v42, v42
    v_exp_f32 v43, v43
    v_exp_f32 v44, v44
    v_exp_f32 v45, v45
    v_exp_f32 v46, v46
    v_exp_f32 v47, v47
    v_pk_fma_f32 v[48:49], v[48:49], s[80:81], v[14:15] op_sel_hi:[1,1,0] neg_lo:[0,0,1] neg_hi:[0,0,1]
    v_pk_fma_f32 v[50:51], v[50:51], s[80:81], v[14:15] op_sel_hi:[1,1,0] neg_lo:[0,0,1] neg_hi:[0,0,1]
    v_cvt_pk_bf16_f32 v96, v40, v41
    v_cvt_pk_bf16_f32 v97, v42, v43
    v_cvt_pk_bf16_f32 v98, v44, v45
    v_cvt_pk_bf16_f32 v99, v46, v47
    v_exp_f32 v48, v48
    s_nop 0
    v_mfma_f32_16x16x32_bf16 v[40:43], v[52:55], v[96:99], 0
    ds_read_b128 v[84:87], v12 offset:3072
    v_exp_f32 v49, v49
    v_mfma_f32_16x16x32_bf16 v[28:31], v[120:123], v[96:99], 0
    v_exp_f32 v50, v50
    v_mfma_f32_16x16x32_bf16 v[32:35], v[124:127], v[96:99], 0
    v_exp_f32 v51, v51
    v_cvt_pk_bf16_f32 v100, v48, v49
    v_cvt_pk_bf16_f32 v101, v50, v51
    v_mov_b64 v[64:65], 0
    v_mov_b64 v[66:67], 0
    v_mfma_f32_16x16x16_bf16 v[40:43], v[52:53], v[100:101], v[40:43]
    v_mov_b64 v[68:69], 0
    v_mov_b64 v[70:71], 0
    v_mfma_f32_16x16x16_bf16 v[28:31], v[36:37], v[100:101], v[28:31]
    v_mfma_f32_16x16x16_bf16 v[32:35], v[38:39], v[100:101], v[32:35]
    v_rcp_f32 v14, v40
    s_mov_b32 exec_lo, 0xff00ff00
    s_mov_b32 exec_hi, 0xff00ff00
    s_nop 0
    v_pk_mul_f32 v[28:29], v[28:29], v[14:15] op_sel_hi:[1,0]
    v_pk_mul_f32 v[30:31], v[30:31], v[14:15] op_sel_hi:[1,0]
    v_cvt_pk_bf16_f32 v88, v28, v29
    v_cvt_pk_bf16_f32 v89, v30, v31
    v_pk_mul_f32 v[32:33], v[32:33], v[14:15] op_sel_hi:[1,0]
    v_pk_mul_f32 v[34:35], v[34:35], v[14:15] op_sel_hi:[1,0]
    v_cvt_pk_bf16_f32 v90, v32, v33
    v_cvt_pk_bf16_f32 v91, v34, v35
    ds_write_b128 v9, v[88:91]
    s_mov_b64 exec, -1
    s_waitcnt vmcnt(8) lgkmcnt(0)
    s_barrier
    ds_read_b128 v[96:99], v1 offset:28672
    ds_read_b128 v[100:103], v1 offset:29184
    ds_read_b128 v[104:107], v1 offset:29696
    ds_read_b128 v[108:111], v1 offset:30208
    s_waitcnt lgkmcnt(3)
    v_smfmac_f32_16x16x64_bf16 v[56:59], v[96:99], v[72:79], v6
    v_smfmac_f32_16x16x64_bf16 v[60:63], v[96:99], v[144:151], v6
    s_waitcnt lgkmcnt(2)
    v_smfmac_f32_16x16x64_bf16 v[56:59], v[100:103], v[80:87], v6
    v_smfmac_f32_16x16x64_bf16 v[60:63], v[100:103], v[152:159], v6
    s_waitcnt lgkmcnt(1)
    v_smfmac_f32_16x16x64_bf16 v[56:59], v[104:107], v[192:199], v6
    v_smfmac_f32_16x16x64_bf16 v[60:63], v[104:107], v[208:215], v6
    s_waitcnt lgkmcnt(0)
    v_smfmac_f32_16x16x64_bf16 v[56:59], v[108:111], v[200:207], v6
    v_smfmac_f32_16x16x64_bf16 v[60:63], v[108:111], v[216:223], v6
    v_smfmac_f32_16x16x64_bf16 v[64:67], v[96:99], v[160:167], v6
    v_smfmac_f32_16x16x64_bf16 v[68:71], v[96:99], v[176:183], v6
    v_cvt_pk_bf16_f32 v40, v56, v60
    v_smfmac_f32_16x16x64_bf16 v[64:67], v[100:103], v[168:175], v6
    v_cvt_pk_bf16_f32 v41, v57, v61
    v_smfmac_f32_16x16x64_bf16 v[68:71], v[100:103], v[184:191], v6
    v_cvt_pk_bf16_f32 v42, v58, v62
    v_smfmac_f32_16x16x64_bf16 v[64:67], v[104:107], v[224:231], v6
    v_cvt_pk_bf16_f32 v43, v59, v63
    v_smfmac_f32_16x16x64_bf16 v[68:71], v[104:107], v[240:247], v6
    global_store_dwordx4 v10, v[40:43], s[50:51] sc1
    v_smfmac_f32_16x16x64_bf16 v[64:67], v[108:111], v[232:239], v6
    v_smfmac_f32_16x16x64_bf16 v[68:71], v[108:111], v[248:255], v6
    s_nop 7
    v_cvt_pk_bf16_f32 v44, v64, v68
    v_cvt_pk_bf16_f32 v45, v65, v69
    v_cvt_pk_bf16_f32 v46, v66, v70
    v_cvt_pk_bf16_f32 v47, v67, v71
    global_store_dwordx4 v10, v[44:47], s[54:55] sc1
    s_waitcnt vmcnt(1)
    ds_read_b128 v[72:75], v12 offset:16384
    ds_read_b128 v[76:79], v12 offset:17408
    ds_read_b128 v[80:83], v12 offset:18432
    ds_read_b128 v[84:87], v12 offset:19456
    ds_read_b128 v[88:91], v12 offset:32768
    ds_read_b128 v[92:95], v12 offset:33792
    global_load_dwordx4 v[48:51], v0, s[18:19] offset:0 sc1
    global_load_dwordx4 v[52:55], v0, s[18:19] offset:1024 sc1
    s_sleep 2
    global_load_dwordx4 v[64:67], v0, s[18:19] offset:0 sc1
    global_load_dwordx4 v[68:71], v0, s[18:19] offset:1024 sc1
    v_mov_b64 v[28:29], 0
    v_mov_b64 v[30:31], 0
    v_mov_b64 v[32:33], 0
    v_mov_b64 v[34:35], 0
    v_mov_b64 v[36:37], 0
    v_mov_b64 v[38:39], 0
    v_mov_b64 v[96:97], -1
    v_mov_b64 v[98:99], -1
    s_waitcnt vmcnt(2)
    v_mfma_f32_16x16x32_bf16 v[100:103], v[20:23], v[48:51], 0
    v_max3_u32 v14, v48, v49, v50
    v_mfma_f32_16x16x32_bf16 v[100:103], v[20:23], v[52:55], v[100:103]
    v_max3_u32 v15, v51, v52, v53
    v_max3_u32 v14, v14, v54, v55
    v_max_u32 v14, v14, v15
    v_cmp_eq_u32 vcc, -1, v14
    s_cbranch_vccnz LlB_83
LokB_84:
    s_nop 2
    v_add_f32_dpp v100, v100, v100 row_ror:4 row_mask:0xf bank_mask:0xf
    v_add_f32_dpp v101, v101, v101 row_ror:4 row_mask:0xf bank_mask:0xf
    v_add_f32_dpp v102, v102, v102 row_ror:4 row_mask:0xf bank_mask:0xf
    v_add_f32_dpp v103, v103, v103 row_ror:4 row_mask:0xf bank_mask:0xf
    v_add_f32_dpp v100, v100, v100 row_ror:8 row_mask:0xf bank_mask:0xf
    v_add_f32_dpp v101, v101, v101 row_ror:8 row_mask:0xf bank_mask:0xf
    v_add_f32_dpp v102, v102, v102 row_ror:8 row_mask:0xf bank_mask:0xf
    v_add_f32_dpp v103, v103, v103 row_ror:8 row_mask:0xf bank_mask:0xf
    v_cvt_pk_bf16_f32 v100, v100, v101
    v_cvt_pk_bf16_f32 v101, v102, v103
    v_cndmask_b32 v100, v100, v101, s[70:71]
    s_mov_b64 exec, 0x00ff00ff
    global_store_dword v11, v100, s[44:45] sc1
    s_mov_b64 exec, -1
    s_add_u32 s68, s68, 1
    s_add_u32 s64, s68, 2
    s_cmp_lt_u32 s64, s76
    s_cbranch_scc1 Lrec_74
Lrs_85:
Lrdy_86:
    global_load_dword v5, v4, s[42:43] sc1
    s_add_u32 s77, s77, 1
    s_cmp_gt_u32 s77, 0x100000
    s_cbranch_scc1 Lrec_74
    s_waitcnt vmcnt(0)
    v_cmp_le_u32 s[74:75], 32, v5
    s_nop 0
    s_ff0_i32_b64 s76, s[74:75]
    s_add_u32 s64, s68, 2
    s_cmp_lt_u32 s64, s76
    s_cbranch_scc0 Lrdy_86
    s_branch Lrec_74
Ldone_9:
    s_waitcnt vmcnt(0)
    s_mov_b64 exec, 1
    global_store_dword v0, v6, s[36:37] sc1
    s_mov_b64 exec, -1
    s_add_u32 s36, s36, 4096
    s_addc_u32 s37, s37, 0
    s_endpgm
LslA_77:
    s_mov_b64 exec, vcc
    global_load_dwordx4 v[104:107], v2, s[44:45] offset:0 sc1
    global_load_dwordx4 v[108:111], v2, s[44:45] offset:1024 sc1
    s_mov_b64 exec, -1
    s_waitcnt vmcnt(2)
    ds_write_b128 v2, v[64:67] offset:0
    ds_write_b128 v2, v[68:71] offset:1024
    v_max3_u32 v14, v64, v65, v66
    v_max3_u32 v15, v67, v68, v69
    v_max3_u32 v14, v14, v70, v71
    v_max_u32 v14, v14, v15
    v_cmp_eq_u32 vcc, -1, v14
    s_cbranch_vccz LokA_76
    s_mov_b64 exec, vcc
    global_load_dwordx4 v[64:67], v2, s[44:45] offset:0 sc1
    global_load_dwordx4 v[68:71], v2, s[44:45] offset:1024 sc1
    s_mov_b64 exec, -1
    s_waitcnt vmcnt(2)
    ds_write_b128 v2, v[104:107] offset:0
    ds_write_b128 v2, v[108:111] offset:1024
    v_max3_u32 v14, v104, v105, v106
    v_max3_u32 v15, v107, v108, v109
    v_max3_u32 v14, v14, v110, v111
    v_max_u32 v14, v14, v15
    v_cmp_eq_u32 vcc, -1, v14
    s_cbranch_vccz LokA_76
    s_add_u32 s77, s77, 1
    s_cmp_lt_u32 s77, 0x80000
    s_cbranch_scc1 LslA_77
    s_branch LokA_76
LlB_78:
    s_mov_b64 exec, vcc
    global_load_dwordx4 v[48:51], v0, s[16:17] offset:0 sc1
    global_load_dwordx4 v[52:55], v0, s[16:17] offset:1024 sc1
    s_mov_b64 exec, -1
    s_waitcnt vmcnt(2)
    v_mfma_f32_16x16x32_bf16 v[100:103], v[20:23], v[64:67], 0
    v_max3_u32 v14, v64, v65, v66
    v_mfma_f32_16x16x32_bf16 v[100:103], v[20:23], v[68:71], v[100:103]
    v_max3_u32 v15, v67, v68, v69
    v_max3_u32 v14, v14, v70, v71
    v_max_u32 v14, v14, v15
    v_cmp_eq_u32 vcc, -1, v14
    s_cbranch_vccz LokB_79
    s_mov_b64 exec, vcc
    global_load_dwordx4 v[64:67], v0, s[16:17] offset:0 sc1
    global_load_dwordx4 v[68:71], v0, s[16:17] offset:1024 sc1
    s_mov_b64 exec, -1
    s_waitcnt vmcnt(2)
    v_mfma_f32_16x16x32_bf16 v[100:103], v[20:23], v[48:51], 0
    v_max3_u32 v14, v48, v49, v50
    v_mfma_f32_16x16x32_bf16 v[100:103], v[20:23], v[52:55], v[100:103]
    v_max3_u32 v15, v51, v52, v53
    v_max3_u32 v14, v14, v54, v55
    v_max_u32 v14, v14, v15
    v_cmp_eq_u32 vcc, -1, v14
    s_cbranch_vccz LokB_79
    s_add_u32 s77, s77, 1
    s_cmp_lt_u32 s77, 0x80000
    s_cbranch_scc1 LlB_78
    s_branch LokB_79
LslA_82:
    s_mov_b64 exec, vcc
    global_load_dwordx4 v[104:107], v2, s[46:47] offset:0 sc1
    global_load_dwordx4 v[108:111], v2, s[46:47] offset:1024 sc1
    s_mov_b64 exec, -1
    s_waitcnt vmcnt(2)
    ds_write_b128 v2, v[64:67] offset:0
    ds_write_b128 v2, v[68:71] offset:1024
    v_max3_u32 v14, v64, v65, v66
    v_max3_u32 v15, v67, v68, v69
    v_max3_u32 v14, v14, v70, v71
    v_max_u32 v14, v14, v15
    v_cmp_eq_u32 vcc, -1, v14
    s_cbranch_vccz LokA_81
    s_mov_b64 exec, vcc
    global_load_dwordx4 v[64:67], v2, s[46:47] offset:0 sc1
    global_load_dwordx4 v[68:71], v2, s[46:47] offset:1024 sc1
    s_mov_b64 exec, -1
    s_waitcnt vmcnt(2)
    ds_write_b128 v2, v[104:107] offset:0
    ds_write_b128 v2, v[108:111] offset:1024
    v_max3_u32 v14, v104, v105, v106
    v_max3_u32 v15, v107, v108, v109
    v_max3_u32 v14, v14, v110, v111
    v_max_u32 v14, v14, v15
    v_cmp_eq_u32 vcc, -1, v14
    s_cbranch_vccz LokA_81
    s_add_u32 s77, s77, 1
    s_cmp_lt_u32 s77, 0x80000
    s_cbranch_scc1 LslA_82
    s_branch LokA_81
LlB_83:
    s_mov_b64 exec, vcc
    global_load_dwordx4 v[48:51], v0, s[18:19] offset:0 sc1
    global_load_dwordx4 v[52:55], v0, s[18:19] offset:1024 sc1
    s_mov_b64 exec, -1
    s_waitcnt vmcnt(2)
    v_mfma_f32_16x16x32_bf16 v[100:103], v[20:23], v[64:67], 0
    v_max3_u32 v14, v64, v65, v66
    v_mfma_f32_16x16x32_bf16 v[100:103], v[20:23], v[68:71], v[100:103]
    v_max3_u32 v15, v67, v68, v69
    v_max3_u32 v14, v14, v70, v71
    v_max_u32 v14, v14, v15
    v_cmp_eq_u32 vcc, -1, v14
    s_cbranch_vccz LokB_84
    s_mov_b64 exec, vcc
    global_load_dwordx4 v[64:67], v0, s[18:19] offset:0 sc1
    global_load_dwordx4 v[68:71], v0, s[18:19] offset:1024 sc1
    s_mov_b64 exec, -1
    s_waitcnt vmcnt(2)
    v_mfma_f32_16x16x32_bf16 v[100:103], v[20:23], v[48:51], 0
    v_max3_u32 v14, v48, v49, v50
    v_mfma_f32_16x16x32_bf16 v[100:103], v[20:23], v[52:55], v[100:103]
    v_max3_u32 v15, v51, v52, v53
    v_max3_u32 v14, v14, v54, v55
    v_max_u32 v14, v14, v15
    v_cmp_eq_u32 vcc, -1, v14
    s_cbranch_vccz LokB_84
    s_add_u32 s77, s77, 1
    s_cmp_lt_u32 s77, 0x80000
    s_cbranch_scc1 LlB_83
    s_branch LokB_84
Lrs_4:
Lrdy_87:
    global_load_dword v5, v4, s[42:43] sc1
    s_add_u32 s77, s77, 1
    s_cmp_gt_u32 s77, 0x100000
    s_cbranch_scc1 Lrb_5
    s_waitcnt vmcnt(0)
    v_cmp_le_u32 s[74:75], 32, v5
    s_nop 0
    s_ff0_i32_b64 s76, s[74:75]
    s_add_u32 s64, s68, 0
    s_cmp_lt_u32 s64, s76
    s_cbranch_scc0 Lrdy_87
    s_branch Lrb_5
Lrs_12:
Lrdy_88:
    global_load_dword v5, v4, s[42:43] sc1
    s_add_u32 s77, s77, 1
    s_cmp_gt_u32 s77, 0x100000
    s_cbranch_scc1 Lrb_13
    s_waitcnt vmcnt(0)
    v_cmp_le_u32 s[74:75], 32, v5
    s_nop 0
    s_ff0_i32_b64 s76, s[74:75]
    s_add_u32 s64, s68, 2
    s_cmp_lt_u32 s64, s76
    s_cbranch_scc0 Lrdy_88
    s_branch Lrb_13
Lfin_11:
    s_endpgm
L_worker:
    s_lshr_b32 s8, s2, 3
    s_sub_u32 s12, s6, 1
    s_lshl_b32 s6, s12, 3
    s_lshr_b32 s7, s8, 2
    s_add_u32 s6, s6, s7
    s_and_b32 s7, s8, 3
    s_cmp_lt_u32 s6, 54
    s_cbranch_scc1 L_gemm1
    s_sub_u32 s6, s8, 24
    s_lshl_b32 s6, s6, 2
    s_add_u32 s6, s6, s3
    s_mul_i32 s6, s6, 10240
    s_add_u32 s6, s6, 84475904
    v_lshlrev_b32 v1, 4, v0
    v_add_u32 v1, s6, v1
    v_mov_b32 v4, 0
    v_mov_b32 v5, 0
    v_mov_b32 v6, 0
    v_mov_b32 v7, 0
    global_store_dwordx4 v1, v[4:7], s[42:43] offset:0 sc1
    global_store_dwordx4 v1, v[4:7], s[42:43] offset:1024 sc1
    global_store_dwordx4 v1, v[4:7], s[42:43] offset:2048 sc1
    global_store_dwordx4 v1, v[4:7], s[42:43] offset:3072 sc1
    s_nop 1
    v_add_u32 v1, 4096, v1
    global_store_dwordx4 v1, v[4:7], s[42:43] offset:0 sc1
    global_store_dwordx4 v1, v[4:7], s[42:43] offset:1024 sc1
    global_store_dwordx4 v1, v[4:7], s[42:43] offset:2048 sc1
    global_store_dwordx4 v1, v[4:7], s[42:43] offset:3072 sc1
    s_nop 1
    v_add_u32 v1, 4096, v1
    global_store_dwordx4 v1, v[4:7], s[42:43] offset:0 sc1
    global_store_dwordx4 v1, v[4:7], s[42:43] offset:1024 sc1
    s_waitcnt vmcnt(0)
    s_barrier
    s_cmp_lg_u32 s3, 0
    s_cbranch_scc1 L_noinit
    v_mov_b32 v1, 128
    v_mov_b32 v2, 1
    s_mov_b64 exec, 1
    global_atomic_add v1, v2, s[40:41]
    s_mov_b64 exec, -1
L_noinit:
    v_mov_b32 v1, 128
    s_mov_b32 s45, 0
Lwi_89:
    global_load_dword v2, v1, s[40:41] sc1
    s_add_u32 s45, s45, 1
    s_cmp_gt_u32 s45, 0x100000
    s_cbranch_scc1 Lwi_90
    s_waitcnt vmcnt(0)
    v_readfirstlane_b32 s44, v2
    s_nop 0
    s_cmp_lt_u32 s44, 8
    s_cbranch_scc1 Lwi_89
Lwi_90:
    s_branch L_phase2
L_gemm1:
    s_cmp_ge_u32 s6, 48
    s_cbranch_scc1 Lg1A_92
    s_lshr_b32 s54, s6, 4
    s_and_b32 s55, s6, 15
    s_mov_b32 s44, s28
    s_mov_b32 s45, s29
    s_cmp_eq_u32 s54, 1
    s_cselect_b32 s44, s30, s44
    s_cselect_b32 s45, s31, s45
    s_cselect_b32 s64, 1, 0
    s_cmp_eq_u32 s54, 2
    s_cselect_b32 s44, s26, s44
    s_cselect_b32 s45, s27, s45
    s_cselect_b32 s66, 8192, 0
    s_add_u32 s66, s66, 84475904
    s_mov_b32 s46, 8192
    s_lshl_b32 s56, s54, 24
    s_lshl_b32 s57, s55, 1
    s_lshr_b32 s58, s3, 1
    s_add_u32 s57, s57, s58
    s_lshl_b32 s57, s57, 6
    s_add_u32 s57, s57, s7
    s_lshl_b32 s57, s57, 13
    s_add_u32 s56, s56, s57
    s_and_b32 s57, s3, 1
    s_add_u32 s58, s64, 11
    s_lshl_b32 s57, s57, s58
    s_add_u32 s56, s56, s57
    s_add_u32 s48, s42, s56
    s_addc_u32 s49, s43, 0
    s_mov_b32 s50, 32768
    v_and_b32 v1, 15, v0
    v_lshlrev_b32 v6, 4, v1
    v_lshrrev_b32 v1, 5, v0
    v_lshl_add_u32 v6, v1, 8, v6
    s_lshl_b32 s57, s64, 1
    s_sub_u32 s57, 12, s57
    v_bfe_u32 v1, v0, 4, 1
    v_lshlrev_b32 v1, s57, v1
    v_add_u32 v6, v6, v1
    s_lshl_b32 s55, s55, 9
    s_branch Lg1go_93
Lg1A_92:
    s_sub_u32 s55, s6, 48
    s_lshr_b32 s54, s55, 1
    s_mov_b32 s44, s18
    s_mov_b32 s45, s19
    s_mov_b32 s46, 3072
    s_cmp_eq_u32 s54, 2
    s_cselect_b32 s64, 3, 2
    s_mov_b32 s66, 84492288
    s_lshl_b32 s56, s54, 21
    s_lshl_b32 s57, s7, 15
    s_add_u32 s56, s56, s57
    s_and_b32 s57, s55, 1
    s_lshl_b32 s57, s57, 14
    s_add_u32 s56, s56, s57
    s_lshl_b32 s57, s3, 12
    s_add_u32 s56, s56, s57
    s_add_u32 s48, s42, s56
    s_addc_u32 s49, s43, 0
    s_add_u32 s48, s48, 75497472
    s_addc_u32 s49, s49, 0
    s_mov_b32 s50, 131072
    v_lshlrev_b32 v6, 4, v0
    s_lshl_b32 s55, s55, 9
Lg1go_93:
    s_lshl_b32 s56, s3, 7
    s_add_u32 s55, s55, s56
    s_add_u32 s44, s44, s55
    s_addc_u32 s45, s45, 0
    v_lshrrev_b32 v1, 4, v0
    v_add_u32 v1, 0, v1
    v_and_b32 v2, 15, v0
    v_xor_b32 v2, v2, v1
    v_lshlrev_b32 v2, 4, v2
    v_lshl_add_u32 v100, v1, 10, v2
    s_lshl_b32 s54, s3, 8
    v_add_u32 v100, s54, v100
    v_lshrrev_b32 v1, 4, v0
    v_add_u32 v1, 4, v1
    v_and_b32 v2, 15, v0
    v_xor_b32 v2, v2, v1
    v_lshlrev_b32 v2, 4, v2
    v_lshl_add_u32 v101, v1, 10, v2
    s_lshl_b32 s54, s3, 8
    v_add_u32 v101, s54, v101
    v_lshrrev_b32 v1, 4, v0
    v_add_u32 v1, 8, v1
    v_and_b32 v2, 15, v0
    v_xor_b32 v2, v2, v1
    v_lshlrev_b32 v2, 4, v2
    v_lshl_add_u32 v102, v1, 10, v2
    s_lshl_b32 s54, s3, 8
    v_add_u32 v102, s54, v102
    v_lshrrev_b32 v1, 4, v0
    v_add_u32 v1, 12, v1
    v_and_b32 v2, 15, v0
    v_xor_b32 v2, v2, v1
    v_lshlrev_b32 v2, 4, v2
    v_lshl_add_u32 v103, v1, 10, v2
    s_lshl_b32 s54, s3, 8
    v_add_u32 v103, s54, v103
    s_lshl_b32 s54, s7, 15
    s_add_u32 s52, s16, s54
    s_addc_u32 s53, s17, 0
    s_mov_b32 s61, 131072
    s_lshl_b32 s54, s3, 13
    s_add_u32 s54, s54, s61
    s_add_u32 m0, s54, 0
    s_nop 0
    global_load_lds_dwordx4 v100, s[52:53]
    s_add_u32 m0, s54, 1024
    s_nop 0
    global_load_lds_dwordx4 v101, s[52:53]
    s_add_u32 m0, s54, 2048
    s_nop 0
    global_load_lds_dwordx4 v102, s[52:53]
    s_add_u32 m0, s54, 3072
    s_nop 0
    global_load_lds_dwordx4 v103, s[52:53]
    s_add_u32 m0, s54, 4096
    s_add_u32 s52, s52, 16384
    s_addc_u32 s53, s53, 0
    global_load_lds_dwordx4 v100, s[52:53]
    s_add_u32 m0, s54, 5120
    s_nop 0
    global_load_lds_dwordx4 v101, s[52:53]
    s_add_u32 m0, s54, 6144
    s_nop 0
    global_load_lds_dwordx4 v102, s[52:53]
    s_add_u32 m0, s54, 7168
    s_nop 0
    global_load_lds_dwordx4 v103, s[52:53]
    s_add_u32 s52, s52, 114688
    s_addc_u32 s53, s53, 0
    v_lshrrev_b32 v1, 3, v0
    v_mul_lo_u32 v3, v1, s46
    v_and_b32 v1, 7, v0
    v_lshl_add_u32 v3, v1, 4, v3
    s_lshl_b32 s63, s3, 15
    v_lshrrev_b32 v1, 5, v0
    v_lshlrev_b32 v4, 10, v1
    v_bfe_u32 v1, v0, 2, 2
    v_lshl_add_u32 v4, v1, 7, v4
    v_bfe_u32 v1, v0, 4, 1
    v_lshl_add_u32 v4, v1, 5, v4
    v_and_b32 v1, 3, v0
    v_lshl_add_u32 v4, v1, 3, v4
    v_add_u32 v4, s63, v4
    s_lshl_b32 s58, s46, 3
    s_add_u32 m0, s63, 0
    s_nop 0
    global_load_lds_dwordx4 v3, s[44:45]
    s_add_u32 s44, s44, s58
    s_addc_u32 s45, s45, 0
    s_add_u32 m0, s63, 1024
    s_nop 0
    global_load_lds_dwordx4 v3, s[44:45]
    s_add_u32 s44, s44, s58
    s_addc_u32 s45, s45, 0
    s_add_u32 m0, s63, 2048
    s_nop 0
    global_load_lds_dwordx4 v3, s[44:45]
    s_add_u32 s44, s44, s58
    s_addc_u32 s45, s45, 0
    s_add_u32 m0, s63, 3072
    s_nop 0
    global_load_lds_dwordx4 v3, s[44:45]
    s_add_u32 s44, s44, s58
    s_addc_u32 s45, s45, 0
    s_add_u32 m0, s63, 4096
    s_nop 0
    global_load_lds_dwordx4 v3, s[44:45]
    s_add_u32 s44, s44, s58
    s_addc_u32 s45, s45, 0
    s_add_u32 m0, s63, 5120
    s_nop 0
    global_load_lds_dwordx4 v3, s[44:45]
    s_add_u32 s44, s44, s58
    s_addc_u32 s45, s45, 0
    s_add_u32 m0, s63, 6144
    s_nop 0
    global_load_lds_dwordx4 v3, s[44:45]
    s_add_u32 s44, s44, s58
    s_addc_u32 s45, s45, 0
    s_add_u32 m0, s63, 7168
    s_nop 0
    global_load_lds_dwordx4 v3, s[44:45]
    s_add_u32 s44, s44, s58
    s_addc_u32 s45, s45, 0
    s_add_u32 m0, s63, 8192
    s_nop 0
    global_load_lds_dwordx4 v3, s[44:45]
    s_add_u32 s44, s44, s58
    s_addc_u32 s45, s45, 0
    s_add_u32 m0, s63, 9216
    s_nop 0
    global_load_lds_dwordx4 v3, s[44:45]
    s_add_u32 s44, s44, s58
    s_addc_u32 s45, s45, 0
    s_add_u32 m0, s63, 10240
    s_nop 0
    global_load_lds_dwordx4 v3, s[44:45]
    s_add_u32 s44, s44, s58
    s_addc_u32 s45, s45, 0
    s_add_u32 m0, s63, 11264
    s_nop 0
    global_load_lds_dwordx4 v3, s[44:45]
    s_add_u32 s44, s44, s58
    s_addc_u32 s45, s45, 0
    s_add_u32 m0, s63, 12288
    s_nop 0
    global_load_lds_dwordx4 v3, s[44:45]
    s_add_u32 s44, s44, s58
    s_addc_u32 s45, s45, 0
    s_add_u32 m0, s63, 13312
    s_nop 0
    global_load_lds_dwordx4 v3, s[44:45]
    s_add_u32 s44, s44, s58
    s_addc_u32 s45, s45, 0
    s_add_u32 m0, s63, 14336
    s_nop 0
    global_load_lds_dwordx4 v3, s[44:45]
    s_add_u32 s44, s44, s58
    s_addc_u32 s45, s45, 0
    s_add_u32 m0, s63, 15360
    s_nop 0
    global_load_lds_dwordx4 v3, s[44:45]
    s_add_u32 s44, s44, s58
    s_addc_u32 s45, s45, 0
    s_add_u32 m0, s63, 16384
    s_nop 0
    global_load_lds_dwordx4 v3, s[44:45]
    s_add_u32 s44, s44, s58
    s_addc_u32 s45, s45, 0
    s_add_u32 m0, s63, 17408
    s_nop 0
    global_load_lds_dwordx4 v3, s[44:45]
    s_add_u32 s44, s44, s58
    s_addc_u32 s45, s45, 0
    s_add_u32 m0, s63, 18432
    s_nop 0
    global_load_lds_dwordx4 v3, s[44:45]
    s_add_u32 s44, s44, s58
    s_addc_u32 s45, s45, 0
    s_add_u32 m0, s63, 19456
    s_nop 0
    global_load_lds_dwordx4 v3, s[44:45]
    s_add_u32 s44, s44, s58
    s_addc_u32 s45, s45, 0
    s_add_u32 m0, s63, 20480
    s_nop 0
    global_load_lds_dwordx4 v3, s[44:45]
    s_add_u32 s44, s44, s58
    s_addc_u32 s45, s45, 0
    s_add_u32 m0, s63, 21504
    s_nop 0
    global_load_lds_dwordx4 v3, s[44:45]
    s_add_u32 s44, s44, s58
    s_addc_u32 s45, s45, 0
    s_add_u32 m0, s63, 22528
    s_nop 0
    global_load_lds_dwordx4 v3, s[44:45]
    s_add_u32 s44, s44, s58
    s_addc_u32 s45, s45, 0
    s_add_u32 m0, s63, 23552
    s_nop 0
    global_load_lds_dwordx4 v3, s[44:45]
    s_add_u32 s44, s44, s58
    s_addc_u32 s45, s45, 0
    s_add_u32 m0, s63, 24576
    s_nop 0
    global_load_lds_dwordx4 v3, s[44:45]
    s_add_u32 s44, s44, s58
    s_addc_u32 s45, s45, 0
    s_add_u32 m0, s63, 25600
    s_nop 0
    global_load_lds_dwordx4 v3, s[44:45]
    s_add_u32 s44, s44, s58
    s_addc_u32 s45, s45, 0
    s_add_u32 m0, s63, 26624
    s_nop 0
    global_load_lds_dwordx4 v3, s[44:45]
    s_add_u32 s44, s44, s58
    s_addc_u32 s45, s45, 0
    s_add_u32 m0, s63, 27648
    s_nop 0
    global_load_lds_dwordx4 v3, s[44:45]
    s_add_u32 s44, s44, s58
    s_addc_u32 s45, s45, 0
    s_add_u32 m0, s63, 28672
    s_nop 0
    global_load_lds_dwordx4 v3, s[44:45]
    s_add_u32 s44, s44, s58
    s_addc_u32 s45, s45, 0
    s_add_u32 m0, s63, 29696
    s_nop 0
    global_load_lds_dwordx4 v3, s[44:45]
    s_add_u32 s44, s44, s58
    s_addc_u32 s45, s45, 0
    s_add_u32 m0, s63, 30720
    s_nop 0
    global_load_lds_dwordx4 v3, s[44:45]
    s_add_u32 s44, s44, s58
    s_addc_u32 s45, s45, 0
    s_add_u32 m0, s63, 31744
    s_nop 0
    global_load_lds_dwordx4 v3, s[44:45]
    s_add_u32 s44, s44, s58
    s_addc_u32 s45, s45, 0
    s_waitcnt vmcnt(28)
    ds_read_b64_tr_b16 a[0:1], v4 offset:0
    ds_read_b64_tr_b16 a[2:3], v4 offset:512
    ds_read_b64_tr_b16 a[128:129], v4 offset:64
    ds_read_b64_tr_b16 a[130:131], v4 offset:576
    ds_read_b64_tr_b16 a[4:5], v4 offset:2048
    ds_read_b64_tr_b16 a[6:7], v4 offset:2560
    ds_read_b64_tr_b16 a[132:133], v4 offset:2112
    ds_read_b64_tr_b16 a[134:135], v4 offset:2624
    s_waitcnt lgkmcnt(0)
    s_add_u32 m0, s63, 0
    s_nop 0
    global_load_lds_dwordx4 v3, s[44:45]
    s_add_u32 s44, s44, s58
    s_addc_u32 s45, s45, 0
    s_add_u32 m0, s63, 1024
    s_nop 0
    global_load_lds_dwordx4 v3, s[44:45]
    s_add_u32 s44, s44, s58
    s_addc_u32 s45, s45, 0
    s_add_u32 m0, s63, 2048
    s_nop 0
    global_load_lds_dwordx4 v3, s[44:45]
    s_add_u32 s44, s44, s58
    s_addc_u32 s45, s45, 0
    s_add_u32 m0, s63, 3072
    s_nop 0
    global_load_lds_dwordx4 v3, s[44:45]
    s_add_u32 s44, s44, s58
    s_addc_u32 s45, s45, 0
    s_waitcnt vmcnt(28)
    ds_read_b64_tr_b16 a[8:9], v4 offset:4096
    ds_read_b64_tr_b16 a[10:11], v4 offset:4608
    ds_read_b64_tr_b16 a[136:137], v4 offset:4160
    ds_read_b64_tr_b16 a[138:139], v4 offset:4672
    ds_read_b64_tr_b16 a[12:13], v4 offset:6144
    ds_read_b64_tr_b16 a[14:15], v4 offset:6656
    ds_read_b64_tr_b16 a[140:141], v4 offset:6208
    ds_read_b64_tr_b16 a[142:143], v4 offset:6720
    s_waitcnt lgkmcnt(0)
    s_add_u32 m0, s63, 4096
    s_nop 0
    global_load_lds_dwordx4 v3, s[44:45]
    s_add_u32 s44, s44, s58
    s_addc_u32 s45, s45, 0
    s_add_u32 m0, s63, 5120
    s_nop 0
    global_load_lds_dwordx4 v3, s[44:45]
    s_add_u32 s44, s44, s58
    s_addc_u32 s45, s45, 0
    s_add_u32 m0, s63, 6144
    s_nop 0
    global_load_lds_dwordx4 v3, s[44:45]
    s_add_u32 s44, s44, s58
    s_addc_u32 s45, s45, 0
    s_add_u32 m0, s63, 7168
    s_nop 0
    global_load_lds_dwordx4 v3, s[44:45]
    s_add_u32 s44, s44, s58
    s_addc_u32 s45, s45, 0
    s_waitcnt vmcnt(28)
    ds_read_b64_tr_b16 a[16:17], v4 offset:8192
    ds_read_b64_tr_b16 a[18:19], v4 offset:8704
    ds_read_b64_tr_b16 a[144:145], v4 offset:8256
    ds_read_b64_tr_b16 a[146:147], v4 offset:8768
    ds_read_b64_tr_b16 a[20:21], v4 offset:10240
    ds_read_b64_tr_b16 a[22:23], v4 offset:10752
    ds_read_b64_tr_b16 a[148:149], v4 offset:10304
    ds_read_b64_tr_b16 a[150:151], v4 offset:10816
    s_waitcnt lgkmcnt(0)
    s_add_u32 m0, s63, 8192
    s_nop 0
    global_load_lds_dwordx4 v3, s[44:45]
    s_add_u32 s44, s44, s58
    s_addc_u32 s45, s45, 0
    s_add_u32 m0, s63, 9216
    s_nop 0
    global_load_lds_dwordx4 v3, s[44:45]
    s_add_u32 s44, s44, s58
    s_addc_u32 s45, s45, 0
    s_add_u32 m0, s63, 10240
    s_nop 0
    global_load_lds_dwordx4 v3, s[44:45]
    s_add_u32 s44, s44, s58
    s_addc_u32 s45, s45, 0
    s_add_u32 m0, s63, 11264
    s_nop 0
    global_load_lds_dwordx4 v3, s[44:45]
    s_add_u32 s44, s44, s58
    s_addc_u32 s45, s45, 0
    s_waitcnt vmcnt(28)
    ds_read_b64_tr_b16 a[24:25], v4 offset:12288
    ds_read_b64_tr_b16 a[26:27], v4 offset:12800
    ds_read_b64_tr_b16 a[152:153], v4 offset:12352
    ds_read_b64_tr_b16 a[154:155], v4 offset:12864
    ds_read_b64_tr_b16 a[28:29], v4 offset:14336
    ds_read_b64_tr_b16 a[30:31], v4 offset:14848
    ds_read_b64_tr_b16 a[156:157], v4 offset:14400
    ds_read_b64_tr_b16 a[158:159], v4 offset:14912
    s_waitcnt lgkmcnt(0)
    s_add_u32 m0, s63, 12288
    s_nop 0
    global_load_lds_dwordx4 v3, s[44:45]
    s_add_u32 s44, s44, s58
    s_addc_u32 s45, s45, 0
    s_add_u32 m0, s63, 13312
    s_nop 0
    global_load_lds_dwordx4 v3, s[44:45]
    s_add_u32 s44, s44, s58
    s_addc_u32 s45, s45, 0
    s_add_u32 m0, s63, 14336
    s_nop 0
    global_load_lds_dwordx4 v3, s[44:45]
    s_add_u32 s44, s44, s58
    s_addc_u32 s45, s45, 0
    s_add_u32 m0, s63, 15360
    s_nop 0
    global_load_lds_dwordx4 v3, s[44:45]
    s_add_u32 s44, s44, s58
    s_addc_u32 s45, s45, 0
    s_waitcnt vmcnt(28)
    ds_read_b64_tr_b16 a[32:33], v4 offset:16384
    ds_read_b64_tr_b16 a[34:35], v4 offset:16896
    ds_read_b64_tr_b16 a[160:161], v4 offset:16448
    ds_read_b64_tr_b16 a[162:163], v4 offset:16960
    ds_read_b64_tr_b16 a[36:37], v4 offset:18432
    ds_read_b64_tr_b16 a[38:39], v4 offset:18944
    ds_read_b64_tr_b16 a[164:165], v4 offset:18496
    ds_read_b64_tr_b16 a[166:167], v4 offset:19008
    s_waitcnt lgkmcnt(0)
    s_add_u32 m0, s63, 16384
    s_nop 0
    global_load_lds_dwordx4 v3, s[44:45]
    s_add_u32 s44, s44, s58
    s_addc_u32 s45, s45, 0
    s_add_u32 m0, s63, 17408
    s_nop 0
    global_load_lds_dwordx4 v3, s[44:45]
    s_add_u32 s44, s44, s58
    s_addc_u32 s45, s45, 0
    s_add_u32 m0, s63, 18432
    s_nop 0
    global_load_lds_dwordx4 v3, s[44:45]
    s_add_u32 s44, s44, s58
    s_addc_u32 s45, s45, 0
    s_add_u32 m0, s63, 19456
    s_nop 0
    global_load_lds_dwordx4 v3, s[44:45]
    s_add_u32 s44, s44, s58
    s_addc_u32 s45, s45, 0
    s_waitcnt vmcnt(28)
    ds_read_b64_tr_b16 a[40:41], v4 offset:20480
    ds_read_b64_tr_b16 a[42:43], v4 offset:20992
    ds_read_b64_tr_b16 a[168:169], v4 offset:20544
    ds_read_b64_tr_b16 a[170:171], v4 offset:21056
    ds_read_b64_tr_b16 a[44:45], v4 offset:22528
    ds_read_b64_tr_b16 a[46:47], v4 offset:23040
    ds_read_b64_tr_b16 a[172:173], v4 offset:22592
    ds_read_b64_tr_b16 a[174:175], v4 offset:23104
    s_waitcnt lgkmcnt(0)
    s_add_u32 m0, s63, 20480
    s_nop 0
    global_load_lds_dwordx4 v3, s[44:45]
    s_add_u32 s44, s44, s58
    s_addc_u32 s45, s45, 0
    s_add_u32 m0, s63, 21504
    s_nop 0
    global_load_lds_dwordx4 v3, s[44:45]
    s_add_u32 s44, s44, s58
    s_addc_u32 s45, s45, 0
    s_add_u32 m0, s63, 22528
    s_nop 0
    global_load_lds_dwordx4 v3, s[44:45]
    s_add_u32 s44, s44, s58
    s_addc_u32 s45, s45, 0
    s_add_u32 m0, s63, 23552
    s_nop 0
    global_load_lds_dwordx4 v3, s[44:45]
    s_add_u32 s44, s44, s58
    s_addc_u32 s45, s45, 0
    s_waitcnt vmcnt(28)
    ds_read_b64_tr_b16 a[48:49], v4 offset:24576
    ds_read_b64_tr_b16 a[50:51], v4 offset:25088
    ds_read_b64_tr_b16 a[176:177], v4 offset:24640
    ds_read_b64_tr_b16 a[178:179], v4 offset:25152
    ds_read_b64_tr_b16 a[52:53], v4 offset:26624
    ds_read_b64_tr_b16 a[54:55], v4 offset:27136
    ds_read_b64_tr_b16 a[180:181], v4 offset:26688
    ds_read_b64_tr_b16 a[182:183], v4 offset:27200
    s_waitcnt lgkmcnt(0)
    s_add_u32 m0, s63, 24576
    s_nop 0
    global_load_lds_dwordx4 v3, s[44:45]
    s_add_u32 s44, s44, s58
    s_addc_u32 s45, s45, 0
    s_add_u32 m0, s63, 25600
    s_nop 0
    global_load_lds_dwordx4 v3, s[44:45]
    s_add_u32 s44, s44, s58
    s_addc_u32 s45, s45, 0
    s_add_u32 m0, s63, 26624
    s_nop 0
    global_load_lds_dwordx4 v3, s[44:45]
    s_add_u32 s44, s44, s58
    s_addc_u32 s45, s45, 0
    s_add_u32 m0, s63, 27648
    s_nop 0
    global_load_lds_dwordx4 v3, s[44:45]
    s_add_u32 s44, s44, s58
    s_addc_u32 s45, s45, 0
    s_waitcnt vmcnt(28)
    ds_read_b64_tr_b16 a[56:57], v4 offset:28672
    ds_read_b64_tr_b16 a[58:59], v4 offset:29184
    ds_read_b64_tr_b16 a[184:185], v4 offset:28736
    ds_read_b64_tr_b16 a[186:187], v4 offset:29248
    ds_read_b64_tr_b16 a[60:61], v4 offset:30720
    ds_read_b64_tr_b16 a[62:63], v4 offset:31232
    ds_read_b64_tr_b16 a[188:189], v4 offset:30784
    ds_read_b64_tr_b16 a[190:191], v4 offset:31296
    s_waitcnt lgkmcnt(0)
    s_add_u32 m0, s63, 28672
    s_nop 0
    global_load_lds_dwordx4 v3, s[44:45]
    s_add_u32 s44, s44, s58
    s_addc_u32 s45, s45, 0
    s_add_u32 m0, s63, 29696
    s_nop 0
    global_load_lds_dwordx4 v3, s[44:45]
    s_add_u32 s44, s44, s58
    s_addc_u32 s45, s45, 0
    s_add_u32 m0, s63, 30720
    s_nop 0
    global_load_lds_dwordx4 v3, s[44:45]
    s_add_u32 s44, s44, s58
    s_addc_u32 s45, s45, 0
    s_add_u32 m0, s63, 31744
    s_nop 0
    global_load_lds_dwordx4 v3, s[44:45]
    s_add_u32 s44, s44, s58
    s_addc_u32 s45, s45, 0
    s_waitcnt vmcnt(28)
    ds_read_b64_tr_b16 a[64:65], v4 offset:0
    ds_read_b64_tr_b16 a[66:67], v4 offset:512
    ds_read_b64_tr_b16 a[192:193], v4 offset:64
    ds_read_b64_tr_b16 a[194:195], v4 offset:576
    ds_read_b64_tr_b16 a[68:69], v4 offset:2048
    ds_read_b64_tr_b16 a[70:71], v4 offset:2560
    ds_read_b64_tr_b16 a[196:197], v4 offset:2112
    ds_read_b64_tr_b16 a[198:199], v4 offset:2624
    s_waitcnt lgkmcnt(0)
    s_waitcnt vmcnt(24)
    ds_read_b64_tr_b16 a[72:73], v4 offset:4096
    ds_read_b64_tr_b16 a[74:75], v4 offset:4608
    ds_read_b64_tr_b16 a[200:201], v4 offset:4160
    ds_read_b64_tr_b16 a[202:203], v4 offset:4672
    ds_read_b64_tr_b16 a[76:77], v4 offset:6144
    ds_read_b64_tr_b16 a[78:79], v4 offset:6656
    ds_read_b64_tr_b16 a[204:205], v4 offset:6208
    ds_read_b64_tr_b16 a[206:207], v4 offset:6720
    s_waitcnt lgkmcnt(0)
    s_waitcnt vmcnt(20)
    ds_read_b64_tr_b16 a[80:81], v4 offset:8192
    ds_read_b64_tr_b16 a[82:83], v4 offset:8704
    ds_read_b64_tr_b16 a[208:209], v4 offset:8256
    ds_read_b64_tr_b16 a[210:211], v4 offset:8768
    ds_read_b64_tr_b16 a[84:85], v4 offset:10240
    ds_read_b64_tr_b16 a[86:87], v4 offset:10752
    ds_read_b64_tr_b16 a[212:213], v4 offset:10304
    ds_read_b64_tr_b16 a[214:215], v4 offset:10816
    s_waitcnt lgkmcnt(0)
    s_waitcnt vmcnt(16)
    ds_read_b64_tr_b16 a[88:89], v4 offset:12288
    ds_read_b64_tr_b16 a[90:91], v4 offset:12800
    ds_read_b64_tr_b16 a[216:217], v4 offset:12352
    ds_read_b64_tr_b16 a[218:219], v4 offset:12864
    ds_read_b64_tr_b16 a[92:93], v4 offset:14336
    ds_read_b64_tr_b16 a[94:95], v4 offset:14848
    ds_read_b64_tr_b16 a[220:221], v4 offset:14400
    ds_read_b64_tr_b16 a[222:223], v4 offset:14912
    s_waitcnt lgkmcnt(0)
    s_waitcnt vmcnt(12)
    ds_read_b64_tr_b16 a[96:97], v4 offset:16384
    ds_read_b64_tr_b16 a[98:99], v4 offset:16896
    ds_read_b64_tr_b16 a[224:225], v4 offset:16448
    ds_read_b64_tr_b16 a[226:227], v4 offset:16960
    ds_read_b64_tr_b16 a[100:101], v4 offset:18432
    ds_read_b64_tr_b16 a[102:103], v4 offset:18944
    ds_read_b64_tr_b16 a[228:229], v4 offset:18496
    ds_read_b64_tr_b16 a[230:231], v4 offset:19008
    s_waitcnt lgkmcnt(0)
    s_waitcnt vmcnt(8)
    ds_read_b64_tr_b16 a[104:105], v4 offset:20480
    ds_read_b64_tr_b16 a[106:107], v4 offset:20992
    ds_read_b64_tr_b16 a[232:233], v4 offset:20544
    ds_read_b64_tr_b16 a[234:235], v4 offset:21056
    ds_read_b64_tr_b16 a[108:109], v4 offset:22528
    ds_read_b64_tr_b16 a[110:111], v4 offset:23040
    ds_read_b64_tr_b16 a[236:237], v4 offset:22592
    ds_read_b64_tr_b16 a[238:239], v4 offset:23104
    s_waitcnt lgkmcnt(0)
    s_waitcnt vmcnt(4)
    ds_read_b64_tr_b16 a[112:113], v4 offset:24576
    ds_read_b64_tr_b16 a[114:115], v4 offset:25088
    ds_read_b64_tr_b16 a[240:241], v4 offset:24640
    ds_read_b64_tr_b16 a[242:243], v4 offset:25152
    ds_read_b64_tr_b16 a[116:117], v4 offset:26624
    ds_read_b64_tr_b16 a[118:119], v4 offset:27136
    ds_read_b64_tr_b16 a[244:245], v4 offset:26688
    ds_read_b64_tr_b16 a[246:247], v4 offset:27200
    s_waitcnt lgkmcnt(0)
    s_waitcnt vmcnt(0)
    ds_read_b64_tr_b16 a[120:121], v4 offset:28672
    ds_read_b64_tr_b16 a[122:123], v4 offset:29184
    ds_read_b64_tr_b16 a[248:249], v4 offset:28736
    ds_read_b64_tr_b16 a[250:251], v4 offset:29248
    ds_read_b64_tr_b16 a[124:125], v4 offset:30720
    ds_read_b64_tr_b16 a[126:127], v4 offset:31232
    ds_read_b64_tr_b16 a[252:253], v4 offset:30784
    ds_read_b64_tr_b16 a[254:255], v4 offset:31296
    s_waitcnt lgkmcnt(0)
    v_and_b32 v1, 31, v0
    v_lshrrev_b32 v2, 5, v0
    v_and_b32 v3, 15, v0
    v_xor_b32 v2, v2, v3
    v_xor_b32 v3, 0, v2
    v_lshlrev_b32 v3, 4, v3
    v_lshl_add_u32 v8, v1, 8, v3
    v_xor_b32 v3, 2, v2
    v_lshlrev_b32 v3, 4, v3
    v_lshl_add_u32 v9, v1, 8, v3
    v_xor_b32 v3, 4, v2
    v_lshlrev_b32 v3, 4, v3
    v_lshl_add_u32 v10, v1, 8, v3
    v_xor_b32 v3, 6, v2
    v_lshlrev_b32 v3, 4, v3
    v_lshl_add_u32 v11, v1, 8, v3
    v_xor_b32 v3, 8, v2
    v_lshlrev_b32 v3, 4, v3
    v_lshl_add_u32 v12, v1, 8, v3
    v_xor_b32 v3, 10, v2
    v_lshlrev_b32 v3, 4, v3
    v_lshl_add_u32 v13, v1, 8, v3
    v_xor_b32 v3, 12, v2
    v_lshlrev_b32 v3, 4, v3
    v_lshl_add_u32 v14, v1, 8, v3
    v_xor_b32 v3, 14, v2
    v_lshlrev_b32 v3, 4, v3
    v_lshl_add_u32 v15, v1, 8, v3
    v_mov_b32 v1, 128
    s_mov_b32 s55, 0
Lwi_94:
    global_load_dword v2, v1, s[40:41] sc1
    s_add_u32 s55, s55, 1
    s_cmp_gt_u32 s55, 0x100000
    s_cbranch_scc1 Lwi_95
    s_waitcnt vmcnt(0)
    v_readfirstlane_b32 s54, v2
    s_nop 0
    s_cmp_lt_u32 s54, 8
    s_cbranch_scc1 Lwi_94
Lwi_95:
    s_barrier
    s_mov_b32 s62, 0
    s_lshl_b32 s54, s3, 13
    s_add_u32 s54, s54, s62
    s_add_u32 m0, s54, 0
    s_nop 0
    global_load_lds_dwordx4 v100, s[52:53]
    s_add_u32 m0, s54, 1024
    s_nop 0
    global_load_lds_dwordx4 v101, s[52:53]
    s_add_u32 m0, s54, 2048
    s_nop 0
    global_load_lds_dwordx4 v102, s[52:53]
    s_add_u32 m0, s54, 3072
    s_nop 0
    global_load_lds_dwordx4 v103, s[52:53]
    s_add_u32 m0, s54, 4096
    s_add_u32 s52, s52, 16384
    s_addc_u32 s53, s53, 0
    global_load_lds_dwordx4 v100, s[52:53]
    s_add_u32 m0, s54, 5120
    s_nop 0
    global_load_lds_dwordx4 v101, s[52:53]
    s_add_u32 m0, s54, 6144
    s_nop 0
    global_load_lds_dwordx4 v102, s[52:53]
    s_add_u32 m0, s54, 7168
    s_nop 0
    global_load_lds_dwordx4 v103, s[52:53]
    s_add_u32 s52, s52, 114688
    s_addc_u32 s53, s53, 0
    s_mov_b32 s62, 32768
    s_mov_b32 s60, 0
    s_mov_b32 s65, s7
    v_add_u32 v8, 131072, v8
    v_add_u32 v9, 131072, v9
    v_add_u32 v10, 131072, v10
    v_add_u32 v11, 131072, v11
    v_add_u32 v12, 131072, v12
    v_add_u32 v13, 131072, v13
    v_add_u32 v14, 131072, v14
    v_add_u32 v15, 131072, v15
    s_cmp_eq_u32 s64, 1
    s_cbranch_scc1 Lg1t_98
    s_cmp_eq_u32 s64, 2
    s_cbranch_scc1 Lg1t_99
    s_cmp_eq_u32 s64, 3
    s_cbranch_scc1 Lg1t_100
Lg1t_97:
    s_waitcnt vmcnt(12)
    s_cmp_eq_u32 s60, 15
    s_cbranch_scc0 Lg1np_101
    s_waitcnt vmcnt(4)
Lg1np_101:
    s_barrier
    s_cmp_lt_u32 s60, 2
    s_cbranch_scc1 Lg1s_102
    s_cmp_lg_u32 s3, 0
    s_cbranch_scc1 Lg1s_102
    s_add_i32 s56, s65, -8
    s_lshl_b32 s56, s56, 7
    s_add_u32 s56, s56, s66
    v_mov_b32 v1, s56
    v_mov_b32 v2, 1
    s_mov_b64 exec, 1
    global_atomic_add v1, v2, s[42:43]
    s_mov_b64 exec, -1
Lg1s_102:
    s_cmp_ge_u32 s60, 14
    s_cbranch_scc1 Lg1np_103
    s_lshl_b32 s54, s3, 13
    s_add_u32 s54, s54, s62
    s_add_u32 m0, s54, 0
    s_nop 0
    global_load_lds_dwordx4 v100, s[52:53]
    s_add_u32 m0, s54, 1024
    s_nop 0
    global_load_lds_dwordx4 v101, s[52:53]
    s_add_u32 m0, s54, 2048
    s_nop 0
    global_load_lds_dwordx4 v102, s[52:53]
    s_add_u32 m0, s54, 3072
    s_nop 0
    global_load_lds_dwordx4 v103, s[52:53]
    s_add_u32 m0, s54, 4096
    s_add_u32 s52, s52, 16384
    s_addc_u32 s53, s53, 0
    global_load_lds_dwordx4 v100, s[52:53]
    s_add_u32 m0, s54, 5120
    s_nop 0
    global_load_lds_dwordx4 v101, s[52:53]
    s_add_u32 m0, s54, 6144
    s_nop 0
    global_load_lds_dwordx4 v102, s[52:53]
    s_add_u32 m0, s54, 7168
    s_nop 0
    global_load_lds_dwordx4 v103, s[52:53]
    s_add_u32 s52, s52, 114688
    s_addc_u32 s53, s53, 0
Lg1np_103:
    ds_read_b128 v[16:19], v8 offset:0
    ds_read_b128 v[20:23], v9 offset:0
    ds_read_b128 v[24:27], v10 offset:0
    ds_read_b128 v[28:31], v11 offset:0
    ds_read_b128 v[32:35], v12 offset:0
    ds_read_b128 v[36:39], v13 offset:0
    s_waitcnt lgkmcnt(5)
    v_mfma_f32_32x32x16_bf16 v[48:63], a[0:3], v[16:19], 0
    v_mfma_f32_32x32x16_bf16 v[64:79], a[128:131], v[16:19], 0
    ds_read_b128 v[40:43], v14 offset:0
    s_waitcnt lgkmcnt(5)
    v_mfma_f32_32x32x16_bf16 v[48:63], a[4:7], v[20:23], v[48:63]
    v_mfma_f32_32x32x16_bf16 v[64:79], a[132:135], v[20:23], v[64:79]
    ds_read_b128 v[44:47], v15 offset:0
    s_waitcnt lgkmcnt(5)
    v_mfma_f32_32x32x16_bf16 v[48:63], a[8:11], v[24:27], v[48:63]
    v_mfma_f32_32x32x16_bf16 v[64:79], a[136:139], v[24:27], v[64:79]
    ds_read_b128 v[16:19], v8 offset:8192
    s_waitcnt lgkmcnt(5)
    v_mfma_f32_32x32x16_bf16 v[48:63], a[12:15], v[28:31], v[48:63]
    v_mfma_f32_32x32x16_bf16 v[64:79], a[140:143], v[28:31], v[64:79]
    ds_read_b128 v[20:23], v9 offset:8192
    s_waitcnt lgkmcnt(5)
    v_mfma_f32_32x32x16_bf16 v[48:63], a[16:19], v[32:35], v[48:63]
    v_mfma_f32_32x32x16_bf16 v[64:79], a[144:147], v[32:35], v[64:79]
    ds_read_b128 v[24:27], v10 offset:8192
    s_waitcnt lgkmcnt(5)
    v_mfma_f32_32x32x16_bf16 v[48:63], a[20:23], v[36:39], v[48:63]
    v_mfma_f32_32x32x16_bf16 v[64:79], a[148:151], v[36:39], v[64:79]
    ds_read_b128 v[28:31], v11 offset:8192
    s_waitcnt lgkmcnt(5)
    v_mfma_f32_32x32x16_bf16 v[48:63], a[24:27], v[40:43], v[48:63]
    v_mfma_f32_32x32x16_bf16 v[64:79], a[152:155], v[40:43], v[64:79]
    ds_read_b128 v[32:35], v12 offset:8192
    s_waitcnt lgkmcnt(5)
    v_mfma_f32_32x32x16_bf16 v[48:63], a[28:31], v[44:47], v[48:63]
    v_mfma_f32_32x32x16_bf16 v[64:79], a[156:159], v[44:47], v[64:79]
    ds_read_b128 v[36:39], v13 offset:8192
    s_waitcnt lgkmcnt(5)
    v_mfma_f32_32x32x16_bf16 v[48:63], a[32:35], v[16:19], v[48:63]
    v_mfma_f32_32x32x16_bf16 v[64:79], a[160:163], v[16:19], v[64:79]
    ds_read_b128 v[40:43], v14 offset:8192
    s_waitcnt lgkmcnt(5)
    v_mfma_f32_32x32x16_bf16 v[48:63], a[36:39], v[20:23], v[48:63]
    v_mfma_f32_32x32x16_bf16 v[64:79], a[164:167], v[20:23], v[64:79]
    ds_read_b128 v[44:47], v15 offset:8192
    s_waitcnt lgkmcnt(5)
    v_mfma_f32_32x32x16_bf16 v[48:63], a[40:43], v[24:27], v[48:63]
    v_mfma_f32_32x32x16_bf16 v[64:79], a[168:171], v[24:27], v[64:79]
    ds_read_b128 v[16:19], v8 offset:16384
    s_waitcnt lgkmcnt(5)
    v_mfma_f32_32x32x16_bf16 v[48:63], a[44:47], v[28:31], v[48:63]
    v_mfma_f32_32x32x16_bf16 v[64:79], a[172:175], v[28:31], v[64:79]
    ds_read_b128 v[20:23], v9 offset:16384
    s_waitcnt lgkmcnt(5)
    v_mfma_f32_32x32x16_bf16 v[48:63], a[48:51], v[32:35], v[48:63]
    v_mfma_f32_32x32x16_bf16 v[64:79], a[176:179], v[32:35], v[64:79]
    ds_read_b128 v[24:27], v10 offset:16384
    s_waitcnt lgkmcnt(5)
    v_mfma_f32_32x32x16_bf16 v[48:63], a[52:55], v[36:39], v[48:63]
    v_mfma_f32_32x32x16_bf16 v[64:79], a[180:183], v[36:39], v[64:79]
    ds_read_b128 v[28:31], v11 offset:16384
    s_waitcnt lgkmcnt(5)
    v_mfma_f32_32x32x16_bf16 v[48:63], a[56:59], v[40:43], v[48:63]
    v_mfma_f32_32x32x16_bf16 v[64:79], a[184:187], v[40:43], v[64:79]
    ds_read_b128 v[32:35], v12 offset:16384
    s_waitcnt lgkmcnt(5)
    v_mfma_f32_32x32x16_bf16 v[48:63], a[60:63], v[44:47], v[48:63]
    v_mfma_f32_32x32x16_bf16 v[64:79], a[188:191], v[44:47], v[64:79]
    ds_read_b128 v[36:39], v13 offset:16384
    s_waitcnt lgkmcnt(5)
    v_mfma_f32_32x32x16_bf16 v[48:63], a[64:67], v[16:19], v[48:63]
    v_mfma_f32_32x32x16_bf16 v[64:79], a[192:195], v[16:19], v[64:79]
    ds_read_b128 v[40:43], v14 offset:16384
    s_waitcnt lgkmcnt(5)
    v_mfma_f32_32x32x16_bf16 v[48:63], a[68:71], v[20:23], v[48:63]
    v_mfma_f32_32x32x16_bf16 v[64:79], a[196:199], v[20:23], v[64:79]
    ds_read_b128 v[44:47], v15 offset:16384
    s_waitcnt lgkmcnt(5)
    v_mfma_f32_32x32x16_bf16 v[48:63], a[72:75], v[24:27], v[48:63]
    v_mfma_f32_32x32x16_bf16 v[64:79], a[200:203], v[24:27], v[64:79]
    ds_read_b128 v[16:19], v8 offset:24576
    s_waitcnt lgkmcnt(5)
    v_mfma_f32_32x32x16_bf16 v[48:63], a[76:79], v[28:31], v[48:63]
    v_mfma_f32_32x32x16_bf16 v[64:79], a[204:207], v[28:31], v[64:79]
    ds_read_b128 v[20:23], v9 offset:24576
    s_waitcnt lgkmcnt(5)
    v_mfma_f32_32x32x16_bf16 v[48:63], a[80:83], v[32:35], v[48:63]
    v_mfma_f32_32x32x16_bf16 v[64:79], a[208:211], v[32:35], v[64:79]
    ds_read_b128 v[24:27], v10 offset:24576
    s_waitcnt lgkmcnt(5)
    v_mfma_f32_32x32x16_bf16 v[48:63], a[84:87], v[36:39], v[48:63]
    v_mfma_f32_32x32x16_bf16 v[64:79], a[212:215], v[36:39], v[64:79]
    ds_read_b128 v[28:31], v11 offset:24576
    s_waitcnt lgkmcnt(5)
    v_mfma_f32_32x32x16_bf16 v[48:63], a[88:91], v[40:43], v[48:63]
    v_mfma_f32_32x32x16_bf16 v[64:79], a[216:219], v[40:43], v[64:79]
    ds_read_b128 v[32:35], v12 offset:24576
    s_waitcnt lgkmcnt(5)
    v_mfma_f32_32x32x16_bf16 v[48:63], a[92:95], v[44:47], v[48:63]
    v_mfma_f32_32x32x16_bf16 v[64:79], a[220:223], v[44:47], v[64:79]
    ds_read_b128 v[36:39], v13 offset:24576
    s_waitcnt lgkmcnt(5)
    v_mfma_f32_32x32x16_bf16 v[48:63], a[96:99], v[16:19], v[48:63]
    v_mfma_f32_32x32x16_bf16 v[64:79], a[224:227], v[16:19], v[64:79]
    ds_read_b128 v[40:43], v14 offset:24576
    s_waitcnt lgkmcnt(5)
    v_mfma_f32_32x32x16_bf16 v[48:63], a[100:103], v[20:23], v[48:63]
    v_mfma_f32_32x32x16_bf16 v[64:79], a[228:231], v[20:23], v[64:79]
    ds_read_b128 v[44:47], v15 offset:24576
    s_waitcnt lgkmcnt(5)
    v_mfma_f32_32x32x16_bf16 v[48:63], a[104:107], v[24:27], v[48:63]
    v_mfma_f32_32x32x16_bf16 v[64:79], a[232:235], v[24:27], v[64:79]
    s_waitcnt lgkmcnt(4)
    v_mfma_f32_32x32x16_bf16 v[48:63], a[108:111], v[28:31], v[48:63]
    v_mfma_f32_32x32x16_bf16 v[64:79], a[236:239], v[28:31], v[64:79]
    s_waitcnt lgkmcnt(3)
    v_mfma_f32_32x32x16_bf16 v[48:63], a[112:115], v[32:35], v[48:63]
    v_mfma_f32_32x32x16_bf16 v[64:79], a[240:243], v[32:35], v[64:79]
    s_waitcnt lgkmcnt(2)
    v_mfma_f32_32x32x16_bf16 v[48:63], a[116:119], v[36:39], v[48:63]
    v_mfma_f32_32x32x16_bf16 v[64:79], a[244:247], v[36:39], v[64:79]
    s_waitcnt lgkmcnt(1)
    v_mfma_f32_32x32x16_bf16 v[48:63], a[120:123], v[40:43], v[48:63]
    v_mfma_f32_32x32x16_bf16 v[64:79], a[248:251], v[40:43], v[64:79]
    s_waitcnt lgkmcnt(0)
    v_mfma_f32_32x32x16_bf16 v[48:63], a[124:127], v[44:47], v[48:63]
    v_mfma_f32_32x32x16_bf16 v[64:79], a[252:255], v[44:47], v[64:79]
    s_add_u32 s54, s61, 32768
    s_cmp_ge_u32 s54, 98304
    s_cselect_b32 s54, 0, s54
    s_sub_u32 s55, s54, s61
    s_mov_b32 s61, s54
    v_add_u32 v8, s55, v8
    v_add_u32 v9, s55, v9
    v_add_u32 v10, s55, v10
    v_add_u32 v11, s55, v11
    v_add_u32 v12, s55, v12
    v_add_u32 v13, s55, v13
    v_add_u32 v14, s55, v14
    v_add_u32 v15, s55, v15
    s_add_u32 s62, s62, 32768
    s_cmp_ge_u32 s62, 98304
    s_cselect_b32 s62, 0, s62
    v_cvt_pk_bf16_f32 v80, v48, v49
    v_cvt_pk_bf16_f32 v81, v50, v51
    v_cvt_pk_bf16_f32 v82, v56, v57
    v_cvt_pk_bf16_f32 v83, v58, v59
    global_store_dwordx4 v6, v[80:83], s[48:49] offset:0 sc1
    v_cvt_pk_bf16_f32 v84, v52, v53
    v_cvt_pk_bf16_f32 v85, v54, v55
    v_cvt_pk_bf16_f32 v86, v60, v61
    v_cvt_pk_bf16_f32 v87, v62, v63
    global_store_dwordx4 v6, v[84:87], s[48:49] offset:512 sc1
    v_cvt_pk_bf16_f32 v88, v64, v65
    v_cvt_pk_bf16_f32 v89, v66, v67
    v_cvt_pk_bf16_f32 v90, v72, v73
    v_cvt_pk_bf16_f32 v91, v74, v75
    global_store_dwordx4 v6, v[88:91], s[48:49] offset:1024 sc1
    v_cvt_pk_bf16_f32 v92, v68, v69
    v_cvt_pk_bf16_f32 v93, v70, v71
    v_cvt_pk_bf16_f32 v94, v76, v77
    v_cvt_pk_bf16_f32 v95, v78, v79
    global_store_dwordx4 v6, v[92:95], s[48:49] offset:1536 sc1
    s_nop 0
    s_add_u32 s48, s48, s50
    s_addc_u32 s49, s49, 0
    s_add_u32 s60, s60, 1
    s_add_u32 s65, s65, 4
    s_cmp_lt_u32 s60, 16
    s_cbranch_scc1 Lg1t_97
    s_branch Lg1end_96
Lg1t_98:
    s_waitcnt vmcnt(12)
    s_cmp_eq_u32 s60, 15
    s_cbranch_scc0 Lg1np_104
    s_waitcnt vmcnt(4)
Lg1np_104:
    s_barrier
    s_cmp_lt_u32 s60, 2
    s_cbranch_scc1 Lg1s_105
    s_cmp_lg_u32 s3, 0
    s_cbranch_scc1 Lg1s_105
    s_add_i32 s56, s65, -8
    s_lshl_b32 s56, s56, 7
    s_add_u32 s56, s56, s66
    v_mov_b32 v1, s56
    v_mov_b32 v2, 1
    s_mov_b64 exec, 1
    global_atomic_add v1, v2, s[42:43]
    s_mov_b64 exec, -1
Lg1s_105:
    s_cmp_ge_u32 s60, 14
    s_cbranch_scc1 Lg1np_106
    s_lshl_b32 s54, s3, 13
    s_add_u32 s54, s54, s62
    s_add_u32 m0, s54, 0
    s_nop 0
    global_load_lds_dwordx4 v100, s[52:53]
    s_add_u32 m0, s54, 1024
    s_nop 0
    global_load_lds_dwordx4 v101, s[52:53]
    s_add_u32 m0, s54, 2048
    s_nop 0
    global_load_lds_dwordx4 v102, s[52:53]
    s_add_u32 m0, s54, 3072
    s_nop 0
    global_load_lds_dwordx4 v103, s[52:53]
    s_add_u32 m0, s54, 4096
    s_add_u32 s52, s52, 16384
    s_addc_u32 s53, s53, 0
    global_load_lds_dwordx4 v100, s[52:53]
    s_add_u32 m0, s54, 5120
    s_nop 0
    global_load_lds_dwordx4 v101, s[52:53]
    s_add_u32 m0, s54, 6144
    s_nop 0
    global_load_lds_dwordx4 v102, s[52:53]
    s_add_u32 m0, s54, 7168
    s_nop 0
    global_load_lds_dwordx4 v103, s[52:53]
    s_add_u32 s52, s52, 114688
    s_addc_u32 s53, s53, 0
Lg1np_106:
    ds_read_b128 v[16:19], v8 offset:0
    ds_read_b128 v[20:23], v9 offset:0
    ds_read_b128 v[24:27], v10 offset:0
    ds_read_b128 v[28:31], v11 offset:0
    ds_read_b128 v[32:35], v12 offset:0
    ds_read_b128 v[36:39], v13 offset:0
    s_waitcnt lgkmcnt(5)
    v_mfma_f32_32x32x16_bf16 v[48:63], v[16:19], a[0:3], 0
    v_mfma_f32_32x32x16_bf16 v[64:79], v[16:19], a[128:131], 0
    ds_read_b128 v[40:43], v14 offset:0
    s_waitcnt lgkmcnt(5)
    v_mfma_f32_32x32x16_bf16 v[48:63], v[20:23], a[4:7], v[48:63]
    v_mfma_f32_32x32x16_bf16 v[64:79], v[20:23], a[132:135], v[64:79]
    ds_read_b128 v[44:47], v15 offset:0
    s_waitcnt lgkmcnt(5)
    v_mfma_f32_32x32x16_bf16 v[48:63], v[24:27], a[8:11], v[48:63]
    v_mfma_f32_32x32x16_bf16 v[64:79], v[24:27], a[136:139], v[64:79]
    ds_read_b128 v[16:19], v8 offset:8192
    s_waitcnt lgkmcnt(5)
    v_mfma_f32_32x32x16_bf16 v[48:63], v[28:31], a[12:15], v[48:63]
    v_mfma_f32_32x32x16_bf16 v[64:79], v[28:31], a[140:143], v[64:79]
    ds_read_b128 v[20:23], v9 offset:8192
    s_waitcnt lgkmcnt(5)
    v_mfma_f32_32x32x16_bf16 v[48:63], v[32:35], a[16:19], v[48:63]
    v_mfma_f32_32x32x16_bf16 v[64:79], v[32:35], a[144:147], v[64:79]
    ds_read_b128 v[24:27], v10 offset:8192
    s_waitcnt lgkmcnt(5)
    v_mfma_f32_32x32x16_bf16 v[48:63], v[36:39], a[20:23], v[48:63]
    v_mfma_f32_32x32x16_bf16 v[64:79], v[36:39], a[148:151], v[64:79]
    ds_read_b128 v[28:31], v11 offset:8192
    s_waitcnt lgkmcnt(5)
    v_mfma_f32_32x32x16_bf16 v[48:63], v[40:43], a[24:27], v[48:63]
    v_mfma_f32_32x32x16_bf16 v[64:79], v[40:43], a[152:155], v[64:79]
    ds_read_b128 v[32:35], v12 offset:8192
    s_waitcnt lgkmcnt(5)
    v_mfma_f32_32x32x16_bf16 v[48:63], v[44:47], a[28:31], v[48:63]
    v_mfma_f32_32x32x16_bf16 v[64:79], v[44:47], a[156:159], v[64:79]
    ds_read_b128 v[36:39], v13 offset:8192
    s_waitcnt lgkmcnt(5)
    v_mfma_f32_32x32x16_bf16 v[48:63], v[16:19], a[32:35], v[48:63]
    v_mfma_f32_32x32x16_bf16 v[64:79], v[16:19], a[160:163], v[64:79]
    ds_read_b128 v[40:43], v14 offset:8192
    s_waitcnt lgkmcnt(5)
    v_mfma_f32_32x32x16_bf16 v[48:63], v[20:23], a[36:39], v[48:63]
    v_mfma_f32_32x32x16_bf16 v[64:79], v[20:23], a[164:167], v[64:79]
    ds_read_b128 v[44:47], v15 offset:8192
    s_waitcnt lgkmcnt(5)
    v_mfma_f32_32x32x16_bf16 v[48:63], v[24:27], a[40:43], v[48:63]
    v_mfma_f32_32x32x16_bf16 v[64:79], v[24:27], a[168:171], v[64:79]
    ds_read_b128 v[16:19], v8 offset:16384
    s_waitcnt lgkmcnt(5)
    v_mfma_f32_32x32x16_bf16 v[48:63], v[28:31], a[44:47], v[48:63]
    v_mfma_f32_32x32x16_bf16 v[64:79], v[28:31], a[172:175], v[64:79]
    ds_read_b128 v[20:23], v9 offset:16384
    s_waitcnt lgkmcnt(5)
    v_mfma_f32_32x32x16_bf16 v[48:63], v[32:35], a[48:51], v[48:63]
    v_mfma_f32_32x32x16_bf16 v[64:79], v[32:35], a[176:179], v[64:79]
    ds_read_b128 v[24:27], v10 offset:16384
    s_waitcnt lgkmcnt(5)
    v_mfma_f32_32x32x16_bf16 v[48:63], v[36:39], a[52:55], v[48:63]
    v_mfma_f32_32x32x16_bf16 v[64:79], v[36:39], a[180:183], v[64:79]
    ds_read_b128 v[28:31], v11 offset:16384
    s_waitcnt lgkmcnt(5)
    v_mfma_f32_32x32x16_bf16 v[48:63], v[40:43], a[56:59], v[48:63]
    v_mfma_f32_32x32x16_bf16 v[64:79], v[40:43], a[184:187], v[64:79]
    ds_read_b128 v[32:35], v12 offset:16384
    s_waitcnt lgkmcnt(5)
    v_mfma_f32_32x32x16_bf16 v[48:63], v[44:47], a[60:63], v[48:63]
    v_mfma_f32_32x32x16_bf16 v[64:79], v[44:47], a[188:191], v[64:79]
    ds_read_b128 v[36:39], v13 offset:16384
    s_waitcnt lgkmcnt(5)
    v_mfma_f32_32x32x16_bf16 v[48:63], v[16:19], a[64:67], v[48:63]
    v_mfma_f32_32x32x16_bf16 v[64:79], v[16:19], a[192:195], v[64:79]
    ds_read_b128 v[40:43], v14 offset:16384
    s_waitcnt lgkmcnt(5)
    v_mfma_f32_32x32x16_bf16 v[48:63], v[20:23], a[68:71], v[48:63]
    v_mfma_f32_32x32x16_bf16 v[64:79], v[20:23], a[196:199], v[64:79]
    ds_read_b128 v[44:47], v15 offset:16384
    s_waitcnt lgkmcnt(5)
    v_mfma_f32_32x32x16_bf16 v[48:63], v[24:27], a[72:75], v[48:63]
    v_mfma_f32_32x32x16_bf16 v[64:79], v[24:27], a[200:203], v[64:79]
    ds_read_b128 v[16:19], v8 offset:24576
    s_waitcnt lgkmcnt(5)
    v_mfma_f32_32x32x16_bf16 v[48:63], v[28:31], a[76:79], v[48:63]
    v_mfma_f32_32x32x16_bf16 v[64:79], v[28:31], a[204:207], v[64:79]
    ds_read_b128 v[20:23], v9 offset:24576
    s_waitcnt lgkmcnt(5)
    v_mfma_f32_32x32x16_bf16 v[48:63], v[32:35], a[80:83], v[48:63]
    v_mfma_f32_32x32x16_bf16 v[64:79], v[32:35], a[208:211], v[64:79]
    ds_read_b128 v[24:27], v10 offset:24576
    s_waitcnt lgkmcnt(5)
    v_mfma_f32_32x32x16_bf16 v[48:63], v[36:39], a[84:87], v[48:63]
    v_mfma_f32_32x32x16_bf16 v[64:79], v[36:39], a[212:215], v[64:79]
    ds_read_b128 v[28:31], v11 offset:24576
    s_waitcnt lgkmcnt(5)
    v_mfma_f32_32x32x16_bf16 v[48:63], v[40:43], a[88:91], v[48:63]
    v_mfma_f32_32x32x16_bf16 v[64:79], v[40:43], a[216:219], v[64:79]
    ds_read_b128 v[32:35], v12 offset:24576
    s_waitcnt lgkmcnt(5)
    v_mfma_f32_32x32x16_bf16 v[48:63], v[44:47], a[92:95], v[48:63]
    v_mfma_f32_32x32x16_bf16 v[64:79], v[44:47], a[220:223], v[64:79]
    ds_read_b128 v[36:39], v13 offset:24576
    s_waitcnt lgkmcnt(5)
    v_mfma_f32_32x32x16_bf16 v[48:63], v[16:19], a[96:99], v[48:63]
    v_mfma_f32_32x32x16_bf16 v[64:79], v[16:19], a[224:227], v[64:79]
    ds_read_b128 v[40:43], v14 offset:24576
    s_waitcnt lgkmcnt(5)
    v_mfma_f32_32x32x16_bf16 v[48:63], v[20:23], a[100:103], v[48:63]
    v_mfma_f32_32x32x16_bf16 v[64:79], v[20:23], a[228:231], v[64:79]
    ds_read_b128 v[44:47], v15 offset:24576
    s_waitcnt lgkmcnt(5)
    v_mfma_f32_32x32x16_bf16 v[48:63], v[24:27], a[104:107], v[48:63]
    v_mfma_f32_32x32x16_bf16 v[64:79], v[24:27], a[232:235], v[64:79]
    s_waitcnt lgkmcnt(4)
    v_mfma_f32_32x32x16_bf16 v[48:63], v[28:31], a[108:111], v[48:63]
    v_mfma_f32_32x32x16_bf16 v[64:79], v[28:31], a[236:239], v[64:79]
    s_waitcnt lgkmcnt(3)
    v_mfma_f32_32x32x16_bf16 v[48:63], v[32:35], a[112:115], v[48:63]
    v_mfma_f32_32x32x16_bf16 v[64:79], v[32:35], a[240:243], v[64:79]
    s_waitcnt lgkmcnt(2)
    v_mfma_f32_32x32x16_bf16 v[48:63], v[36:39], a[116:119], v[48:63]
    v_mfma_f32_32x32x16_bf16 v[64:79], v[36:39], a[244:247], v[64:79]
    s_waitcnt lgkmcnt(1)
    v_mfma_f32_32x32x16_bf16 v[48:63], v[40:43], a[120:123], v[48:63]
    v_mfma_f32_32x32x16_bf16 v[64:79], v[40:43], a[248:251], v[64:79]
    s_waitcnt lgkmcnt(0)
    v_mfma_f32_32x32x16_bf16 v[48:63], v[44:47], a[124:127], v[48:63]
    v_mfma_f32_32x32x16_bf16 v[64:79], v[44:47], a[252:255], v[64:79]
    s_add_u32 s54, s61, 32768
    s_cmp_ge_u32 s54, 98304
    s_cselect_b32 s54, 0, s54
    s_sub_u32 s55, s54, s61
    s_mov_b32 s61, s54
    v_add_u32 v8, s55, v8
    v_add_u32 v9, s55, v9
    v_add_u32 v10, s55, v10
    v_add_u32 v11, s55, v11
    v_add_u32 v12, s55, v12
    v_add_u32 v13, s55, v13
    v_add_u32 v14, s55, v14
    v_add_u32 v15, s55, v15
    s_add_u32 s62, s62, 32768
    s_cmp_ge_u32 s62, 98304
    s_cselect_b32 s62, 0, s62
    v_cvt_pk_bf16_f32 v80, v48, v49
    v_cvt_pk_bf16_f32 v81, v50, v51
    v_cvt_pk_bf16_f32 v82, v56, v57
    v_cvt_pk_bf16_f32 v83, v58, v59
    global_store_dwordx4 v6, v[80:83], s[48:49] offset:0 sc1
    v_cvt_pk_bf16_f32 v84, v52, v53
    v_cvt_pk_bf16_f32 v85, v54, v55
    v_cvt_pk_bf16_f32 v86, v60, v61
    v_cvt_pk_bf16_f32 v87, v62, v63
    global_store_dwordx4 v6, v[84:87], s[48:49] offset:512 sc1
    v_cvt_pk_bf16_f32 v88, v64, v65
    v_cvt_pk_bf16_f32 v89, v66, v67
    v_cvt_pk_bf16_f32 v90, v72, v73
    v_cvt_pk_bf16_f32 v91, v74, v75
    global_store_dwordx4 v6, v[88:91], s[48:49] offset:2048 sc1
    v_cvt_pk_bf16_f32 v92, v68, v69
    v_cvt_pk_bf16_f32 v93, v70, v71
    v_cvt_pk_bf16_f32 v94, v76, v77
    v_cvt_pk_bf16_f32 v95, v78, v79
    global_store_dwordx4 v6, v[92:95], s[48:49] offset:2560 sc1
    s_nop 0
    s_add_u32 s48, s48, s50
    s_addc_u32 s49, s49, 0
    s_add_u32 s60, s60, 1
    s_add_u32 s65, s65, 4
    s_cmp_lt_u32 s60, 16
    s_cbranch_scc1 Lg1t_98
    s_branch Lg1end_96
Lg1t_99:
    s_waitcnt vmcnt(12)
    s_cmp_eq_u32 s60, 15
    s_cbranch_scc0 Lg1np_107
    s_waitcnt vmcnt(4)
Lg1np_107:
    s_barrier
    s_cmp_lt_u32 s60, 2
    s_cbranch_scc1 Lg1s_108
    s_cmp_lg_u32 s3, 0
    s_cbranch_scc1 Lg1s_108
    s_add_i32 s56, s65, -8
    s_lshl_b32 s56, s56, 7
    s_add_u32 s56, s56, s66
    v_mov_b32 v1, s56
    v_mov_b32 v2, 1
    s_mov_b64 exec, 1
    global_atomic_add v1, v2, s[42:43]
    s_mov_b64 exec, -1
Lg1s_108:
    s_cmp_ge_u32 s60, 14
    s_cbranch_scc1 Lg1np_109
    s_lshl_b32 s54, s3, 13
    s_add_u32 s54, s54, s62
    s_add_u32 m0, s54, 0
    s_nop 0
    global_load_lds_dwordx4 v100, s[52:53]
    s_add_u32 m0, s54, 1024
    s_nop 0
    global_load_lds_dwordx4 v101, s[52:53]
    s_add_u32 m0, s54, 2048
    s_nop 0
    global_load_lds_dwordx4 v102, s[52:53]
    s_add_u32 m0, s54, 3072
    s_nop 0
    global_load_lds_dwordx4 v103, s[52:53]
    s_add_u32 m0, s54, 4096
    s_add_u32 s52, s52, 16384
    s_addc_u32 s53, s53, 0
    global_load_lds_dwordx4 v100, s[52:53]
    s_add_u32 m0, s54, 5120
    s_nop 0
    global_load_lds_dwordx4 v101, s[52:53]
    s_add_u32 m0, s54, 6144
    s_nop 0
    global_load_lds_dwordx4 v102, s[52:53]
    s_add_u32 m0, s54, 7168
    s_nop 0
    global_load_lds_dwordx4 v103, s[52:53]
    s_add_u32 s52, s52, 114688
    s_addc_u32 s53, s53, 0
Lg1np_109:
    ds_read_b128 v[16:19], v8 offset:0
    ds_read_b128 v[20:23], v9 offset:0
    ds_read_b128 v[24:27], v10 offset:0
    ds_read_b128 v[28:31], v11 offset:0
    ds_read_b128 v[32:35], v12 offset:0
    ds_read_b128 v[36:39], v13 offset:0
    s_waitcnt lgkmcnt(5)
    v_mfma_f32_32x32x16_bf16 v[48:63], a[0:3], v[16:19], 0
    v_mfma_f32_32x32x16_bf16 v[64:79], a[128:131], v[16:19], 0
    ds_read_b128 v[40:43], v14 offset:0
    s_waitcnt lgkmcnt(5)
    v_mfma_f32_32x32x16_bf16 v[48:63], a[4:7], v[20:23], v[48:63]
    v_mfma_f32_32x32x16_bf16 v[64:79], a[132:135], v[20:23], v[64:79]
    ds_read_b128 v[44:47], v15 offset:0
    s_waitcnt lgkmcnt(5)
    v_mfma_f32_32x32x16_bf16 v[48:63], a[8:11], v[24:27], v[48:63]
    v_mfma_f32_32x32x16_bf16 v[64:79], a[136:139], v[24:27], v[64:79]
    ds_read_b128 v[16:19], v8 offset:8192
    s_waitcnt lgkmcnt(5)
    v_mfma_f32_32x32x16_bf16 v[48:63], a[12:15], v[28:31], v[48:63]
    v_mfma_f32_32x32x16_bf16 v[64:79], a[140:143], v[28:31], v[64:79]
    ds_read_b128 v[20:23], v9 offset:8192
    s_waitcnt lgkmcnt(5)
    v_mfma_f32_32x32x16_bf16 v[48:63], a[16:19], v[32:35], v[48:63]
    v_mfma_f32_32x32x16_bf16 v[64:79], a[144:147], v[32:35], v[64:79]
    ds_read_b128 v[24:27], v10 offset:8192
    s_waitcnt lgkmcnt(5)
    v_mfma_f32_32x32x16_bf16 v[48:63], a[20:23], v[36:39], v[48:63]
    v_mfma_f32_32x32x16_bf16 v[64:79], a[148:151], v[36:39], v[64:79]
    ds_read_b128 v[28:31], v11 offset:8192
    s_waitcnt lgkmcnt(5)
    v_mfma_f32_32x32x16_bf16 v[48:63], a[24:27], v[40:43], v[48:63]
    v_mfma_f32_32x32x16_bf16 v[64:79], a[152:155], v[40:43], v[64:79]
    ds_read_b128 v[32:35], v12 offset:8192
    s_waitcnt lgkmcnt(5)
    v_mfma_f32_32x32x16_bf16 v[48:63], a[28:31], v[44:47], v[48:63]
    v_mfma_f32_32x32x16_bf16 v[64:79], a[156:159], v[44:47], v[64:79]
    ds_read_b128 v[36:39], v13 offset:8192
    s_waitcnt lgkmcnt(5)
    v_mfma_f32_32x32x16_bf16 v[48:63], a[32:35], v[16:19], v[48:63]
    v_mfma_f32_32x32x16_bf16 v[64:79], a[160:163], v[16:19], v[64:79]
    ds_read_b128 v[40:43], v14 offset:8192
    s_waitcnt lgkmcnt(5)
    v_mfma_f32_32x32x16_bf16 v[48:63], a[36:39], v[20:23], v[48:63]
    v_mfma_f32_32x32x16_bf16 v[64:79], a[164:167], v[20:23], v[64:79]
    ds_read_b128 v[44:47], v15 offset:8192
    s_waitcnt lgkmcnt(5)
    v_mfma_f32_32x32x16_bf16 v[48:63], a[40:43], v[24:27], v[48:63]
    v_mfma_f32_32x32x16_bf16 v[64:79], a[168:171], v[24:27], v[64:79]
    ds_read_b128 v[16:19], v8 offset:16384
    s_waitcnt lgkmcnt(5)
    v_mfma_f32_32x32x16_bf16 v[48:63], a[44:47], v[28:31], v[48:63]
    v_mfma_f32_32x32x16_bf16 v[64:79], a[172:175], v[28:31], v[64:79]
    ds_read_b128 v[20:23], v9 offset:16384
    s_waitcnt lgkmcnt(5)
    v_mfma_f32_32x32x16_bf16 v[48:63], a[48:51], v[32:35], v[48:63]
    v_mfma_f32_32x32x16_bf16 v[64:79], a[176:179], v[32:35], v[64:79]
    ds_read_b128 v[24:27], v10 offset:16384
    s_waitcnt lgkmcnt(5)
    v_mfma_f32_32x32x16_bf16 v[48:63], a[52:55], v[36:39], v[48:63]
    v_mfma_f32_32x32x16_bf16 v[64:79], a[180:183], v[36:39], v[64:79]
    ds_read_b128 v[28:31], v11 offset:16384
    s_waitcnt lgkmcnt(5)
    v_mfma_f32_32x32x16_bf16 v[48:63], a[56:59], v[40:43], v[48:63]
    v_mfma_f32_32x32x16_bf16 v[64:79], a[184:187], v[40:43], v[64:79]
    ds_read_b128 v[32:35], v12 offset:16384
    s_waitcnt lgkmcnt(5)
    v_mfma_f32_32x32x16_bf16 v[48:63], a[60:63], v[44:47], v[48:63]
    v_mfma_f32_32x32x16_bf16 v[64:79], a[188:191], v[44:47], v[64:79]
    ds_read_b128 v[36:39], v13 offset:16384
    s_waitcnt lgkmcnt(5)
    v_mfma_f32_32x32x16_bf16 v[48:63], a[64:67], v[16:19], v[48:63]
    v_mfma_f32_32x32x16_bf16 v[64:79], a[192:195], v[16:19], v[64:79]
    ds_read_b128 v[40:43], v14 offset:16384
    s_waitcnt lgkmcnt(5)
    v_mfma_f32_32x32x16_bf16 v[48:63], a[68:71], v[20:23], v[48:63]
    v_mfma_f32_32x32x16_bf16 v[64:79], a[196:199], v[20:23], v[64:79]
    ds_read_b128 v[44:47], v15 offset:16384
    s_waitcnt lgkmcnt(5)
    v_mfma_f32_32x32x16_bf16 v[48:63], a[72:75], v[24:27], v[48:63]
    v_mfma_f32_32x32x16_bf16 v[64:79], a[200:203], v[24:27], v[64:79]
    ds_read_b128 v[16:19], v8 offset:24576
    s_waitcnt lgkmcnt(5)
    v_mfma_f32_32x32x16_bf16 v[48:63], a[76:79], v[28:31], v[48:63]
    v_mfma_f32_32x32x16_bf16 v[64:79], a[204:207], v[28:31], v[64:79]
    ds_read_b128 v[20:23], v9 offset:24576
    s_waitcnt lgkmcnt(5)
    v_mfma_f32_32x32x16_bf16 v[48:63], a[80:83], v[32:35], v[48:63]
    v_mfma_f32_32x32x16_bf16 v[64:79], a[208:211], v[32:35], v[64:79]
    ds_read_b128 v[24:27], v10 offset:24576
    s_waitcnt lgkmcnt(5)
    v_mfma_f32_32x32x16_bf16 v[48:63], a[84:87], v[36:39], v[48:63]
    v_mfma_f32_32x32x16_bf16 v[64:79], a[212:215], v[36:39], v[64:79]
    ds_read_b128 v[28:31], v11 offset:24576
    s_waitcnt lgkmcnt(5)
    v_mfma_f32_32x32x16_bf16 v[48:63], a[88:91], v[40:43], v[48:63]
    v_mfma_f32_32x32x16_bf16 v[64:79], a[216:219], v[40:43], v[64:79]
    ds_read_b128 v[32:35], v12 offset:24576
    s_waitcnt lgkmcnt(5)
    v_mfma_f32_32x32x16_bf16 v[48:63], a[92:95], v[44:47], v[48:63]
    v_mfma_f32_32x32x16_bf16 v[64:79], a[220:223], v[44:47], v[64:79]
    ds_read_b128 v[36:39], v13 offset:24576
    s_waitcnt lgkmcnt(5)
    v_mfma_f32_32x32x16_bf16 v[48:63], a[96:99], v[16:19], v[48:63]
    v_mfma_f32_32x32x16_bf16 v[64:79], a[224:227], v[16:19], v[64:79]
    ds_read_b128 v[40:43], v14 offset:24576
    s_waitcnt lgkmcnt(5)
    v_mfma_f32_32x32x16_bf16 v[48:63], a[100:103], v[20:23], v[48:63]
    v_mfma_f32_32x32x16_bf16 v[64:79], a[228:231], v[20:23], v[64:79]
    ds_read_b128 v[44:47], v15 offset:24576
    s_waitcnt lgkmcnt(5)
    v_mfma_f32_32x32x16_bf16 v[48:63], a[104:107], v[24:27], v[48:63]
    v_mfma_f32_32x32x16_bf16 v[64:79], a[232:235], v[24:27], v[64:79]
    s_waitcnt lgkmcnt(4)
    v_mfma_f32_32x32x16_bf16 v[48:63], a[108:111], v[28:31], v[48:63]
    v_mfma_f32_32x32x16_bf16 v[64:79], a[236:239], v[28:31], v[64:79]
    s_waitcnt lgkmcnt(3)
    v_mfma_f32_32x32x16_bf16 v[48:63], a[112:115], v[32:35], v[48:63]
    v_mfma_f32_32x32x16_bf16 v[64:79], a[240:243], v[32:35], v[64:79]
    s_waitcnt lgkmcnt(2)
    v_mfma_f32_32x32x16_bf16 v[48:63], a[116:119], v[36:39], v[48:63]
    v_mfma_f32_32x32x16_bf16 v[64:79], a[244:247], v[36:39], v[64:79]
    s_waitcnt lgkmcnt(1)
    v_mfma_f32_32x32x16_bf16 v[48:63], a[120:123], v[40:43], v[48:63]
    v_mfma_f32_32x32x16_bf16 v[64:79], a[248:251], v[40:43], v[64:79]
    s_waitcnt lgkmcnt(0)
    v_mfma_f32_32x32x16_bf16 v[48:63], a[124:127], v[44:47], v[48:63]
    v_mfma_f32_32x32x16_bf16 v[64:79], a[252:255], v[44:47], v[64:79]
    s_add_u32 s54, s61, 32768
    s_cmp_ge_u32 s54, 98304
    s_cselect_b32 s54, 0, s54
    s_sub_u32 s55, s54, s61
    s_mov_b32 s61, s54
    v_add_u32 v8, s55, v8
    v_add_u32 v9, s55, v9
    v_add_u32 v10, s55, v10
    v_add_u32 v11, s55, v11
    v_add_u32 v12, s55, v12
    v_add_u32 v13, s55, v13
    v_add_u32 v14, s55, v14
    v_add_u32 v15, s55, v15
    s_add_u32 s62, s62, 32768
    s_cmp_ge_u32 s62, 98304
    s_cselect_b32 s62, 0, s62
    v_cvt_pk_bf16_f32 v80, v48, v49
    v_cvt_pk_bf16_f32 v81, v50, v51
    v_cvt_pk_bf16_f32 v82, v52, v53
    v_cvt_pk_bf16_f32 v83, v54, v55
    global_store_dwordx4 v6, v[80:83], s[48:49] offset:0 sc1
    v_cvt_pk_bf16_f32 v84, v56, v57
    v_cvt_pk_bf16_f32 v85, v58, v59
    v_cvt_pk_bf16_f32 v86, v60, v61
    v_cvt_pk_bf16_f32 v87, v62, v63
    global_store_dwordx4 v6, v[84:87], s[48:49] offset:1024 sc1
    v_cvt_pk_bf16_f32 v88, v64, v65
    v_cvt_pk_bf16_f32 v89, v66, v67
    v_cvt_pk_bf16_f32 v90, v68, v69
    v_cvt_pk_bf16_f32 v91, v70, v71
    global_store_dwordx4 v6, v[88:91], s[48:49] offset:2048 sc1
    v_cvt_pk_bf16_f32 v92, v72, v73
    v_cvt_pk_bf16_f32 v93, v74, v75
    v_cvt_pk_bf16_f32 v94, v76, v77
    v_cvt_pk_bf16_f32 v95, v78, v79
    global_store_dwordx4 v6, v[92:95], s[48:49] offset:3072 sc1
    s_nop 0
    s_add_u32 s48, s48, s50
    s_addc_u32 s49, s49, 0
    s_add_u32 s60, s60, 1
    s_add_u32 s65, s65, 4
    s_cmp_lt_u32 s60, 16
    s_cbranch_scc1 Lg1t_99
    s_branch Lg1end_96
Lg1t_100:
    s_waitcnt vmcnt(12)
    s_cmp_eq_u32 s60, 15
    s_cbranch_scc0 Lg1np_110
    s_waitcnt vmcnt(4)
Lg1np_110:
    s_barrier
    s_cmp_lt_u32 s60, 2
    s_cbranch_scc1 Lg1s_111
    s_cmp_lg_u32 s3, 0
    s_cbranch_scc1 Lg1s_111
    s_add_i32 s56, s65, -8
    s_lshl_b32 s56, s56, 7
    s_add_u32 s56, s56, s66
    v_mov_b32 v1, s56
    v_mov_b32 v2, 1
    s_mov_b64 exec, 1
    global_atomic_add v1, v2, s[42:43]
    s_mov_b64 exec, -1
Lg1s_111:
    s_cmp_ge_u32 s60, 14
    s_cbranch_scc1 Lg1np_112
    s_lshl_b32 s54, s3, 13
    s_add_u32 s54, s54, s62
    s_add_u32 m0, s54, 0
    s_nop 0
    global_load_lds_dwordx4 v100, s[52:53]
    s_add_u32 m0, s54, 1024
    s_nop 0
    global_load_lds_dwordx4 v101, s[52:53]
    s_add_u32 m0, s54, 2048
    s_nop 0
    global_load_lds_dwordx4 v102, s[52:53]
    s_add_u32 m0, s54, 3072
    s_nop 0
    global_load_lds_dwordx4 v103, s[52:53]
    s_add_u32 m0, s54, 4096
    s_add_u32 s52, s52, 16384
    s_addc_u32 s53, s53, 0
    global_load_lds_dwordx4 v100, s[52:53]
    s_add_u32 m0, s54, 5120
    s_nop 0
    global_load_lds_dwordx4 v101, s[52:53]
    s_add_u32 m0, s54, 6144
    s_nop 0
    global_load_lds_dwordx4 v102, s[52:53]
    s_add_u32 m0, s54, 7168
    s_nop 0
    global_load_lds_dwordx4 v103, s[52:53]
    s_add_u32 s52, s52, 114688
    s_addc_u32 s53, s53, 0
Lg1np_112:
    ds_read_b128 v[16:19], v8 offset:0
    ds_read_b128 v[20:23], v9 offset:0
    ds_read_b128 v[24:27], v10 offset:0
    ds_read_b128 v[28:31], v11 offset:0
    ds_read_b128 v[32:35], v12 offset:0
    ds_read_b128 v[36:39], v13 offset:0
    s_waitcnt lgkmcnt(5)
    v_mfma_f32_32x32x16_bf16 v[48:63], v[16:19], a[0:3], 0
    v_mfma_f32_32x32x16_bf16 v[64:79], v[16:19], a[128:131], 0
    ds_read_b128 v[40:43], v14 offset:0
    s_waitcnt lgkmcnt(5)
    v_mfma_f32_32x32x16_bf16 v[48:63], v[20:23], a[4:7], v[48:63]
    v_mfma_f32_32x32x16_bf16 v[64:79], v[20:23], a[132:135], v[64:79]
    ds_read_b128 v[44:47], v15 offset:0
    s_waitcnt lgkmcnt(5)
    v_mfma_f32_32x32x16_bf16 v[48:63], v[24:27], a[8:11], v[48:63]
    v_mfma_f32_32x32x16_bf16 v[64:79], v[24:27], a[136:139], v[64:79]
    ds_read_b128 v[16:19], v8 offset:8192
    s_waitcnt lgkmcnt(5)
    v_mfma_f32_32x32x16_bf16 v[48:63], v[28:31], a[12:15], v[48:63]
    v_mfma_f32_32x32x16_bf16 v[64:79], v[28:31], a[140:143], v[64:79]
    ds_read_b128 v[20:23], v9 offset:8192
    s_waitcnt lgkmcnt(5)
    v_mfma_f32_32x32x16_bf16 v[48:63], v[32:35], a[16:19], v[48:63]
    v_mfma_f32_32x32x16_bf16 v[64:79], v[32:35], a[144:147], v[64:79]
    ds_read_b128 v[24:27], v10 offset:8192
    s_waitcnt lgkmcnt(5)
    v_mfma_f32_32x32x16_bf16 v[48:63], v[36:39], a[20:23], v[48:63]
    v_mfma_f32_32x32x16_bf16 v[64:79], v[36:39], a[148:151], v[64:79]
    ds_read_b128 v[28:31], v11 offset:8192
    s_waitcnt lgkmcnt(5)
    v_mfma_f32_32x32x16_bf16 v[48:63], v[40:43], a[24:27], v[48:63]
    v_mfma_f32_32x32x16_bf16 v[64:79], v[40:43], a[152:155], v[64:79]
    ds_read_b128 v[32:35], v12 offset:8192
    s_waitcnt lgkmcnt(5)
    v_mfma_f32_32x32x16_bf16 v[48:63], v[44:47], a[28:31], v[48:63]
    v_mfma_f32_32x32x16_bf16 v[64:79], v[44:47], a[156:159], v[64:79]
    ds_read_b128 v[36:39], v13 offset:8192
    s_waitcnt lgkmcnt(5)
    v_mfma_f32_32x32x16_bf16 v[48:63], v[16:19], a[32:35], v[48:63]
    v_mfma_f32_32x32x16_bf16 v[64:79], v[16:19], a[160:163], v[64:79]
    ds_read_b128 v[40:43], v14 offset:8192
    s_waitcnt lgkmcnt(5)
    v_mfma_f32_32x32x16_bf16 v[48:63], v[20:23], a[36:39], v[48:63]
    v_mfma_f32_32x32x16_bf16 v[64:79], v[20:23], a[164:167], v[64:79]
    ds_read_b128 v[44:47], v15 offset:8192
    s_waitcnt lgkmcnt(5)
    v_mfma_f32_32x32x16_bf16 v[48:63], v[24:27], a[40:43], v[48:63]
    v_mfma_f32_32x32x16_bf16 v[64:79], v[24:27], a[168:171], v[64:79]
    ds_read_b128 v[16:19], v8 offset:16384
    s_waitcnt lgkmcnt(5)
    v_mfma_f32_32x32x16_bf16 v[48:63], v[28:31], a[44:47], v[48:63]
    v_mfma_f32_32x32x16_bf16 v[64:79], v[28:31], a[172:175], v[64:79]
    ds_read_b128 v[20:23], v9 offset:16384
    s_waitcnt lgkmcnt(5)
    v_mfma_f32_32x32x16_bf16 v[48:63], v[32:35], a[48:51], v[48:63]
    v_mfma_f32_32x32x16_bf16 v[64:79], v[32:35], a[176:179], v[64:79]
    ds_read_b128 v[24:27], v10 offset:16384
    s_waitcnt lgkmcnt(5)
    v_mfma_f32_32x32x16_bf16 v[48:63], v[36:39], a[52:55], v[48:63]
    v_mfma_f32_32x32x16_bf16 v[64:79], v[36:39], a[180:183], v[64:79]
    ds_read_b128 v[28:31], v11 offset:16384
    s_waitcnt lgkmcnt(5)
    v_mfma_f32_32x32x16_bf16 v[48:63], v[40:43], a[56:59], v[48:63]
    v_mfma_f32_32x32x16_bf16 v[64:79], v[40:43], a[184:187], v[64:79]
    ds_read_b128 v[32:35], v12 offset:16384
    s_waitcnt lgkmcnt(5)
    v_mfma_f32_32x32x16_bf16 v[48:63], v[44:47], a[60:63], v[48:63]
    v_mfma_f32_32x32x16_bf16 v[64:79], v[44:47], a[188:191], v[64:79]
    ds_read_b128 v[36:39], v13 offset:16384
    s_waitcnt lgkmcnt(5)
    v_mfma_f32_32x32x16_bf16 v[48:63], v[16:19], a[64:67], v[48:63]
    v_mfma_f32_32x32x16_bf16 v[64:79], v[16:19], a[192:195], v[64:79]
    ds_read_b128 v[40:43], v14 offset:16384
    s_waitcnt lgkmcnt(5)
    v_mfma_f32_32x32x16_bf16 v[48:63], v[20:23], a[68:71], v[48:63]
    v_mfma_f32_32x32x16_bf16 v[64:79], v[20:23], a[196:199], v[64:79]
    ds_read_b128 v[44:47], v15 offset:16384
    s_waitcnt lgkmcnt(5)
    v_mfma_f32_32x32x16_bf16 v[48:63], v[24:27], a[72:75], v[48:63]
    v_mfma_f32_32x32x16_bf16 v[64:79], v[24:27], a[200:203], v[64:79]
    ds_read_b128 v[16:19], v8 offset:24576
    s_waitcnt lgkmcnt(5)
    v_mfma_f32_32x32x16_bf16 v[48:63], v[28:31], a[76:79], v[48:63]
    v_mfma_f32_32x32x16_bf16 v[64:79], v[28:31], a[204:207], v[64:79]
    ds_read_b128 v[20:23], v9 offset:24576
    s_waitcnt lgkmcnt(5)
    v_mfma_f32_32x32x16_bf16 v[48:63], v[32:35], a[80:83], v[48:63]
    v_mfma_f32_32x32x16_bf16 v[64:79], v[32:35], a[208:211], v[64:79]
    ds_read_b128 v[24:27], v10 offset:24576
    s_waitcnt lgkmcnt(5)
    v_mfma_f32_32x32x16_bf16 v[48:63], v[36:39], a[84:87], v[48:63]
    v_mfma_f32_32x32x16_bf16 v[64:79], v[36:39], a[212:215], v[64:79]
    ds_read_b128 v[28:31], v11 offset:24576
    s_waitcnt lgkmcnt(5)
    v_mfma_f32_32x32x16_bf16 v[48:63], v[40:43], a[88:91], v[48:63]
    v_mfma_f32_32x32x16_bf16 v[64:79], v[40:43], a[216:219], v[64:79]
    ds_read_b128 v[32:35], v12 offset:24576
    s_waitcnt lgkmcnt(5)
    v_mfma_f32_32x32x16_bf16 v[48:63], v[44:47], a[92:95], v[48:63]
    v_mfma_f32_32x32x16_bf16 v[64:79], v[44:47], a[220:223], v[64:79]
    ds_read_b128 v[36:39], v13 offset:24576
    s_waitcnt lgkmcnt(5)
    v_mfma_f32_32x32x16_bf16 v[48:63], v[16:19], a[96:99], v[48:63]
    v_mfma_f32_32x32x16_bf16 v[64:79], v[16:19], a[224:227], v[64:79]
    ds_read_b128 v[40:43], v14 offset:24576
    s_waitcnt lgkmcnt(5)
    v_mfma_f32_32x32x16_bf16 v[48:63], v[20:23], a[100:103], v[48:63]
    v_mfma_f32_32x32x16_bf16 v[64:79], v[20:23], a[228:231], v[64:79]
    ds_read_b128 v[44:47], v15 offset:24576
    s_waitcnt lgkmcnt(5)
    v_mfma_f32_32x32x16_bf16 v[48:63], v[24:27], a[104:107], v[48:63]
    v_mfma_f32_32x32x16_bf16 v[64:79], v[24:27], a[232:235], v[64:79]
    s_waitcnt lgkmcnt(4)
    v_mfma_f32_32x32x16_bf16 v[48:63], v[28:31], a[108:111], v[48:63]
    v_mfma_f32_32x32x16_bf16 v[64:79], v[28:31], a[236:239], v[64:79]
    s_waitcnt lgkmcnt(3)
    v_mfma_f32_32x32x16_bf16 v[48:63], v[32:35], a[112:115], v[48:63]
    v_mfma_f32_32x32x16_bf16 v[64:79], v[32:35], a[240:243], v[64:79]
    s_waitcnt lgkmcnt(2)
    v_mfma_f32_32x32x16_bf16 v[48:63], v[36:39], a[116:119], v[48:63]
    v_mfma_f32_32x32x16_bf16 v[64:79], v[36:39], a[244:247], v[64:79]
    s_waitcnt lgkmcnt(1)
    v_mfma_f32_32x32x16_bf16 v[48:63], v[40:43], a[120:123], v[48:63]
    v_mfma_f32_32x32x16_bf16 v[64:79], v[40:43], a[248:251], v[64:79]
    s_waitcnt lgkmcnt(0)
    v_mfma_f32_32x32x16_bf16 v[48:63], v[44:47], a[124:127], v[48:63]
    v_mfma_f32_32x32x16_bf16 v[64:79], v[44:47], a[252:255], v[64:79]
    s_add_u32 s54, s61, 32768
    s_cmp_ge_u32 s54, 98304
    s_cselect_b32 s54, 0, s54
    s_sub_u32 s55, s54, s61
    s_mov_b32 s61, s54
    v_add_u32 v8, s55, v8
    v_add_u32 v9, s55, v9
    v_add_u32 v10, s55, v10
    v_add_u32 v11, s55, v11
    v_add_u32 v12, s55, v12
    v_add_u32 v13, s55, v13
    v_add_u32 v14, s55, v14
    v_add_u32 v15, s55, v15
    s_add_u32 s62, s62, 32768
    s_cmp_ge_u32 s62, 98304
    s_cselect_b32 s62, 0, s62
    v_cvt_pk_bf16_f32 v80, v48, v49
    v_cvt_pk_bf16_f32 v81, v50, v51
    v_cvt_pk_bf16_f32 v82, v52, v53
    v_cvt_pk_bf16_f32 v83, v54, v55
    global_store_dwordx4 v6, v[80:83], s[48:49] offset:0 sc1
    v_cvt_pk_bf16_f32 v84, v56, v57
    v_cvt_pk_bf16_f32 v85, v58, v59
    v_cvt_pk_bf16_f32 v86, v60, v61
    v_cvt_pk_bf16_f32 v87, v62, v63
    global_store_dwordx4 v6, v[84:87], s[48:49] offset:1024 sc1
    v_cvt_pk_bf16_f32 v88, v64, v65
    v_cvt_pk_bf16_f32 v89, v66, v67
    v_cvt_pk_bf16_f32 v90, v68, v69
    v_cvt_pk_bf16_f32 v91, v70, v71
    global_store_dwordx4 v6, v[88:91], s[48:49] offset:2048 sc1
    v_cvt_pk_bf16_f32 v92, v72, v73
    v_cvt_pk_bf16_f32 v93, v74, v75
    v_cvt_pk_bf16_f32 v94, v76, v77
    v_cvt_pk_bf16_f32 v95, v78, v79
    global_store_dwordx4 v6, v[92:95], s[48:49] offset:3072 sc1
    s_nop 0
    s_add_u32 s48, s48, s50
    s_addc_u32 s49, s49, 0
    s_add_u32 s60, s60, 1
    s_add_u32 s65, s65, 4
    s_cmp_lt_u32 s60, 16
    s_cbranch_scc1 Lg1t_100
    s_branch Lg1end_96
Lg1end_96:
    s_waitcnt vmcnt(0)
    s_barrier
    s_cmp_lg_u32 s3, 0
    s_cbranch_scc1 Lg1s_113
    s_add_i32 s56, s65, -8
    s_lshl_b32 s56, s56, 7
    s_add_u32 s56, s56, s66
    v_mov_b32 v1, s56
    v_mov_b32 v2, 1
    s_mov_b64 exec, 1
    global_atomic_add v1, v2, s[42:43]
    s_mov_b64 exec, -1
    s_add_i32 s56, s65, -4
    s_lshl_b32 s56, s56, 7
    s_add_u32 s56, s56, s66
    v_mov_b32 v1, s56
    v_mov_b32 v2, 1
    s_mov_b64 exec, 1
    global_atomic_add v1, v2, s[42:43]
    s_mov_b64 exec, -1
Lg1s_113:
L_phase2:
    s_mov_b32 s10, 0
    s_cmp_lt_u32 s8, 16
    s_cbranch_scc1 L_stage2
    s_lshl_b32 s9, s12, 4
    s_add_u32 s9, s9, s8
    s_sub_u32 s9, s9, 16
    s_lshl_b32 s9, s9, 2
    s_add_u32 s9, s9, s3
    v_lshlrev_b32 v1, 4, v0
    v_and_b32 v2, 31, v0
    v_lshrrev_b32 v3, 5, v0
    v_lshlrev_b32 v3, 2, v3
    v_sub_u32 v2, v2, v3
    v_cmp_gt_i32 s[44:45], 0, v2
    v_cmp_gt_i32 s[46:47], 1, v2
    v_cmp_gt_i32 s[48:49], 2, v2
    v_cmp_gt_i32 s[50:51], 3, v2
    v_cmp_gt_i32 s[52:53], 8, v2
    v_cmp_gt_i32 s[54:55], 9, v2
    v_cmp_gt_i32 s[56:57], 10, v2
    v_cmp_gt_i32 s[58:59], 11, v2
    v_cmp_gt_i32 s[60:61], 16, v2
    v_cmp_gt_i32 s[62:63], 17, v2
    v_cmp_gt_i32 s[64:65], 18, v2
    v_cmp_gt_i32 s[66:67], 19, v2
    v_cmp_gt_i32 s[68:69], 24, v2
    v_cmp_gt_i32 s[70:71], 25, v2
    v_cmp_gt_i32 s[72:73], 26, v2
    v_cmp_gt_i32 s[74:75], 27, v2
    s_mov_b32 s84, 0x3eb8aa3b
    v_bfe_u32 v2, v0, 4, 1
    v_lshlrev_b32 v2, 14, v2
    v_lshrrev_b32 v3, 5, v0
    v_lshl_add_u32 v2, v3, 8, v2
    v_and_b32 v3, 15, v0
    v_lshl_add_u32 v2, v3, 4, v2
    v_mov_b32 v3, 0xf149f2ca
    v_mov_b32 v4, 0x3f803f80
    v_mov_b32 v5, 0x3f803f80
    v_mov_b32 v6, 0x3f803f80
    v_mov_b32 v7, 0x3f803f80
L_aa_loop:
    s_and_b32 s6, s9, 15
    s_lshr_b32 s7, s9, 4
    v_add_u32 v8, s7, v0
    v_subrev_u32 v8, 8, v8
    v_max_i32 v8, 0, v8
    v_lshlrev_b32 v8, 7, v8
    v_add_u32 v8, 84492288, v8
    s_mov_b64 exec, 0x1ff
Lwa_114:
    global_load_dword v9, v8, s[42:43] sc1
    s_add_u32 s10, s10, 1
    s_cmp_gt_u32 s10, 0x80000
    s_cbranch_scc1 Lwa_115
    s_waitcnt vmcnt(0)
    v_cmp_ne_u32 vcc, 6, v9
    s_cbranch_vccz Lwa_115
    s_sleep 8
    s_branch Lwa_114
Lwa_115:
    s_mov_b64 exec, -1
    s_sub_i32 s76, s7, 8
    s_max_i32 s76, s76, 0
    s_lshl_b32 s76, s76, 15
    s_lshl_b32 s77, s6, 11
    s_add_u32 s76, s76, s77
    s_add_u32 s90, s42, s76
    s_addc_u32 s91, s43, 0
    s_add_u32 s90, s90, 79691776
    s_addc_u32 s91, s91, 0
    s_add_u32 s88, s42, s76
    s_addc_u32 s89, s43, 0
    s_add_u32 s88, s88, 77594624
    s_addc_u32 s89, s89, 0
    global_load_dwordx4 a[0:3], v1, s[90:91] offset:0 sc1
    global_load_dwordx4 a[4:7], v1, s[90:91] offset:1024 sc1
    global_load_dwordx4 a[72:75], v1, s[88:89] offset:0 sc1
    global_load_dwordx4 a[108:111], v1, s[88:89] offset:1024 sc1
    s_sub_i32 s76, s7, 7
    s_max_i32 s76, s76, 0
    s_lshl_b32 s76, s76, 15
    s_lshl_b32 s77, s6, 11
    s_add_u32 s76, s76, s77
    s_add_u32 s90, s42, s76
    s_addc_u32 s91, s43, 0
    s_add_u32 s90, s90, 79691776
    s_addc_u32 s91, s91, 0
    s_add_u32 s88, s42, s76
    s_addc_u32 s89, s43, 0
    s_add_u32 s88, s88, 77594624
    s_addc_u32 s89, s89, 0
    global_load_dwordx4 a[8:11], v1, s[90:91] offset:0 sc1
    global_load_dwordx4 a[12:15], v1, s[90:91] offset:1024 sc1
    global_load_dwordx4 a[76:79], v1, s[88:89] offset:0 sc1
    global_load_dwordx4 a[112:115], v1, s[88:89] offset:1024 sc1
    s_sub_i32 s76, s7, 6
    s_max_i32 s76, s76, 0
    s_lshl_b32 s76, s76, 15
    s_lshl_b32 s77, s6, 11
    s_add_u32 s76, s76, s77
    s_add_u32 s90, s42, s76
    s_addc_u32 s91, s43, 0
    s_add_u32 s90, s90, 79691776
    s_addc_u32 s91, s91, 0
    s_add_u32 s88, s42, s76
    s_addc_u32 s89, s43, 0
    s_add_u32 s88, s88, 77594624
    s_addc_u32 s89, s89, 0
    global_load_dwordx4 a[16:19], v1, s[90:91] offset:0 sc1
    global_load_dwordx4 a[20:23], v1, s[90:91] offset:1024 sc1
    global_load_dwordx4 a[80:83], v1, s[88:89] offset:0 sc1
    global_load_dwordx4 a[116:119], v1, s[88:89] offset:1024 sc1
    s_sub_i32 s76, s7, 5
    s_max_i32 s76, s76, 0
    s_lshl_b32 s76, s76, 15
    s_lshl_b32 s77, s6, 11
    s_add_u32 s76, s76, s77
    s_add_u32 s90, s42, s76
    s_addc_u32 s91, s43, 0
    s_add_u32 s90, s90, 79691776
    s_addc_u32 s91, s91, 0
    s_add_u32 s88, s42, s76
    s_addc_u32 s89, s43, 0
    s_add_u32 s88, s88, 77594624
    s_addc_u32 s89, s89, 0
    global_load_dwordx4 a[24:27], v1, s[90:91] offset:0 sc1
    global_load_dwordx4 a[28:31], v1, s[90:91] offset:1024 sc1
    global_load_dwordx4 a[84:87], v1, s[88:89] offset:0 sc1
    global_load_dwordx4 a[120:123], v1, s[88:89] offset:1024 sc1
    s_sub_i32 s76, s7, 4
    s_max_i32 s76, s76, 0
    s_lshl_b32 s76, s76, 15
    s_lshl_b32 s77, s6, 11
    s_add_u32 s76, s76, s77
    s_add_u32 s90, s42, s76
    s_addc_u32 s91, s43, 0
    s_add_u32 s90, s90, 79691776
    s_addc_u32 s91, s91, 0
    s_add_u32 s88, s42, s76
    s_addc_u32 s89, s43, 0
    s_add_u32 s88, s88, 77594624
    s_addc_u32 s89, s89, 0
    global_load_dwordx4 a[32:35], v1, s[90:91] offset:0 sc1
    global_load_dwordx4 a[36:39], v1, s[90:91] offset:1024 sc1
    global_load_dwordx4 a[88:91], v1, s[88:89] offset:0 sc1
    global_load_dwordx4 a[124:127], v1, s[88:89] offset:1024 sc1
    s_sub_i32 s76, s7, 3
    s_max_i32 s76, s76, 0
    s_lshl_b32 s76, s76, 15
    s_lshl_b32 s77, s6, 11
    s_add_u32 s76, s76, s77
    s_add_u32 s90, s42, s76
    s_addc_u32 s91, s43, 0
    s_add_u32 s90, s90, 79691776
    s_addc_u32 s91, s91, 0
    s_add_u32 s88, s42, s76
    s_addc_u32 s89, s43, 0
    s_add_u32 s88, s88, 77594624
    s_addc_u32 s89, s89, 0
    global_load_dwordx4 a[40:43], v1, s[90:91] offset:0 sc1
    global_load_dwordx4 a[44:47], v1, s[90:91] offset:1024 sc1
    global_load_dwordx4 a[92:95], v1, s[88:89] offset:0 sc1
    global_load_dwordx4 a[128:131], v1, s[88:89] offset:1024 sc1
    s_sub_i32 s76, s7, 2
    s_max_i32 s76, s76, 0
    s_lshl_b32 s76, s76, 15
    s_lshl_b32 s77, s6, 11
    s_add_u32 s76, s76, s77
    s_add_u32 s90, s42, s76
    s_addc_u32 s91, s43, 0
    s_add_u32 s90, s90, 79691776
    s_addc_u32 s91, s91, 0
    s_add_u32 s88, s42, s76
    s_addc_u32 s89, s43, 0
    s_add_u32 s88, s88, 77594624
    s_addc_u32 s89, s89, 0
    global_load_dwordx4 a[48:51], v1, s[90:91] offset:0 sc1
    global_load_dwordx4 a[52:55], v1, s[90:91] offset:1024 sc1
    global_load_dwordx4 a[96:99], v1, s[88:89] offset:0 sc1
    global_load_dwordx4 a[132:135], v1, s[88:89] offset:1024 sc1
    s_sub_i32 s76, s7, 1
    s_max_i32 s76, s76, 0
    s_lshl_b32 s76, s76, 15
    s_lshl_b32 s77, s6, 11
    s_add_u32 s76, s76, s77
    s_add_u32 s90, s42, s76
    s_addc_u32 s91, s43, 0
    s_add_u32 s90, s90, 79691776
    s_addc_u32 s91, s91, 0
    s_add_u32 s88, s42, s76
    s_addc_u32 s89, s43, 0
    s_add_u32 s88, s88, 77594624
    s_addc_u32 s89, s89, 0
    global_load_dwordx4 a[56:59], v1, s[90:91] offset:0 sc1
    global_load_dwordx4 a[60:63], v1, s[90:91] offset:1024 sc1
    global_load_dwordx4 a[100:103], v1, s[88:89] offset:0 sc1
    global_load_dwordx4 a[136:139], v1, s[88:89] offset:1024 sc1
    s_sub_i32 s76, s7, 0
    s_max_i32 s76, s76, 0
    s_lshl_b32 s76, s76, 15
    s_lshl_b32 s77, s6, 11
    s_add_u32 s76, s76, s77
    s_add_u32 s90, s42, s76
    s_addc_u32 s91, s43, 0
    s_add_u32 s90, s90, 79691776
    s_addc_u32 s91, s91, 0
    s_add_u32 s88, s42, s76
    s_addc_u32 s89, s43, 0
    s_add_u32 s88, s88, 77594624
    s_addc_u32 s89, s89, 0
    global_load_dwordx4 a[64:67], v1, s[90:91] offset:0 sc1
    global_load_dwordx4 a[68:71], v1, s[90:91] offset:1024 sc1
    global_load_dwordx4 a[104:107], v1, s[88:89] offset:0 sc1
    global_load_dwordx4 a[140:143], v1, s[88:89] offset:1024 sc1
    s_add_u32 s86, s42, s76
    s_addc_u32 s87, s43, 0
    s_add_u32 s86, s86, 75497472
    s_addc_u32 s87, s87, 0
    global_load_dwordx4 v[8:11], v1, s[86:87] offset:0 sc1
    global_load_dwordx4 v[12:15], v1, s[86:87] offset:1024 sc1
    s_lshl_b32 s76, s7, 15
    s_lshl_b32 s77, s6, 10
    s_add_u32 s76, s76, s77
    s_add_u32 s92, s42, s76
    s_addc_u32 s93, s43, 0
    s_add_u32 s92, s92, 81788928
    s_addc_u32 s93, s93, 0
    s_waitcnt vmcnt(0)
    s_cmp_lt_u32 s7, 8
    s_cbranch_scc1 Laa_116
    v_mfma_f32_32x32x16_bf16 v[64:79], a[72:75], v[8:11], 0
    s_branch Laa_117
Laa_116:
    s_nop 10
    v_mov_b32 v64, v3
    v_mov_b32 v65, v3
    v_mov_b32 v66, v3
    v_mov_b32 v67, v3
    v_mov_b32 v68, v3
    v_mov_b32 v69, v3
    v_mov_b32 v70, v3
    v_mov_b32 v71, v3
    v_mov_b32 v72, v3
    v_mov_b32 v73, v3
    v_mov_b32 v74, v3
    v_mov_b32 v75, v3
    v_mov_b32 v76, v3
    v_mov_b32 v77, v3
    v_mov_b32 v78, v3
    v_mov_b32 v79, v3
Laa_117:
    s_cmp_lt_u32 s7, 7
    s_cbranch_scc1 Laa_118
    v_mfma_f32_32x32x16_bf16 v[80:95], a[76:79], v[8:11], 0
    s_branch Laa_119
Laa_118:
    s_nop 10
    v_mov_b32 v80, v3
    v_mov_b32 v81, v3
    v_mov_b32 v82, v3
    v_mov_b32 v83, v3
    v_mov_b32 v84, v3
    v_mov_b32 v85, v3
    v_mov_b32 v86, v3
    v_mov_b32 v87, v3
    v_mov_b32 v88, v3
    v_mov_b32 v89, v3
    v_mov_b32 v90, v3
    v_mov_b32 v91, v3
    v_mov_b32 v92, v3
    v_mov_b32 v93, v3
    v_mov_b32 v94, v3
    v_mov_b32 v95, v3
Laa_119:
    s_cmp_lt_u32 s7, 6
    s_cbranch_scc1 Laa_120
    v_mfma_f32_32x32x16_bf16 v[96:111], a[80:83], v[8:11], 0
    s_branch Laa_121
Laa_120:
    s_nop 10
    v_mov_b32 v96, v3
    v_mov_b32 v97, v3
    v_mov_b32 v98, v3
    v_mov_b32 v99, v3
    v_mov_b32 v100, v3
    v_mov_b32 v101, v3
    v_mov_b32 v102, v3
    v_mov_b32 v103, v3
    v_mov_b32 v104, v3
    v_mov_b32 v105, v3
    v_mov_b32 v106, v3
    v_mov_b32 v107, v3
    v_mov_b32 v108, v3
    v_mov_b32 v109, v3
    v_mov_b32 v110, v3
    v_mov_b32 v111, v3
Laa_121:
    s_cmp_lt_u32 s7, 5
    s_cbranch_scc1 Laa_122
    v_mfma_f32_32x32x16_bf16 v[112:127], a[84:87], v[8:11], 0
    s_branch Laa_123
Laa_122:
    s_nop 10
    v_mov_b32 v112, v3
    v_mov_b32 v113, v3
    v_mov_b32 v114, v3
    v_mov_b32 v115, v3
    v_mov_b32 v116, v3
    v_mov_b32 v117, v3
    v_mov_b32 v118, v3
    v_mov_b32 v119, v3
    v_mov_b32 v120, v3
    v_mov_b32 v121, v3
    v_mov_b32 v122, v3
    v_mov_b32 v123, v3
    v_mov_b32 v124, v3
    v_mov_b32 v125, v3
    v_mov_b32 v126, v3
    v_mov_b32 v127, v3
Laa_123:
    s_cmp_lt_u32 s7, 4
    s_cbranch_scc1 Laa_124
    v_mfma_f32_32x32x16_bf16 v[128:143], a[88:91], v[8:11], 0
    s_branch Laa_125
Laa_124:
    s_nop 10
    v_mov_b32 v128, v3
    v_mov_b32 v129, v3
    v_mov_b32 v130, v3
    v_mov_b32 v131, v3
    v_mov_b32 v132, v3
    v_mov_b32 v133, v3
    v_mov_b32 v134, v3
    v_mov_b32 v135, v3
    v_mov_b32 v136, v3
    v_mov_b32 v137, v3
    v_mov_b32 v138, v3
    v_mov_b32 v139, v3
    v_mov_b32 v140, v3
    v_mov_b32 v141, v3
    v_mov_b32 v142, v3
    v_mov_b32 v143, v3
Laa_125:
    s_cmp_lt_u32 s7, 3
    s_cbranch_scc1 Laa_126
    v_mfma_f32_32x32x16_bf16 v[144:159], a[92:95], v[8:11], 0
    s_branch Laa_127
Laa_126:
    s_nop 10
    v_mov_b32 v144, v3
    v_mov_b32 v145, v3
    v_mov_b32 v146, v3
    v_mov_b32 v147, v3
    v_mov_b32 v148, v3
    v_mov_b32 v149, v3
    v_mov_b32 v150, v3
    v_mov_b32 v151, v3
    v_mov_b32 v152, v3
    v_mov_b32 v153, v3
    v_mov_b32 v154, v3
    v_mov_b32 v155, v3
    v_mov_b32 v156, v3
    v_mov_b32 v157, v3
    v_mov_b32 v158, v3
    v_mov_b32 v159, v3
Laa_127:
    s_cmp_lt_u32 s7, 2
    s_cbranch_scc1 Laa_128
    v_mfma_f32_32x32x16_bf16 v[160:175], a[96:99], v[8:11], 0
    s_branch Laa_129
Laa_128:
    s_nop 10
    v_mov_b32 v160, v3
    v_mov_b32 v161, v3
    v_mov_b32 v162, v3
    v_mov_b32 v163, v3
    v_mov_b32 v164, v3
    v_mov_b32 v165, v3
    v_mov_b32 v166, v3
    v_mov_b32 v167, v3
    v_mov_b32 v168, v3
    v_mov_b32 v169, v3
    v_mov_b32 v170, v3
    v_mov_b32 v171, v3
    v_mov_b32 v172, v3
    v_mov_b32 v173, v3
    v_mov_b32 v174, v3
    v_mov_b32 v175, v3
Laa_129:
    s_cmp_lt_u32 s7, 1
    s_cbranch_scc1 Laa_130
    v_mfma_f32_32x32x16_bf16 v[176:191], a[100:103], v[8:11], 0
    s_branch Laa_131
Laa_130:
    s_nop 10
    v_mov_b32 v176, v3
    v_mov_b32 v177, v3
    v_mov_b32 v178, v3
    v_mov_b32 v179, v3
    v_mov_b32 v180, v3
    v_mov_b32 v181, v3
    v_mov_b32 v182, v3
    v_mov_b32 v183, v3
    v_mov_b32 v184, v3
    v_mov_b32 v185, v3
    v_mov_b32 v186, v3
    v_mov_b32 v187, v3
    v_mov_b32 v188, v3
    v_mov_b32 v189, v3
    v_mov_b32 v190, v3
    v_mov_b32 v191, v3
Laa_131:
    v_mfma_f32_32x32x16_bf16 v[192:207], a[104:107], v[8:11], 0
    s_nop 15
    v_cndmask_b32 v64, v3, v64, s[44:45]
    v_cndmask_b32 v192, v192, v3, s[44:45]
    v_cndmask_b32 v65, v3, v65, s[46:47]
    v_cndmask_b32 v193, v193, v3, s[46:47]
    v_cndmask_b32 v66, v3, v66, s[48:49]
    v_cndmask_b32 v194, v194, v3, s[48:49]
    v_cndmask_b32 v67, v3, v67, s[50:51]
    v_cndmask_b32 v195, v195, v3, s[50:51]
    v_cndmask_b32 v68, v3, v68, s[52:53]
    v_cndmask_b32 v196, v196, v3, s[52:53]
    v_cndmask_b32 v69, v3, v69, s[54:55]
    v_cndmask_b32 v197, v197, v3, s[54:55]
    v_cndmask_b32 v70, v3, v70, s[56:57]
    v_cndmask_b32 v198, v198, v3, s[56:57]
    v_cndmask_b32 v71, v3, v71, s[58:59]
    v_cndmask_b32 v199, v199, v3, s[58:59]
    v_cndmask_b32 v72, v3, v72, s[60:61]
    v_cndmask_b32 v200, v200, v3, s[60:61]
    v_cndmask_b32 v73, v3, v73, s[62:63]
    v_cndmask_b32 v201, v201, v3, s[62:63]
    v_cndmask_b32 v74, v3, v74, s[64:65]
    v_cndmask_b32 v202, v202, v3, s[64:65]
    v_cndmask_b32 v75, v3, v75, s[66:67]
    v_cndmask_b32 v203, v203, v3, s[66:67]
    v_cndmask_b32 v76, v3, v76, s[68:69]
    v_cndmask_b32 v204, v204, v3, s[68:69]
    v_cndmask_b32 v77, v3, v77, s[70:71]
    v_cndmask_b32 v205, v205, v3, s[70:71]
    v_cndmask_b32 v78, v3, v78, s[72:73]
    v_cndmask_b32 v206, v206, v3, s[72:73]
    v_cndmask_b32 v79, v3, v79, s[74:75]
    v_cndmask_b32 v207, v207, v3, s[74:75]
    v_max3_f32 v240, v64, v65, v66
    v_max3_f32 v241, v67, v68, v69
    v_max3_f32 v240, v240, v70, v71
    v_max3_f32 v241, v241, v72, v73
    v_max3_f32 v240, v240, v74, v75
    v_max3_f32 v241, v241, v76, v77
    v_max3_f32 v240, v240, v78, v79
    v_max3_f32 v241, v241, v80, v81
    v_max3_f32 v240, v240, v82, v83
    v_max3_f32 v241, v241, v84, v85
    v_max3_f32 v240, v240, v86, v87
    v_max3_f32 v241, v241, v88, v89
    v_max3_f32 v240, v240, v90, v91
    v_max3_f32 v241, v241, v92, v93
    v_max3_f32 v240, v240, v94, v95
    v_max3_f32 v241, v241, v96, v97
    v_max3_f32 v240, v240, v98, v99
    v_max3_f32 v241, v241, v100, v101
    v_max3_f32 v240, v240, v102, v103
    v_max3_f32 v241, v241, v104, v105
    v_max3_f32 v240, v240, v106, v107
    v_max3_f32 v241, v241, v108, v109
    v_max3_f32 v240, v240, v110, v111
    v_max3_f32 v241, v241, v112, v113
    v_max3_f32 v240, v240, v114, v115
    v_max3_f32 v241, v241, v116, v117
    v_max3_f32 v240, v240, v118, v119
    v_max3_f32 v241, v241, v120, v121
    v_max3_f32 v240, v240, v122, v123
    v_max3_f32 v241, v241, v124, v125
    v_max3_f32 v240, v240, v126, v127
    v_max3_f32 v241, v241, v128, v129
    v_max3_f32 v240, v240, v130, v131
    v_max3_f32 v241, v241, v132, v133
    v_max3_f32 v240, v240, v134, v135
    v_max3_f32 v241, v241, v136, v137
    v_max3_f32 v240, v240, v138, v139
    v_max3_f32 v241, v241, v140, v141
    v_max3_f32 v240, v240, v142, v143
    v_max3_f32 v241, v241, v144, v145
    v_max3_f32 v240, v240, v146, v147
    v_max3_f32 v241, v241, v148, v149
    v_max3_f32 v240, v240, v150, v151
    v_max3_f32 v241, v241, v152, v153
    v_max3_f32 v240, v240, v154, v155
    v_max3_f32 v241, v241, v156, v157
    v_max3_f32 v240, v240, v158, v159
    v_max3_f32 v241, v241, v160, v161
    v_max3_f32 v240, v240, v162, v163
    v_max3_f32 v241, v241, v164, v165
    v_max3_f32 v240, v240, v166, v167
    v_max3_f32 v241, v241, v168, v169
    v_max3_f32 v240, v240, v170, v171
    v_max3_f32 v241, v241, v172, v173
    v_max3_f32 v240, v240, v174, v175
    v_max3_f32 v241, v241, v176, v177
    v_max3_f32 v240, v240, v178, v179
    v_max3_f32 v241, v241, v180, v181
    v_max3_f32 v240, v240, v182, v183
    v_max3_f32 v241, v241, v184, v185
    v_max3_f32 v240, v240, v186, v187
    v_max3_f32 v241, v241, v188, v189
    v_max3_f32 v240, v240, v190, v191
    v_max3_f32 v241, v241, v192, v193
    v_max3_f32 v240, v240, v194, v195
    v_max3_f32 v241, v241, v196, v197
    v_max3_f32 v240, v240, v198, v199
    v_max3_f32 v241, v241, v200, v201
    v_max3_f32 v240, v240, v202, v203
    v_max3_f32 v241, v241, v204, v205
    v_max3_f32 v240, v240, v206, v207
    v_max_f32 v240, v240, v241
    v_mov_b32 v241, v240
    s_nop 1
    v_permlane32_swap_b32 v240, v241
    v_max_f32 v240, v240, v241
    v_mul_f32 v240, s84, v240
    v_fma_f32 v64, v64, s84, -v240
    v_fma_f32 v65, v65, s84, -v240
    v_fma_f32 v66, v66, s84, -v240
    v_fma_f32 v67, v67, s84, -v240
    v_fma_f32 v68, v68, s84, -v240
    v_fma_f32 v69, v69, s84, -v240
    v_fma_f32 v70, v70, s84, -v240
    v_fma_f32 v71, v71, s84, -v240
    v_fma_f32 v72, v72, s84, -v240
    v_fma_f32 v73, v73, s84, -v240
    v_fma_f32 v74, v74, s84, -v240
    v_fma_f32 v75, v75, s84, -v240
    v_fma_f32 v76, v76, s84, -v240
    v_fma_f32 v77, v77, s84, -v240
    v_fma_f32 v78, v78, s84, -v240
    v_fma_f32 v79, v79, s84, -v240
    v_exp_f32 v64, v64
    v_exp_f32 v65, v65
    v_exp_f32 v66, v66
    v_exp_f32 v67, v67
    v_exp_f32 v68, v68
    v_exp_f32 v69, v69
    v_exp_f32 v70, v70
    v_exp_f32 v71, v71
    v_exp_f32 v72, v72
    v_exp_f32 v73, v73
    v_exp_f32 v74, v74
    v_exp_f32 v75, v75
    v_exp_f32 v76, v76
    v_exp_f32 v77, v77
    v_exp_f32 v78, v78
    v_exp_f32 v79, v79
    v_cvt_pk_bf16_f32 v64, v64, v65
    v_cvt_pk_bf16_f32 v65, v66, v67
    v_cvt_pk_bf16_f32 v66, v68, v69
    v_cvt_pk_bf16_f32 v67, v70, v71
    v_cvt_pk_bf16_f32 v68, v72, v73
    v_cvt_pk_bf16_f32 v69, v74, v75
    v_cvt_pk_bf16_f32 v70, v76, v77
    v_cvt_pk_bf16_f32 v71, v78, v79
    v_mfma_f32_32x32x16_bf16 v[208:223], a[0:3], v[64:67], 0
    v_mfma_f32_32x32x16_bf16 v[224:239], v[4:7], v[64:67], 0
    v_mfma_f32_32x32x16_bf16 v[208:223], a[4:7], v[68:71], v[208:223]
    v_mfma_f32_32x32x16_bf16 v[224:239], v[4:7], v[68:71], v[224:239]
    v_fma_f32 v80, v80, s84, -v240
    v_fma_f32 v81, v81, s84, -v240
    v_fma_f32 v82, v82, s84, -v240
    v_fma_f32 v83, v83, s84, -v240
    v_fma_f32 v84, v84, s84, -v240
    v_fma_f32 v85, v85, s84, -v240
    v_fma_f32 v86, v86, s84, -v240
    v_fma_f32 v87, v87, s84, -v240
    v_fma_f32 v88, v88, s84, -v240
    v_fma_f32 v89, v89, s84, -v240
    v_fma_f32 v90, v90, s84, -v240
    v_fma_f32 v91, v91, s84, -v240
    v_fma_f32 v92, v92, s84, -v240
    v_fma_f32 v93, v93, s84, -v240
    v_fma_f32 v94, v94, s84, -v240
    v_fma_f32 v95, v95, s84, -v240
    v_exp_f32 v80, v80
    v_exp_f32 v81, v81
    v_exp_f32 v82, v82
    v_exp_f32 v83, v83
    v_exp_f32 v84, v84
    v_exp_f32 v85, v85
    v_exp_f32 v86, v86
    v_exp_f32 v87, v87
    v_exp_f32 v88, v88
    v_exp_f32 v89, v89
    v_exp_f32 v90, v90
    v_exp_f32 v91, v91
    v_exp_f32 v92, v92
    v_exp_f32 v93, v93
    v_exp_f32 v94, v94
    v_exp_f32 v95, v95
    v_cvt_pk_bf16_f32 v80, v80, v81
    v_cvt_pk_bf16_f32 v81, v82, v83
    v_cvt_pk_bf16_f32 v82, v84, v85
    v_cvt_pk_bf16_f32 v83, v86, v87
    v_cvt_pk_bf16_f32 v84, v88, v89
    v_cvt_pk_bf16_f32 v85, v90, v91
    v_cvt_pk_bf16_f32 v86, v92, v93
    v_cvt_pk_bf16_f32 v87, v94, v95
    v_mfma_f32_32x32x16_bf16 v[208:223], a[8:11], v[80:83], v[208:223]
    v_mfma_f32_32x32x16_bf16 v[224:239], v[4:7], v[80:83], v[224:239]
    v_mfma_f32_32x32x16_bf16 v[208:223], a[12:15], v[84:87], v[208:223]
    v_mfma_f32_32x32x16_bf16 v[224:239], v[4:7], v[84:87], v[224:239]
    v_fma_f32 v96, v96, s84, -v240
    v_fma_f32 v97, v97, s84, -v240
    v_fma_f32 v98, v98, s84, -v240
    v_fma_f32 v99, v99, s84, -v240
    v_fma_f32 v100, v100, s84, -v240
    v_fma_f32 v101, v101, s84, -v240
    v_fma_f32 v102, v102, s84, -v240
    v_fma_f32 v103, v103, s84, -v240
    v_fma_f32 v104, v104, s84, -v240
    v_fma_f32 v105, v105, s84, -v240
    v_fma_f32 v106, v106, s84, -v240
    v_fma_f32 v107, v107, s84, -v240
    v_fma_f32 v108, v108, s84, -v240
    v_fma_f32 v109, v109, s84, -v240
    v_fma_f32 v110, v110, s84, -v240
    v_fma_f32 v111, v111, s84, -v240
    v_exp_f32 v96, v96
    v_exp_f32 v97, v97
    v_exp_f32 v98, v98
    v_exp_f32 v99, v99
    v_exp_f32 v100, v100
    v_exp_f32 v101, v101
    v_exp_f32 v102, v102
    v_exp_f32 v103, v103
    v_exp_f32 v104, v104
    v_exp_f32 v105, v105
    v_exp_f32 v106, v106
    v_exp_f32 v107, v107
    v_exp_f32 v108, v108
    v_exp_f32 v109, v109
    v_exp_f32 v110, v110
    v_exp_f32 v111, v111
    v_cvt_pk_bf16_f32 v96, v96, v97
    v_cvt_pk_bf16_f32 v97, v98, v99
    v_cvt_pk_bf16_f32 v98, v100, v101
    v_cvt_pk_bf16_f32 v99, v102, v103
    v_cvt_pk_bf16_f32 v100, v104, v105
    v_cvt_pk_bf16_f32 v101, v106, v107
    v_cvt_pk_bf16_f32 v102, v108, v109
    v_cvt_pk_bf16_f32 v103, v110, v111
    v_mfma_f32_32x32x16_bf16 v[208:223], a[16:19], v[96:99], v[208:223]
    v_mfma_f32_32x32x16_bf16 v[224:239], v[4:7], v[96:99], v[224:239]
    v_mfma_f32_32x32x16_bf16 v[208:223], a[20:23], v[100:103], v[208:223]
    v_mfma_f32_32x32x16_bf16 v[224:239], v[4:7], v[100:103], v[224:239]
    v_fma_f32 v112, v112, s84, -v240
    v_fma_f32 v113, v113, s84, -v240
    v_fma_f32 v114, v114, s84, -v240
    v_fma_f32 v115, v115, s84, -v240
    v_fma_f32 v116, v116, s84, -v240
    v_fma_f32 v117, v117, s84, -v240
    v_fma_f32 v118, v118, s84, -v240
    v_fma_f32 v119, v119, s84, -v240
    v_fma_f32 v120, v120, s84, -v240
    v_fma_f32 v121, v121, s84, -v240
    v_fma_f32 v122, v122, s84, -v240
    v_fma_f32 v123, v123, s84, -v240
    v_fma_f32 v124, v124, s84, -v240
    v_fma_f32 v125, v125, s84, -v240
    v_fma_f32 v126, v126, s84, -v240
    v_fma_f32 v127, v127, s84, -v240
    v_exp_f32 v112, v112
    v_exp_f32 v113, v113
    v_exp_f32 v114, v114
    v_exp_f32 v115, v115
    v_exp_f32 v116, v116
    v_exp_f32 v117, v117
    v_exp_f32 v118, v118
    v_exp_f32 v119, v119
    v_exp_f32 v120, v120
    v_exp_f32 v121, v121
    v_exp_f32 v122, v122
    v_exp_f32 v123, v123
    v_exp_f32 v124, v124
    v_exp_f32 v125, v125
    v_exp_f32 v126, v126
    v_exp_f32 v127, v127
    v_cvt_pk_bf16_f32 v112, v112, v113
    v_cvt_pk_bf16_f32 v113, v114, v115
    v_cvt_pk_bf16_f32 v114, v116, v117
    v_cvt_pk_bf16_f32 v115, v118, v119
    v_cvt_pk_bf16_f32 v116, v120, v121
    v_cvt_pk_bf16_f32 v117, v122, v123
    v_cvt_pk_bf16_f32 v118, v124, v125
    v_cvt_pk_bf16_f32 v119, v126, v127
    v_mfma_f32_32x32x16_bf16 v[208:223], a[24:27], v[112:115], v[208:223]
    v_mfma_f32_32x32x16_bf16 v[224:239], v[4:7], v[112:115], v[224:239]
    v_mfma_f32_32x32x16_bf16 v[208:223], a[28:31], v[116:119], v[208:223]
    v_mfma_f32_32x32x16_bf16 v[224:239], v[4:7], v[116:119], v[224:239]
    v_fma_f32 v128, v128, s84, -v240
    v_fma_f32 v129, v129, s84, -v240
    v_fma_f32 v130, v130, s84, -v240
    v_fma_f32 v131, v131, s84, -v240
    v_fma_f32 v132, v132, s84, -v240
    v_fma_f32 v133, v133, s84, -v240
    v_fma_f32 v134, v134, s84, -v240
    v_fma_f32 v135, v135, s84, -v240
    v_fma_f32 v136, v136, s84, -v240
    v_fma_f32 v137, v137, s84, -v240
    v_fma_f32 v138, v138, s84, -v240
    v_fma_f32 v139, v139, s84, -v240
    v_fma_f32 v140, v140, s84, -v240
    v_fma_f32 v141, v141, s84, -v240
    v_fma_f32 v142, v142, s84, -v240
    v_fma_f32 v143, v143, s84, -v240
    v_exp_f32 v128, v128
    v_exp_f32 v129, v129
    v_exp_f32 v130, v130
    v_exp_f32 v131, v131
    v_exp_f32 v132, v132
    v_exp_f32 v133, v133
    v_exp_f32 v134, v134
    v_exp_f32 v135, v135
    v_exp_f32 v136, v136
    v_exp_f32 v137, v137
    v_exp_f32 v138, v138
    v_exp_f32 v139, v139
    v_exp_f32 v140, v140
    v_exp_f32 v141, v141
    v_exp_f32 v142, v142
    v_exp_f32 v143, v143
    v_cvt_pk_bf16_f32 v128, v128, v129
    v_cvt_pk_bf16_f32 v129, v130, v131
    v_cvt_pk_bf16_f32 v130, v132, v133
    v_cvt_pk_bf16_f32 v131, v134, v135
    v_cvt_pk_bf16_f32 v132, v136, v137
    v_cvt_pk_bf16_f32 v133, v138, v139
    v_cvt_pk_bf16_f32 v134, v140, v141
    v_cvt_pk_bf16_f32 v135, v142, v143
    v_mfma_f32_32x32x16_bf16 v[208:223], a[32:35], v[128:131], v[208:223]
    v_mfma_f32_32x32x16_bf16 v[224:239], v[4:7], v[128:131], v[224:239]
    v_mfma_f32_32x32x16_bf16 v[208:223], a[36:39], v[132:135], v[208:223]
    v_mfma_f32_32x32x16_bf16 v[224:239], v[4:7], v[132:135], v[224:239]
    v_fma_f32 v144, v144, s84, -v240
    v_fma_f32 v145, v145, s84, -v240
    v_fma_f32 v146, v146, s84, -v240
    v_fma_f32 v147, v147, s84, -v240
    v_fma_f32 v148, v148, s84, -v240
    v_fma_f32 v149, v149, s84, -v240
    v_fma_f32 v150, v150, s84, -v240
    v_fma_f32 v151, v151, s84, -v240
    v_fma_f32 v152, v152, s84, -v240
    v_fma_f32 v153, v153, s84, -v240
    v_fma_f32 v154, v154, s84, -v240
    v_fma_f32 v155, v155, s84, -v240
    v_fma_f32 v156, v156, s84, -v240
    v_fma_f32 v157, v157, s84, -v240
    v_fma_f32 v158, v158, s84, -v240
    v_fma_f32 v159, v159, s84, -v240
    v_exp_f32 v144, v144
    v_exp_f32 v145, v145
    v_exp_f32 v146, v146
    v_exp_f32 v147, v147
    v_exp_f32 v148, v148
    v_exp_f32 v149, v149
    v_exp_f32 v150, v150
    v_exp_f32 v151, v151
    v_exp_f32 v152, v152
    v_exp_f32 v153, v153
    v_exp_f32 v154, v154
    v_exp_f32 v155, v155
    v_exp_f32 v156, v156
    v_exp_f32 v157, v157
    v_exp_f32 v158, v158
    v_exp_f32 v159, v159
    v_cvt_pk_bf16_f32 v144, v144, v145
    v_cvt_pk_bf16_f32 v145, v146, v147
    v_cvt_pk_bf16_f32 v146, v148, v149
    v_cvt_pk_bf16_f32 v147, v150, v151
    v_cvt_pk_bf16_f32 v148, v152, v153
    v_cvt_pk_bf16_f32 v149, v154, v155
    v_cvt_pk_bf16_f32 v150, v156, v157
    v_cvt_pk_bf16_f32 v151, v158, v159
    v_mfma_f32_32x32x16_bf16 v[208:223], a[40:43], v[144:147], v[208:223]
    v_mfma_f32_32x32x16_bf16 v[224:239], v[4:7], v[144:147], v[224:239]
    v_mfma_f32_32x32x16_bf16 v[208:223], a[44:47], v[148:151], v[208:223]
    v_mfma_f32_32x32x16_bf16 v[224:239], v[4:7], v[148:151], v[224:239]
    v_fma_f32 v160, v160, s84, -v240
    v_fma_f32 v161, v161, s84, -v240
    v_fma_f32 v162, v162, s84, -v240
    v_fma_f32 v163, v163, s84, -v240
    v_fma_f32 v164, v164, s84, -v240
    v_fma_f32 v165, v165, s84, -v240
    v_fma_f32 v166, v166, s84, -v240
    v_fma_f32 v167, v167, s84, -v240
    v_fma_f32 v168, v168, s84, -v240
    v_fma_f32 v169, v169, s84, -v240
    v_fma_f32 v170, v170, s84, -v240
    v_fma_f32 v171, v171, s84, -v240
    v_fma_f32 v172, v172, s84, -v240
    v_fma_f32 v173, v173, s84, -v240
    v_fma_f32 v174, v174, s84, -v240
    v_fma_f32 v175, v175, s84, -v240
    v_exp_f32 v160, v160
    v_exp_f32 v161, v161
    v_exp_f32 v162, v162
    v_exp_f32 v163, v163
    v_exp_f32 v164, v164
    v_exp_f32 v165, v165
    v_exp_f32 v166, v166
    v_exp_f32 v167, v167
    v_exp_f32 v168, v168
    v_exp_f32 v169, v169
    v_exp_f32 v170, v170
    v_exp_f32 v171, v171
    v_exp_f32 v172, v172
    v_exp_f32 v173, v173
    v_exp_f32 v174, v174
    v_exp_f32 v175, v175
    v_cvt_pk_bf16_f32 v160, v160, v161
    v_cvt_pk_bf16_f32 v161, v162, v163
    v_cvt_pk_bf16_f32 v162, v164, v165
    v_cvt_pk_bf16_f32 v163, v166, v167
    v_cvt_pk_bf16_f32 v164, v168, v169
    v_cvt_pk_bf16_f32 v165, v170, v171
    v_cvt_pk_bf16_f32 v166, v172, v173
    v_cvt_pk_bf16_f32 v167, v174, v175
    v_mfma_f32_32x32x16_bf16 v[208:223], a[48:51], v[160:163], v[208:223]
    v_mfma_f32_32x32x16_bf16 v[224:239], v[4:7], v[160:163], v[224:239]
    v_mfma_f32_32x32x16_bf16 v[208:223], a[52:55], v[164:167], v[208:223]
    v_mfma_f32_32x32x16_bf16 v[224:239], v[4:7], v[164:167], v[224:239]
    v_fma_f32 v176, v176, s84, -v240
    v_fma_f32 v177, v177, s84, -v240
    v_fma_f32 v178, v178, s84, -v240
    v_fma_f32 v179, v179, s84, -v240
    v_fma_f32 v180, v180, s84, -v240
    v_fma_f32 v181, v181, s84, -v240
    v_fma_f32 v182, v182, s84, -v240
    v_fma_f32 v183, v183, s84, -v240
    v_fma_f32 v184, v184, s84, -v240
    v_fma_f32 v185, v185, s84, -v240
    v_fma_f32 v186, v186, s84, -v240
    v_fma_f32 v187, v187, s84, -v240
    v_fma_f32 v188, v188, s84, -v240
    v_fma_f32 v189, v189, s84, -v240
    v_fma_f32 v190, v190, s84, -v240
    v_fma_f32 v191, v191, s84, -v240
    v_exp_f32 v176, v176
    v_exp_f32 v177, v177
    v_exp_f32 v178, v178
    v_exp_f32 v179, v179
    v_exp_f32 v180, v180
    v_exp_f32 v181, v181
    v_exp_f32 v182, v182
    v_exp_f32 v183, v183
    v_exp_f32 v184, v184
    v_exp_f32 v185, v185
    v_exp_f32 v186, v186
    v_exp_f32 v187, v187
    v_exp_f32 v188, v188
    v_exp_f32 v189, v189
    v_exp_f32 v190, v190
    v_exp_f32 v191, v191
    v_cvt_pk_bf16_f32 v176, v176, v177
    v_cvt_pk_bf16_f32 v177, v178, v179
    v_cvt_pk_bf16_f32 v178, v180, v181
    v_cvt_pk_bf16_f32 v179, v182, v183
    v_cvt_pk_bf16_f32 v180, v184, v185
    v_cvt_pk_bf16_f32 v181, v186, v187
    v_cvt_pk_bf16_f32 v182, v188, v189
    v_cvt_pk_bf16_f32 v183, v190, v191
    v_mfma_f32_32x32x16_bf16 v[208:223], a[56:59], v[176:179], v[208:223]
    v_mfma_f32_32x32x16_bf16 v[224:239], v[4:7], v[176:179], v[224:239]
    v_mfma_f32_32x32x16_bf16 v[208:223], a[60:63], v[180:183], v[208:223]
    v_mfma_f32_32x32x16_bf16 v[224:239], v[4:7], v[180:183], v[224:239]
    v_fma_f32 v192, v192, s84, -v240
    v_fma_f32 v193, v193, s84, -v240
    v_fma_f32 v194, v194, s84, -v240
    v_fma_f32 v195, v195, s84, -v240
    v_fma_f32 v196, v196, s84, -v240
    v_fma_f32 v197, v197, s84, -v240
    v_fma_f32 v198, v198, s84, -v240
    v_fma_f32 v199, v199, s84, -v240
    v_fma_f32 v200, v200, s84, -v240
    v_fma_f32 v201, v201, s84, -v240
    v_fma_f32 v202, v202, s84, -v240
    v_fma_f32 v203, v203, s84, -v240
    v_fma_f32 v204, v204, s84, -v240
    v_fma_f32 v205, v205, s84, -v240
    v_fma_f32 v206, v206, s84, -v240
    v_fma_f32 v207, v207, s84, -v240
    v_exp_f32 v192, v192
    v_exp_f32 v193, v193
    v_exp_f32 v194, v194
    v_exp_f32 v195, v195
    v_exp_f32 v196, v196
    v_exp_f32 v197, v197
    v_exp_f32 v198, v198
    v_exp_f32 v199, v199
    v_exp_f32 v200, v200
    v_exp_f32 v201, v201
    v_exp_f32 v202, v202
    v_exp_f32 v203, v203
    v_exp_f32 v204, v204
    v_exp_f32 v205, v205
    v_exp_f32 v206, v206
    v_exp_f32 v207, v207
    v_cvt_pk_bf16_f32 v192, v192, v193
    v_cvt_pk_bf16_f32 v193, v194, v195
    v_cvt_pk_bf16_f32 v194, v196, v197
    v_cvt_pk_bf16_f32 v195, v198, v199
    v_cvt_pk_bf16_f32 v196, v200, v201
    v_cvt_pk_bf16_f32 v197, v202, v203
    v_cvt_pk_bf16_f32 v198, v204, v205
    v_cvt_pk_bf16_f32 v199, v206, v207
    v_mfma_f32_32x32x16_bf16 v[208:223], a[64:67], v[192:195], v[208:223]
    v_mfma_f32_32x32x16_bf16 v[224:239], v[4:7], v[192:195], v[224:239]
    v_mfma_f32_32x32x16_bf16 v[208:223], a[68:71], v[196:199], v[208:223]
    v_mfma_f32_32x32x16_bf16 v[224:239], v[4:7], v[196:199], v[224:239]
    s_nop 11
    v_rcp_f32 v240, v224
    s_nop 0
    v_mul_f32 v208, v208, v240
    v_mul_f32 v209, v209, v240
    v_mul_f32 v210, v210, v240
    v_mul_f32 v211, v211, v240
    v_mul_f32 v212, v212, v240
    v_mul_f32 v213, v213, v240
    v_mul_f32 v214, v214, v240
    v_mul_f32 v215, v215, v240
    v_cvt_pk_bf16_f32 v244, v208, v209
    v_cvt_pk_bf16_f32 v245, v210, v211
    v_cvt_pk_bf16_f32 v246, v212, v213
    v_cvt_pk_bf16_f32 v247, v214, v215
    global_store_dwordx4 v2, v[244:247], s[92:93] offset:0 sc1
    s_cmp_lt_u32 s7, 8
    s_cbranch_scc1 Laa_134
    v_mfma_f32_32x32x16_bf16 v[64:79], a[108:111], v[12:15], 0
    s_branch Laa_135
Laa_134:
    s_nop 10
    v_mov_b32 v64, v3
    v_mov_b32 v65, v3
    v_mov_b32 v66, v3
    v_mov_b32 v67, v3
    v_mov_b32 v68, v3
    v_mov_b32 v69, v3
    v_mov_b32 v70, v3
    v_mov_b32 v71, v3
    v_mov_b32 v72, v3
    v_mov_b32 v73, v3
    v_mov_b32 v74, v3
    v_mov_b32 v75, v3
    v_mov_b32 v76, v3
    v_mov_b32 v77, v3
    v_mov_b32 v78, v3
    v_mov_b32 v79, v3
Laa_135:
    s_cmp_lt_u32 s7, 7
    s_cbranch_scc1 Laa_136
    v_mfma_f32_32x32x16_bf16 v[80:95], a[112:115], v[12:15], 0
    s_branch Laa_137
Laa_136:
    s_nop 10
    v_mov_b32 v80, v3
    v_mov_b32 v81, v3
    v_mov_b32 v82, v3
    v_mov_b32 v83, v3
    v_mov_b32 v84, v3
    v_mov_b32 v85, v3
    v_mov_b32 v86, v3
    v_mov_b32 v87, v3
    v_mov_b32 v88, v3
    v_mov_b32 v89, v3
    v_mov_b32 v90, v3
    v_mov_b32 v91, v3
    v_mov_b32 v92, v3
    v_mov_b32 v93, v3
    v_mov_b32 v94, v3
    v_mov_b32 v95, v3
Laa_137:
    s_cmp_lt_u32 s7, 6
    s_cbranch_scc1 Laa_138
    v_mfma_f32_32x32x16_bf16 v[96:111], a[116:119], v[12:15], 0
    s_branch Laa_139
Laa_138:
    s_nop 10
    v_mov_b32 v96, v3
    v_mov_b32 v97, v3
    v_mov_b32 v98, v3
    v_mov_b32 v99, v3
    v_mov_b32 v100, v3
    v_mov_b32 v101, v3
    v_mov_b32 v102, v3
    v_mov_b32 v103, v3
    v_mov_b32 v104, v3
    v_mov_b32 v105, v3
    v_mov_b32 v106, v3
    v_mov_b32 v107, v3
    v_mov_b32 v108, v3
    v_mov_b32 v109, v3
    v_mov_b32 v110, v3
    v_mov_b32 v111, v3
Laa_139:
    s_cmp_lt_u32 s7, 5
    s_cbranch_scc1 Laa_140
    v_mfma_f32_32x32x16_bf16 v[112:127], a[120:123], v[12:15], 0
    s_branch Laa_141
Laa_140:
    s_nop 10
    v_mov_b32 v112, v3
    v_mov_b32 v113, v3
    v_mov_b32 v114, v3
    v_mov_b32 v115, v3
    v_mov_b32 v116, v3
    v_mov_b32 v117, v3
    v_mov_b32 v118, v3
    v_mov_b32 v119, v3
    v_mov_b32 v120, v3
    v_mov_b32 v121, v3
    v_mov_b32 v122, v3
    v_mov_b32 v123, v3
    v_mov_b32 v124, v3
    v_mov_b32 v125, v3
    v_mov_b32 v126, v3
    v_mov_b32 v127, v3
Laa_141:
    s_cmp_lt_u32 s7, 4
    s_cbranch_scc1 Laa_142
    v_mfma_f32_32x32x16_bf16 v[128:143], a[124:127], v[12:15], 0
    s_branch Laa_143
Laa_142:
    s_nop 10
    v_mov_b32 v128, v3
    v_mov_b32 v129, v3
    v_mov_b32 v130, v3
    v_mov_b32 v131, v3
    v_mov_b32 v132, v3
    v_mov_b32 v133, v3
    v_mov_b32 v134, v3
    v_mov_b32 v135, v3
    v_mov_b32 v136, v3
    v_mov_b32 v137, v3
    v_mov_b32 v138, v3
    v_mov_b32 v139, v3
    v_mov_b32 v140, v3
    v_mov_b32 v141, v3
    v_mov_b32 v142, v3
    v_mov_b32 v143, v3
Laa_143:
    s_cmp_lt_u32 s7, 3
    s_cbranch_scc1 Laa_144
    v_mfma_f32_32x32x16_bf16 v[144:159], a[128:131], v[12:15], 0
    s_branch Laa_145
Laa_144:
    s_nop 10
    v_mov_b32 v144, v3
    v_mov_b32 v145, v3
    v_mov_b32 v146, v3
    v_mov_b32 v147, v3
    v_mov_b32 v148, v3
    v_mov_b32 v149, v3
    v_mov_b32 v150, v3
    v_mov_b32 v151, v3
    v_mov_b32 v152, v3
    v_mov_b32 v153, v3
    v_mov_b32 v154, v3
    v_mov_b32 v155, v3
    v_mov_b32 v156, v3
    v_mov_b32 v157, v3
    v_mov_b32 v158, v3
    v_mov_b32 v159, v3
Laa_145:
    s_cmp_lt_u32 s7, 2
    s_cbranch_scc1 Laa_146
    v_mfma_f32_32x32x16_bf16 v[160:175], a[132:135], v[12:15], 0
    s_branch Laa_147
Laa_146:
    s_nop 10
    v_mov_b32 v160, v3
    v_mov_b32 v161, v3
    v_mov_b32 v162, v3
    v_mov_b32 v163, v3
    v_mov_b32 v164, v3
    v_mov_b32 v165, v3
    v_mov_b32 v166, v3
    v_mov_b32 v167, v3
    v_mov_b32 v168, v3
    v_mov_b32 v169, v3
    v_mov_b32 v170, v3
    v_mov_b32 v171, v3
    v_mov_b32 v172, v3
    v_mov_b32 v173, v3
    v_mov_b32 v174, v3
    v_mov_b32 v175, v3
Laa_147:
    s_cmp_lt_u32 s7, 1
    s_cbranch_scc1 Laa_148
    v_mfma_f32_32x32x16_bf16 v[176:191], a[136:139], v[12:15], 0
    s_branch Laa_149
Laa_148:
    s_nop 10
    v_mov_b32 v176, v3
    v_mov_b32 v177, v3
    v_mov_b32 v178, v3
    v_mov_b32 v179, v3
    v_mov_b32 v180, v3
    v_mov_b32 v181, v3
    v_mov_b32 v182, v3
    v_mov_b32 v183, v3
    v_mov_b32 v184, v3
    v_mov_b32 v185, v3
    v_mov_b32 v186, v3
    v_mov_b32 v187, v3
    v_mov_b32 v188, v3
    v_mov_b32 v189, v3
    v_mov_b32 v190, v3
    v_mov_b32 v191, v3
Laa_149:
    v_mfma_f32_32x32x16_bf16 v[192:207], a[140:143], v[12:15], 0
    s_nop 15
    v_cndmask_b32 v64, v3, v64, s[44:45]
    v_cndmask_b32 v192, v192, v3, s[44:45]
    v_cndmask_b32 v65, v3, v65, s[46:47]
    v_cndmask_b32 v193, v193, v3, s[46:47]
    v_cndmask_b32 v66, v3, v66, s[48:49]
    v_cndmask_b32 v194, v194, v3, s[48:49]
    v_cndmask_b32 v67, v3, v67, s[50:51]
    v_cndmask_b32 v195, v195, v3, s[50:51]
    v_cndmask_b32 v68, v3, v68, s[52:53]
    v_cndmask_b32 v196, v196, v3, s[52:53]
    v_cndmask_b32 v69, v3, v69, s[54:55]
    v_cndmask_b32 v197, v197, v3, s[54:55]
    v_cndmask_b32 v70, v3, v70, s[56:57]
    v_cndmask_b32 v198, v198, v3, s[56:57]
    v_cndmask_b32 v71, v3, v71, s[58:59]
    v_cndmask_b32 v199, v199, v3, s[58:59]
    v_cndmask_b32 v72, v3, v72, s[60:61]
    v_cndmask_b32 v200, v200, v3, s[60:61]
    v_cndmask_b32 v73, v3, v73, s[62:63]
    v_cndmask_b32 v201, v201, v3, s[62:63]
    v_cndmask_b32 v74, v3, v74, s[64:65]
    v_cndmask_b32 v202, v202, v3, s[64:65]
    v_cndmask_b32 v75, v3, v75, s[66:67]
    v_cndmask_b32 v203, v203, v3, s[66:67]
    v_cndmask_b32 v76, v3, v76, s[68:69]
    v_cndmask_b32 v204, v204, v3, s[68:69]
    v_cndmask_b32 v77, v3, v77, s[70:71]
    v_cndmask_b32 v205, v205, v3, s[70:71]
    v_cndmask_b32 v78, v3, v78, s[72:73]
    v_cndmask_b32 v206, v206, v3, s[72:73]
    v_cndmask_b32 v79, v3, v79, s[74:75]
    v_cndmask_b32 v207, v207, v3, s[74:75]
    v_max3_f32 v240, v64, v65, v66
    v_max3_f32 v241, v67, v68, v69
    v_max3_f32 v240, v240, v70, v71
    v_max3_f32 v241, v241, v72, v73
    v_max3_f32 v240, v240, v74, v75
    v_max3_f32 v241, v241, v76, v77
    v_max3_f32 v240, v240, v78, v79
    v_max3_f32 v241, v241, v80, v81
    v_max3_f32 v240, v240, v82, v83
    v_max3_f32 v241, v241, v84, v85
    v_max3_f32 v240, v240, v86, v87
    v_max3_f32 v241, v241, v88, v89
    v_max3_f32 v240, v240, v90, v91
    v_max3_f32 v241, v241, v92, v93
    v_max3_f32 v240, v240, v94, v95
    v_max3_f32 v241, v241, v96, v97
    v_max3_f32 v240, v240, v98, v99
    v_max3_f32 v241, v241, v100, v101
    v_max3_f32 v240, v240, v102, v103
    v_max3_f32 v241, v241, v104, v105
    v_max3_f32 v240, v240, v106, v107
    v_max3_f32 v241, v241, v108, v109
    v_max3_f32 v240, v240, v110, v111
    v_max3_f32 v241, v241, v112, v113
    v_max3_f32 v240, v240, v114, v115
    v_max3_f32 v241, v241, v116, v117
    v_max3_f32 v240, v240, v118, v119
    v_max3_f32 v241, v241, v120, v121
    v_max3_f32 v240, v240, v122, v123
    v_max3_f32 v241, v241, v124, v125
    v_max3_f32 v240, v240, v126, v127
    v_max3_f32 v241, v241, v128, v129
    v_max3_f32 v240, v240, v130, v131
    v_max3_f32 v241, v241, v132, v133
    v_max3_f32 v240, v240, v134, v135
    v_max3_f32 v241, v241, v136, v137
    v_max3_f32 v240, v240, v138, v139
    v_max3_f32 v241, v241, v140, v141
    v_max3_f32 v240, v240, v142, v143
    v_max3_f32 v241, v241, v144, v145
    v_max3_f32 v240, v240, v146, v147
    v_max3_f32 v241, v241, v148, v149
    v_max3_f32 v240, v240, v150, v151
    v_max3_f32 v241, v241, v152, v153
    v_max3_f32 v240, v240, v154, v155
    v_max3_f32 v241, v241, v156, v157
    v_max3_f32 v240, v240, v158, v159
    v_max3_f32 v241, v241, v160, v161
    v_max3_f32 v240, v240, v162, v163
    v_max3_f32 v241, v241, v164, v165
    v_max3_f32 v240, v240, v166, v167
    v_max3_f32 v241, v241, v168, v169
    v_max3_f32 v240, v240, v170, v171
    v_max3_f32 v241, v241, v172, v173
    v_max3_f32 v240, v240, v174, v175
    v_max3_f32 v241, v241, v176, v177
    v_max3_f32 v240, v240, v178, v179
    v_max3_f32 v241, v241, v180, v181
    v_max3_f32 v240, v240, v182, v183
    v_max3_f32 v241, v241, v184, v185
    v_max3_f32 v240, v240, v186, v187
    v_max3_f32 v241, v241, v188, v189
    v_max3_f32 v240, v240, v190, v191
    v_max3_f32 v241, v241, v192, v193
    v_max3_f32 v240, v240, v194, v195
    v_max3_f32 v241, v241, v196, v197
    v_max3_f32 v240, v240, v198, v199
    v_max3_f32 v241, v241, v200, v201
    v_max3_f32 v240, v240, v202, v203
    v_max3_f32 v241, v241, v204, v205
    v_max3_f32 v240, v240, v206, v207
    v_max_f32 v240, v240, v241
    v_mov_b32 v241, v240
    s_nop 1
    v_permlane32_swap_b32 v240, v241
    v_max_f32 v240, v240, v241
    v_mul_f32 v240, s84, v240
    v_fma_f32 v64, v64, s84, -v240
    v_fma_f32 v65, v65, s84, -v240
    v_fma_f32 v66, v66, s84, -v240
    v_fma_f32 v67, v67, s84, -v240
    v_fma_f32 v68, v68, s84, -v240
    v_fma_f32 v69, v69, s84, -v240
    v_fma_f32 v70, v70, s84, -v240
    v_fma_f32 v71, v71, s84, -v240
    v_fma_f32 v72, v72, s84, -v240
    v_fma_f32 v73, v73, s84, -v240
    v_fma_f32 v74, v74, s84, -v240
    v_fma_f32 v75, v75, s84, -v240
    v_fma_f32 v76, v76, s84, -v240
    v_fma_f32 v77, v77, s84, -v240
    v_fma_f32 v78, v78, s84, -v240
    v_fma_f32 v79, v79, s84, -v240
    v_exp_f32 v64, v64
    v_exp_f32 v65, v65
    v_exp_f32 v66, v66
    v_exp_f32 v67, v67
    v_exp_f32 v68, v68
    v_exp_f32 v69, v69
    v_exp_f32 v70, v70
    v_exp_f32 v71, v71
    v_exp_f32 v72, v72
    v_exp_f32 v73, v73
    v_exp_f32 v74, v74
    v_exp_f32 v75, v75
    v_exp_f32 v76, v76
    v_exp_f32 v77, v77
    v_exp_f32 v78, v78
    v_exp_f32 v79, v79
    v_cvt_pk_bf16_f32 v64, v64, v65
    v_cvt_pk_bf16_f32 v65, v66, v67
    v_cvt_pk_bf16_f32 v66, v68, v69
    v_cvt_pk_bf16_f32 v67, v70, v71
    v_cvt_pk_bf16_f32 v68, v72, v73
    v_cvt_pk_bf16_f32 v69, v74, v75
    v_cvt_pk_bf16_f32 v70, v76, v77
    v_cvt_pk_bf16_f32 v71, v78, v79
    v_mfma_f32_32x32x16_bf16 v[208:223], a[0:3], v[64:67], 0
    v_mfma_f32_32x32x16_bf16 v[224:239], v[4:7], v[64:67], 0
    v_mfma_f32_32x32x16_bf16 v[208:223], a[4:7], v[68:71], v[208:223]
    v_mfma_f32_32x32x16_bf16 v[224:239], v[4:7], v[68:71], v[224:239]
    v_fma_f32 v80, v80, s84, -v240
    v_fma_f32 v81, v81, s84, -v240
    v_fma_f32 v82, v82, s84, -v240
    v_fma_f32 v83, v83, s84, -v240
    v_fma_f32 v84, v84, s84, -v240
    v_fma_f32 v85, v85, s84, -v240
    v_fma_f32 v86, v86, s84, -v240
    v_fma_f32 v87, v87, s84, -v240
    v_fma_f32 v88, v88, s84, -v240
    v_fma_f32 v89, v89, s84, -v240
    v_fma_f32 v90, v90, s84, -v240
    v_fma_f32 v91, v91, s84, -v240
    v_fma_f32 v92, v92, s84, -v240
    v_fma_f32 v93, v93, s84, -v240
    v_fma_f32 v94, v94, s84, -v240
    v_fma_f32 v95, v95, s84, -v240
    v_exp_f32 v80, v80
    v_exp_f32 v81, v81
    v_exp_f32 v82, v82
    v_exp_f32 v83, v83
    v_exp_f32 v84, v84
    v_exp_f32 v85, v85
    v_exp_f32 v86, v86
    v_exp_f32 v87, v87
    v_exp_f32 v88, v88
    v_exp_f32 v89, v89
    v_exp_f32 v90, v90
    v_exp_f32 v91, v91
    v_exp_f32 v92, v92
    v_exp_f32 v93, v93
    v_exp_f32 v94, v94
    v_exp_f32 v95, v95
    v_cvt_pk_bf16_f32 v80, v80, v81
    v_cvt_pk_bf16_f32 v81, v82, v83
    v_cvt_pk_bf16_f32 v82, v84, v85
    v_cvt_pk_bf16_f32 v83, v86, v87
    v_cvt_pk_bf16_f32 v84, v88, v89
    v_cvt_pk_bf16_f32 v85, v90, v91
    v_cvt_pk_bf16_f32 v86, v92, v93
    v_cvt_pk_bf16_f32 v87, v94, v95
    v_mfma_f32_32x32x16_bf16 v[208:223], a[8:11], v[80:83], v[208:223]
    v_mfma_f32_32x32x16_bf16 v[224:239], v[4:7], v[80:83], v[224:239]
    v_mfma_f32_32x32x16_bf16 v[208:223], a[12:15], v[84:87], v[208:223]
    v_mfma_f32_32x32x16_bf16 v[224:239], v[4:7], v[84:87], v[224:239]
    v_fma_f32 v96, v96, s84, -v240
    v_fma_f32 v97, v97, s84, -v240
    v_fma_f32 v98, v98, s84, -v240
    v_fma_f32 v99, v99, s84, -v240
    v_fma_f32 v100, v100, s84, -v240
    v_fma_f32 v101, v101, s84, -v240
    v_fma_f32 v102, v102, s84, -v240
    v_fma_f32 v103, v103, s84, -v240
    v_fma_f32 v104, v104, s84, -v240
    v_fma_f32 v105, v105, s84, -v240
    v_fma_f32 v106, v106, s84, -v240
    v_fma_f32 v107, v107, s84, -v240
    v_fma_f32 v108, v108, s84, -v240
    v_fma_f32 v109, v109, s84, -v240
    v_fma_f32 v110, v110, s84, -v240
    v_fma_f32 v111, v111, s84, -v240
    v_exp_f32 v96, v96
    v_exp_f32 v97, v97
    v_exp_f32 v98, v98
    v_exp_f32 v99, v99
    v_exp_f32 v100, v100
    v_exp_f32 v101, v101
    v_exp_f32 v102, v102
    v_exp_f32 v103, v103
    v_exp_f32 v104, v104
    v_exp_f32 v105, v105
    v_exp_f32 v106, v106
    v_exp_f32 v107, v107
    v_exp_f32 v108, v108
    v_exp_f32 v109, v109
    v_exp_f32 v110, v110
    v_exp_f32 v111, v111
    v_cvt_pk_bf16_f32 v96, v96, v97
    v_cvt_pk_bf16_f32 v97, v98, v99
    v_cvt_pk_bf16_f32 v98, v100, v101
    v_cvt_pk_bf16_f32 v99, v102, v103
    v_cvt_pk_bf16_f32 v100, v104, v105
    v_cvt_pk_bf16_f32 v101, v106, v107
    v_cvt_pk_bf16_f32 v102, v108, v109
    v_cvt_pk_bf16_f32 v103, v110, v111
    v_mfma_f32_32x32x16_bf16 v[208:223], a[16:19], v[96:99], v[208:223]
    v_mfma_f32_32x32x16_bf16 v[224:239], v[4:7], v[96:99], v[224:239]
    v_mfma_f32_32x32x16_bf16 v[208:223], a[20:23], v[100:103], v[208:223]
    v_mfma_f32_32x32x16_bf16 v[224:239], v[4:7], v[100:103], v[224:239]
    v_fma_f32 v112, v112, s84, -v240
    v_fma_f32 v113, v113, s84, -v240
    v_fma_f32 v114, v114, s84, -v240
    v_fma_f32 v115, v115, s84, -v240
    v_fma_f32 v116, v116, s84, -v240
    v_fma_f32 v117, v117, s84, -v240
    v_fma_f32 v118, v118, s84, -v240
    v_fma_f32 v119, v119, s84, -v240
    v_fma_f32 v120, v120, s84, -v240
    v_fma_f32 v121, v121, s84, -v240
    v_fma_f32 v122, v122, s84, -v240
    v_fma_f32 v123, v123, s84, -v240
    v_fma_f32 v124, v124, s84, -v240
    v_fma_f32 v125, v125, s84, -v240
    v_fma_f32 v126, v126, s84, -v240
    v_fma_f32 v127, v127, s84, -v240
    v_exp_f32 v112, v112
    v_exp_f32 v113, v113
    v_exp_f32 v114, v114
    v_exp_f32 v115, v115
    v_exp_f32 v116, v116
    v_exp_f32 v117, v117
    v_exp_f32 v118, v118
    v_exp_f32 v119, v119
    v_exp_f32 v120, v120
    v_exp_f32 v121, v121
    v_exp_f32 v122, v122
    v_exp_f32 v123, v123
    v_exp_f32 v124, v124
    v_exp_f32 v125, v125
    v_exp_f32 v126, v126
    v_exp_f32 v127, v127
    v_cvt_pk_bf16_f32 v112, v112, v113
    v_cvt_pk_bf16_f32 v113, v114, v115
    v_cvt_pk_bf16_f32 v114, v116, v117
    v_cvt_pk_bf16_f32 v115, v118, v119
    v_cvt_pk_bf16_f32 v116, v120, v121
    v_cvt_pk_bf16_f32 v117, v122, v123
    v_cvt_pk_bf16_f32 v118, v124, v125
    v_cvt_pk_bf16_f32 v119, v126, v127
    v_mfma_f32_32x32x16_bf16 v[208:223], a[24:27], v[112:115], v[208:223]
    v_mfma_f32_32x32x16_bf16 v[224:239], v[4:7], v[112:115], v[224:239]
    v_mfma_f32_32x32x16_bf16 v[208:223], a[28:31], v[116:119], v[208:223]
    v_mfma_f32_32x32x16_bf16 v[224:239], v[4:7], v[116:119], v[224:239]
    v_fma_f32 v128, v128, s84, -v240
    v_fma_f32 v129, v129, s84, -v240
    v_fma_f32 v130, v130, s84, -v240
    v_fma_f32 v131, v131, s84, -v240
    v_fma_f32 v132, v132, s84, -v240
    v_fma_f32 v133, v133, s84, -v240
    v_fma_f32 v134, v134, s84, -v240
    v_fma_f32 v135, v135, s84, -v240
    v_fma_f32 v136, v136, s84, -v240
    v_fma_f32 v137, v137, s84, -v240
    v_fma_f32 v138, v138, s84, -v240
    v_fma_f32 v139, v139, s84, -v240
    v_fma_f32 v140, v140, s84, -v240
    v_fma_f32 v141, v141, s84, -v240
    v_fma_f32 v142, v142, s84, -v240
    v_fma_f32 v143, v143, s84, -v240
    v_exp_f32 v128, v128
    v_exp_f32 v129, v129
    v_exp_f32 v130, v130
    v_exp_f32 v131, v131
    v_exp_f32 v132, v132
    v_exp_f32 v133, v133
    v_exp_f32 v134, v134
    v_exp_f32 v135, v135
    v_exp_f32 v136, v136
    v_exp_f32 v137, v137
    v_exp_f32 v138, v138
    v_exp_f32 v139, v139
    v_exp_f32 v140, v140
    v_exp_f32 v141, v141
    v_exp_f32 v142, v142
    v_exp_f32 v143, v143
    v_cvt_pk_bf16_f32 v128, v128, v129
    v_cvt_pk_bf16_f32 v129, v130, v131
    v_cvt_pk_bf16_f32 v130, v132, v133
    v_cvt_pk_bf16_f32 v131, v134, v135
    v_cvt_pk_bf16_f32 v132, v136, v137
    v_cvt_pk_bf16_f32 v133, v138, v139
    v_cvt_pk_bf16_f32 v134, v140, v141
    v_cvt_pk_bf16_f32 v135, v142, v143
    v_mfma_f32_32x32x16_bf16 v[208:223], a[32:35], v[128:131], v[208:223]
    v_mfma_f32_32x32x16_bf16 v[224:239], v[4:7], v[128:131], v[224:239]
    v_mfma_f32_32x32x16_bf16 v[208:223], a[36:39], v[132:135], v[208:223]
    v_mfma_f32_32x32x16_bf16 v[224:239], v[4:7], v[132:135], v[224:239]
    v_fma_f32 v144, v144, s84, -v240
    v_fma_f32 v145, v145, s84, -v240
    v_fma_f32 v146, v146, s84, -v240
    v_fma_f32 v147, v147, s84, -v240
    v_fma_f32 v148, v148, s84, -v240
    v_fma_f32 v149, v149, s84, -v240
    v_fma_f32 v150, v150, s84, -v240
    v_fma_f32 v151, v151, s84, -v240
    v_fma_f32 v152, v152, s84, -v240
    v_fma_f32 v153, v153, s84, -v240
    v_fma_f32 v154, v154, s84, -v240
    v_fma_f32 v155, v155, s84, -v240
    v_fma_f32 v156, v156, s84, -v240
    v_fma_f32 v157, v157, s84, -v240
    v_fma_f32 v158, v158, s84, -v240
    v_fma_f32 v159, v159, s84, -v240
    v_exp_f32 v144, v144
    v_exp_f32 v145, v145
    v_exp_f32 v146, v146
    v_exp_f32 v147, v147
    v_exp_f32 v148, v148
    v_exp_f32 v149, v149
    v_exp_f32 v150, v150
    v_exp_f32 v151, v151
    v_exp_f32 v152, v152
    v_exp_f32 v153, v153
    v_exp_f32 v154, v154
    v_exp_f32 v155, v155
    v_exp_f32 v156, v156
    v_exp_f32 v157, v157
    v_exp_f32 v158, v158
    v_exp_f32 v159, v159
    v_cvt_pk_bf16_f32 v144, v144, v145
    v_cvt_pk_bf16_f32 v145, v146, v147
    v_cvt_pk_bf16_f32 v146, v148, v149
    v_cvt_pk_bf16_f32 v147, v150, v151
    v_cvt_pk_bf16_f32 v148, v152, v153
    v_cvt_pk_bf16_f32 v149, v154, v155
    v_cvt_pk_bf16_f32 v150, v156, v157
    v_cvt_pk_bf16_f32 v151, v158, v159
    v_mfma_f32_32x32x16_bf16 v[208:223], a[40:43], v[144:147], v[208:223]
    v_mfma_f32_32x32x16_bf16 v[224:239], v[4:7], v[144:147], v[224:239]
    v_mfma_f32_32x32x16_bf16 v[208:223], a[44:47], v[148:151], v[208:223]
    v_mfma_f32_32x32x16_bf16 v[224:239], v[4:7], v[148:151], v[224:239]
    v_fma_f32 v160, v160, s84, -v240
    v_fma_f32 v161, v161, s84, -v240
    v_fma_f32 v162, v162, s84, -v240
    v_fma_f32 v163, v163, s84, -v240
    v_fma_f32 v164, v164, s84, -v240
    v_fma_f32 v165, v165, s84, -v240
    v_fma_f32 v166, v166, s84, -v240
    v_fma_f32 v167, v167, s84, -v240
    v_fma_f32 v168, v168, s84, -v240
    v_fma_f32 v169, v169, s84, -v240
    v_fma_f32 v170, v170, s84, -v240
    v_fma_f32 v171, v171, s84, -v240
    v_fma_f32 v172, v172, s84, -v240
    v_fma_f32 v173, v173, s84, -v240
    v_fma_f32 v174, v174, s84, -v240
    v_fma_f32 v175, v175, s84, -v240
    v_exp_f32 v160, v160
    v_exp_f32 v161, v161
    v_exp_f32 v162, v162
    v_exp_f32 v163, v163
    v_exp_f32 v164, v164
    v_exp_f32 v165, v165
    v_exp_f32 v166, v166
    v_exp_f32 v167, v167
    v_exp_f32 v168, v168
    v_exp_f32 v169, v169
    v_exp_f32 v170, v170
    v_exp_f32 v171, v171
    v_exp_f32 v172, v172
    v_exp_f32 v173, v173
    v_exp_f32 v174, v174
    v_exp_f32 v175, v175
    v_cvt_pk_bf16_f32 v160, v160, v161
    v_cvt_pk_bf16_f32 v161, v162, v163
    v_cvt_pk_bf16_f32 v162, v164, v165
    v_cvt_pk_bf16_f32 v163, v166, v167
    v_cvt_pk_bf16_f32 v164, v168, v169
    v_cvt_pk_bf16_f32 v165, v170, v171
    v_cvt_pk_bf16_f32 v166, v172, v173
    v_cvt_pk_bf16_f32 v167, v174, v175
    v_mfma_f32_32x32x16_bf16 v[208:223], a[48:51], v[160:163], v[208:223]
    v_mfma_f32_32x32x16_bf16 v[224:239], v[4:7], v[160:163], v[224:239]
    v_mfma_f32_32x32x16_bf16 v[208:223], a[52:55], v[164:167], v[208:223]
    v_mfma_f32_32x32x16_bf16 v[224:239], v[4:7], v[164:167], v[224:239]
    v_fma_f32 v176, v176, s84, -v240
    v_fma_f32 v177, v177, s84, -v240
    v_fma_f32 v178, v178, s84, -v240
    v_fma_f32 v179, v179, s84, -v240
    v_fma_f32 v180, v180, s84, -v240
    v_fma_f32 v181, v181, s84, -v240
    v_fma_f32 v182, v182, s84, -v240
    v_fma_f32 v183, v183, s84, -v240
    v_fma_f32 v184, v184, s84, -v240
    v_fma_f32 v185, v185, s84, -v240
    v_fma_f32 v186, v186, s84, -v240
    v_fma_f32 v187, v187, s84, -v240
    v_fma_f32 v188, v188, s84, -v240
    v_fma_f32 v189, v189, s84, -v240
    v_fma_f32 v190, v190, s84, -v240
    v_fma_f32 v191, v191, s84, -v240
    v_exp_f32 v176, v176
    v_exp_f32 v177, v177
    v_exp_f32 v178, v178
    v_exp_f32 v179, v179
    v_exp_f32 v180, v180
    v_exp_f32 v181, v181
    v_exp_f32 v182, v182
    v_exp_f32 v183, v183
    v_exp_f32 v184, v184
    v_exp_f32 v185, v185
    v_exp_f32 v186, v186
    v_exp_f32 v187, v187
    v_exp_f32 v188, v188
    v_exp_f32 v189, v189
    v_exp_f32 v190, v190
    v_exp_f32 v191, v191
    v_cvt_pk_bf16_f32 v176, v176, v177
    v_cvt_pk_bf16_f32 v177, v178, v179
    v_cvt_pk_bf16_f32 v178, v180, v181
    v_cvt_pk_bf16_f32 v179, v182, v183
    v_cvt_pk_bf16_f32 v180, v184, v185
    v_cvt_pk_bf16_f32 v181, v186, v187
    v_cvt_pk_bf16_f32 v182, v188, v189
    v_cvt_pk_bf16_f32 v183, v190, v191
    v_mfma_f32_32x32x16_bf16 v[208:223], a[56:59], v[176:179], v[208:223]
    v_mfma_f32_32x32x16_bf16 v[224:239], v[4:7], v[176:179], v[224:239]
    v_mfma_f32_32x32x16_bf16 v[208:223], a[60:63], v[180:183], v[208:223]
    v_mfma_f32_32x32x16_bf16 v[224:239], v[4:7], v[180:183], v[224:239]
    v_fma_f32 v192, v192, s84, -v240
    v_fma_f32 v193, v193, s84, -v240
    v_fma_f32 v194, v194, s84, -v240
    v_fma_f32 v195, v195, s84, -v240
    v_fma_f32 v196, v196, s84, -v240
    v_fma_f32 v197, v197, s84, -v240
    v_fma_f32 v198, v198, s84, -v240
    v_fma_f32 v199, v199, s84, -v240
    v_fma_f32 v200, v200, s84, -v240
    v_fma_f32 v201, v201, s84, -v240
    v_fma_f32 v202, v202, s84, -v240
    v_fma_f32 v203, v203, s84, -v240
    v_fma_f32 v204, v204, s84, -v240
    v_fma_f32 v205, v205, s84, -v240
    v_fma_f32 v206, v206, s84, -v240
    v_fma_f32 v207, v207, s84, -v240
    v_exp_f32 v192, v192
    v_exp_f32 v193, v193
    v_exp_f32 v194, v194
    v_exp_f32 v195, v195
    v_exp_f32 v196, v196
    v_exp_f32 v197, v197
    v_exp_f32 v198, v198
    v_exp_f32 v199, v199
    v_exp_f32 v200, v200
    v_exp_f32 v201, v201
    v_exp_f32 v202, v202
    v_exp_f32 v203, v203
    v_exp_f32 v204, v204
    v_exp_f32 v205, v205
    v_exp_f32 v206, v206
    v_exp_f32 v207, v207
    v_cvt_pk_bf16_f32 v192, v192, v193
    v_cvt_pk_bf16_f32 v193, v194, v195
    v_cvt_pk_bf16_f32 v194, v196, v197
    v_cvt_pk_bf16_f32 v195, v198, v199
    v_cvt_pk_bf16_f32 v196, v200, v201
    v_cvt_pk_bf16_f32 v197, v202, v203
    v_cvt_pk_bf16_f32 v198, v204, v205
    v_cvt_pk_bf16_f32 v199, v206, v207
    v_mfma_f32_32x32x16_bf16 v[208:223], a[64:67], v[192:195], v[208:223]
    v_mfma_f32_32x32x16_bf16 v[224:239], v[4:7], v[192:195], v[224:239]
    v_mfma_f32_32x32x16_bf16 v[208:223], a[68:71], v[196:199], v[208:223]
    v_mfma_f32_32x32x16_bf16 v[224:239], v[4:7], v[196:199], v[224:239]
    s_nop 11
    v_rcp_f32 v240, v224
    s_nop 0
    v_mul_f32 v216, v216, v240
    v_mul_f32 v217, v217, v240
    v_mul_f32 v218, v218, v240
    v_mul_f32 v219, v219, v240
    v_mul_f32 v220, v220, v240
    v_mul_f32 v221, v221, v240
    v_mul_f32 v222, v222, v240
    v_mul_f32 v223, v223, v240
    v_cvt_pk_bf16_f32 v244, v216, v217
    v_cvt_pk_bf16_f32 v245, v218, v219
    v_cvt_pk_bf16_f32 v246, v220, v221
    v_cvt_pk_bf16_f32 v247, v222, v223
    global_store_dwordx4 v2, v[244:247], s[92:93] offset:512 sc1
    s_waitcnt vmcnt(0)
    s_lshl_b32 s76, s7, 7
    s_add_u32 s76, s76, 84508672
    v_mov_b32 v8, s76
    v_mov_b32 v9, 1
    s_mov_b64 exec, 1
    global_atomic_add v8, v9, s[42:43]
    s_mov_b64 exec, -1
    s_add_u32 s9, s9, 448
    s_cmp_lt_u32 s9, 1024
    s_cbranch_scc1 L_aa_loop
    s_cmp_lt_u32 s8, 24
    s_cbranch_scc1 L_xattn
    s_endpgm
L_xattn:
    s_sub_u32 s6, s8, 16
    s_lshl_b32 s6, s6, 2
    s_add_u32 s6, s6, s3
    s_mov_b32 s7, s12
    v_min_u32 v252, 46, v0
    v_lshlrev_b32 v252, 21, v252
    v_add_u32 v252, 0x1fff00, v252
    global_load_dword v253, v252, s[42:43] sc1
    v_lshlrev_b32 v1, 4, v0
    v_and_b32 v2, 15, v0
    v_lshrrev_b32 v3, 4, v0
    v_lshlrev_b32 v3, 2, v3
    v_sub_u32 v2, v2, v3
    v_cmp_gt_i32 s[44:45], 0, v2
    v_cmp_gt_i32 s[46:47], 1, v2
    v_cmp_gt_i32 s[48:49], 2, v2
    v_cmp_gt_i32 s[50:51], 3, v2
    v_cmp_le_u32 s[52:53], 32, v0
    s_mov_b32 s84, 0x3e0293ee
    v_mov_b32 v3, 0xf149f2ca
    v_mov_b32 v4, 0x3f803f80
    v_mov_b32 v5, 0x3f803f80
    v_mov_b32 v6, 0x3f803f80
    v_mov_b32 v7, 0x3f803f80
    v_cndmask_b32 v8, 0, v3, s[52:53]
    v_cndmask_b32 v9, 0, v3, s[52:53]
    v_cndmask_b32 v10, 0, v3, s[52:53]
    v_cndmask_b32 v11, 0, v3, s[52:53]
    s_lshl_b32 s96, s3, 12
    v_and_b32 v12, 1, v0
    v_lshlrev_b32 v12, 8, v12
    v_lshrrev_b32 v13, 2, v0
    v_lshl_add_u32 v12, v13, 4, v12
    v_add_u32 v12, s96, v12
    v_and_b32 v13, 31, v0
    v_lshlrev_b32 v13, 4, v13
    v_add_u32 v13, 8, v13
    v_add_u32 v13, s96, v13
    v_add_u32 v14, 4096, v1
L_xa_loop:
    s_lshl_b32 s76, s7, 7
    s_add_u32 s76, s76, 84475904
    v_mov_b32 v252, s76
Lwf_152:
    global_load_dword v253, v252, s[42:43] sc1
    s_add_u32 s10, s10, 1
    s_cmp_gt_u32 s10, 0x80000
    s_cbranch_scc1 Lwf_153
    s_waitcnt vmcnt(0)
    v_readfirstlane_b32 s76, v253
    s_nop 0
    s_and_b32 s76, s76, 65535
    s_cmp_eq_u32 s76, 32
    s_cbranch_scc1 Lwf_153
    s_sleep 4
    s_branch Lwf_152
Lwf_153:
    s_lshl_b32 s76, s7, 7
    s_add_u32 s76, s76, 84484096
    v_mov_b32 v252, s76
Lwf_154:
    global_load_dword v253, v252, s[42:43] sc1
    s_add_u32 s10, s10, 1
    s_cmp_gt_u32 s10, 0x80000
    s_cbranch_scc1 Lwf_155
    s_waitcnt vmcnt(0)
    v_readfirstlane_b32 s76, v253
    s_nop 0
    s_and_b32 s76, s76, 65535
    s_cmp_eq_u32 s76, 16
    s_cbranch_scc1 Lwf_155
    s_sleep 4
    s_branch Lwf_154
Lwf_155:
    s_lshl_b32 s76, s6, 6
    s_add_u32 s76, s76, s7
    s_lshl_b32 s77, s76, 13
    s_add_u32 s86, s42, s77
    s_addc_u32 s87, s43, 0
    s_add_u32 s86, s86, 33554432
    s_addc_u32 s87, s87, 0
    s_add_u32 s88, s42, s77
    s_addc_u32 s89, s43, 0
    s_add_u32 s90, s42, s77
    s_addc_u32 s91, s43, 0
    s_add_u32 s90, s90, 16777216
    s_addc_u32 s91, s91, 0
    s_add_u32 s77, s76, s6
    s_lshl_b32 s77, s77, 12
    s_add_u32 s94, s42, s77
    s_addc_u32 s95, s43, 0
    s_add_u32 s94, s94, 88215552
    s_addc_u32 s95, s95, 0
    global_load_dwordx4 v[16:19], v1, s[86:87] offset:0 sc1
    global_load_dwordx4 v[20:23], v1, s[86:87] offset:1024 sc1
    global_load_dwordx4 v[24:27], v1, s[86:87] offset:2048 sc1
    global_load_dwordx4 v[28:31], v1, s[86:87] offset:3072 sc1
    global_load_dwordx4 v[32:35], v14, s[86:87] offset:0 sc1
    global_load_dwordx4 v[36:39], v14, s[86:87] offset:1024 sc1
    global_load_dwordx4 v[40:43], v14, s[86:87] offset:2048 sc1
    global_load_dwordx4 v[44:47], v14, s[86:87] offset:3072 sc1
    global_load_dwordx4 v[48:51], v1, s[88:89] offset:0 sc1
    global_load_dwordx4 v[52:55], v1, s[88:89] offset:1024 sc1
    global_load_dwordx4 v[56:59], v1, s[88:89] offset:2048 sc1
    global_load_dwordx4 v[60:63], v1, s[88:89] offset:3072 sc1
    global_load_dwordx4 v[64:67], v14, s[88:89] offset:0 sc1
    global_load_dwordx4 v[68:71], v14, s[88:89] offset:1024 sc1
    global_load_dwordx4 v[72:75], v14, s[88:89] offset:2048 sc1
    global_load_dwordx4 v[76:79], v14, s[88:89] offset:3072 sc1
    global_load_dwordx4 v[80:83], v1, s[90:91] offset:0 sc1
    global_load_dwordx4 v[84:87], v1, s[90:91] offset:1024 sc1
    global_load_dwordx4 v[88:91], v1, s[90:91] offset:2048 sc1
    global_load_dwordx4 v[92:95], v1, s[90:91] offset:3072 sc1
    global_load_dwordx4 v[96:99], v14, s[90:91] offset:0 sc1
    global_load_dwordx4 v[100:103], v14, s[90:91] offset:1024 sc1
    global_load_dwordx4 v[104:107], v14, s[90:91] offset:2048 sc1
    global_load_dwordx4 v[108:111], v14, s[90:91] offset:3072 sc1
    s_lshl_b32 s76, s7, 18
    s_lshl_b32 s77, s6, 12
    s_add_u32 s76, s76, s77
    s_add_u32 s92, s42, s76
    s_addc_u32 s93, s43, 0
    s_add_u32 s92, s92, 50331648
    s_addc_u32 s93, s93, 0
    s_waitcnt vmcnt(0)
    v_mfma_f32_16x16x32_bf16 v[144:147], v[48:51], v[16:19], 0
    v_mfma_f32_16x16x32_bf16 v[152:155], v[48:51], v[32:35], 0
    v_mfma_f32_16x16x32_bf16 v[156:159], v[64:67], v[32:35], 0
    v_mfma_f32_16x16x32_bf16 v[144:147], v[52:55], v[20:23], v[144:147]
    v_mfma_f32_16x16x32_bf16 v[152:155], v[52:55], v[36:39], v[152:155]
    v_mfma_f32_16x16x32_bf16 v[156:159], v[68:71], v[36:39], v[156:159]
    v_mfma_f32_16x16x32_bf16 v[144:147], v[56:59], v[24:27], v[144:147]
    v_mfma_f32_16x16x32_bf16 v[152:155], v[56:59], v[40:43], v[152:155]
    v_mfma_f32_16x16x32_bf16 v[156:159], v[72:75], v[40:43], v[156:159]
    v_mfma_f32_16x16x32_bf16 v[144:147], v[60:63], v[28:31], v[144:147]
    v_mfma_f32_16x16x32_bf16 v[152:155], v[60:63], v[44:47], v[152:155]
    v_mfma_f32_16x16x32_bf16 v[156:159], v[76:79], v[44:47], v[156:159]
    v_cndmask_b32 v144, v144, v3, s[44:45]
    v_cndmask_b32 v145, v145, v3, s[46:47]
    v_cndmask_b32 v146, v146, v3, s[48:49]
    v_cndmask_b32 v147, v147, v3, s[50:51]
    s_nop 3
    v_cndmask_b32 v156, v156, v3, s[44:45]
    v_cndmask_b32 v157, v157, v3, s[46:47]
    v_cndmask_b32 v158, v158, v3, s[48:49]
    v_cndmask_b32 v159, v159, v3, s[50:51]
    v_max3_f32 v164, v144, v145, v146
    v_max_f32 v164, v164, v147
    v_max3_f32 v165, v152, v153, v154
    v_max3_f32 v165, v165, v155, v156
    v_max3_f32 v165, v165, v157, v158
    v_max_f32 v165, v165, v159
    v_mov_b32 v170, 0
    v_mov_b32 v171, 0
    s_lshl_b32 s76, s7, 5
    s_add_u32 s76, s76, s6
    s_lshl_b32 s76, s76, 7
    s_add_u32 s76, s76, 84525056
    v_lshlrev_b32 v252, 2, v0
    v_add_u32 v252, s76, v252
    s_mov_b64 exec, 15
Lwm_156:
    global_load_dword v253, v252, s[42:43] sc1
    s_add_u32 s10, s10, 1
    s_cmp_gt_u32 s10, 0x80000
    s_cbranch_scc1 Lwm_157
    s_waitcnt vmcnt(0)
    v_cmp_eq_u32 vcc, 0, v253
    s_cbranch_vccz Lwm_157
    s_sleep 2
    s_branch Lwm_156
Lwm_157:
    s_mov_b64 exec, -1
    s_mov_b32 m0, s96
    s_nop 0
    global_load_lds_dwordx4 v1, s[94:95] offset:0 sc1
    global_load_lds_dwordx4 v1, s[94:95] offset:1024 sc1
    global_load_lds_dwordx4 v1, s[94:95] offset:2048 sc1
    global_load_lds_dwordx4 v1, s[94:95] offset:3072 sc1
    s_waitcnt vmcnt(0)
    ds_read_b64_tr_b16 v[112:113], v12 offset:0
    ds_read_b64_tr_b16 v[114:115], v12 offset:512
    ds_read_b64_tr_b16 v[116:117], v12 offset:1024
    ds_read_b64_tr_b16 v[118:119], v12 offset:1536
    ds_read_b64_tr_b16 v[120:121], v12 offset:2048
    ds_read_b64_tr_b16 v[122:123], v12 offset:2560
    ds_read_b64_tr_b16 v[124:125], v12 offset:3072
    ds_read_b64_tr_b16 v[126:127], v12 offset:3584
    ds_read_b64 v[128:129], v13 offset:0
    ds_read_b64 v[130:131], v13 offset:512
    ds_read_b64 v[132:133], v13 offset:1024
    ds_read_b64 v[134:135], v13 offset:1536
    ds_read_b64 v[136:137], v13 offset:2048
    ds_read_b64 v[138:139], v13 offset:2560
    ds_read_b64 v[140:141], v13 offset:3072
    ds_read_b64 v[142:143], v13 offset:3584
    s_waitcnt lgkmcnt(0)
    v_mfma_f32_16x16x32_bf16 v[148:151], v[112:115], v[16:19], v[8:11]
    v_mfma_f32_16x16x32_bf16 v[160:163], v[112:115], v[32:35], v[8:11]
    v_mfma_f32_16x16x32_bf16 v[148:151], v[116:119], v[20:23], v[148:151]
    v_mfma_f32_16x16x32_bf16 v[160:163], v[116:119], v[36:39], v[160:163]
    v_mfma_f32_16x16x32_bf16 v[148:151], v[120:123], v[24:27], v[148:151]
    v_mfma_f32_16x16x32_bf16 v[160:163], v[120:123], v[40:43], v[160:163]
    v_mfma_f32_16x16x32_bf16 v[148:151], v[124:127], v[28:31], v[148:151]
    v_mfma_f32_16x16x32_bf16 v[160:163], v[124:127], v[44:47], v[160:163]
    s_nop 3
    v_max3_f32 v164, v164, v148, v149
    v_max3_f32 v164, v164, v150, v151
    s_nop 1
    v_max3_f32 v165, v165, v160, v161
    v_max3_f32 v165, v165, v162, v163
    v_mov_b32 v166, v164
    v_mov_b32 v167, v165
    s_nop 0
    v_permlane32_swap_b32 v164, v166
    v_permlane32_swap_b32 v165, v167
    v_max_f32 v164, v164, v166
    v_max_f32 v165, v165, v167
    v_mov_b32 v166, v164
    v_mov_b32 v167, v165
    s_nop 0
    v_permlane16_swap_b32 v164, v166
    v_permlane16_swap_b32 v165, v167
    v_max_f32 v164, v164, v166
    v_max_f32 v165, v165, v167
    v_mul_f32 v164, s84, v164
    v_mul_f32 v165, s84, v165
    v_fma_f32 v144, v144, s84, -v164
    v_fma_f32 v145, v145, s84, -v164
    v_fma_f32 v146, v146, s84, -v164
    v_fma_f32 v147, v147, s84, -v164
    v_fma_f32 v148, v148, s84, -v164
    v_fma_f32 v149, v149, s84, -v164
    v_fma_f32 v150, v150, s84, -v164
    v_fma_f32 v151, v151, s84, -v164
    v_exp_f32 v144, v144
    v_exp_f32 v145, v145
    v_exp_f32 v146, v146
    v_exp_f32 v147, v147
    v_exp_f32 v148, v148
    v_exp_f32 v149, v149
    v_exp_f32 v150, v150
    v_exp_f32 v151, v151
    v_cvt_pk_bf16_f32 v168, v144, v145
    v_cvt_pk_bf16_f32 v169, v146, v147
    v_cvt_pk_bf16_f32 v172, v148, v149
    v_cvt_pk_bf16_f32 v173, v150, v151
    v_mfma_f32_16x16x32_bf16 v[248:251], v[4:7], v[168:171], 0
    v_mfma_f32_16x16x32_bf16 v[184:187], v[80:83], v[168:171], 0
    v_mfma_f32_16x16x32_bf16 v[188:191], v[84:87], v[168:171], 0
    v_mfma_f32_16x16x32_bf16 v[192:195], v[88:91], v[168:171], 0
    v_mfma_f32_16x16x32_bf16 v[196:199], v[92:95], v[168:171], 0
    v_mfma_f32_16x16x32_bf16 v[200:203], v[96:99], v[168:171], 0
    v_mfma_f32_16x16x32_bf16 v[204:207], v[100:103], v[168:171], 0
    v_mfma_f32_16x16x32_bf16 v[208:211], v[104:107], v[168:171], 0
    v_mfma_f32_16x16x32_bf16 v[212:215], v[108:111], v[168:171], 0
    v_mfma_f32_16x16x16_bf16 v[248:251], v[4:5], v[172:173], v[248:251]
    v_mfma_f32_16x16x16_bf16 v[184:187], v[128:129], v[172:173], v[184:187]
    v_mfma_f32_16x16x16_bf16 v[188:191], v[130:131], v[172:173], v[188:191]
    v_mfma_f32_16x16x16_bf16 v[192:195], v[132:133], v[172:173], v[192:195]
    v_mfma_f32_16x16x16_bf16 v[196:199], v[134:135], v[172:173], v[196:199]
    v_mfma_f32_16x16x16_bf16 v[200:203], v[136:137], v[172:173], v[200:203]
    v_mfma_f32_16x16x16_bf16 v[204:207], v[138:139], v[172:173], v[204:207]
    v_mfma_f32_16x16x16_bf16 v[208:211], v[140:141], v[172:173], v[208:211]
    v_mfma_f32_16x16x16_bf16 v[212:215], v[142:143], v[172:173], v[212:215]
    v_fma_f32 v152, v152, s84, -v165
    v_fma_f32 v153, v153, s84, -v165
    v_fma_f32 v154, v154, s84, -v165
    v_fma_f32 v155, v155, s84, -v165
    v_fma_f32 v156, v156, s84, -v165
    v_fma_f32 v157, v157, s84, -v165
    v_fma_f32 v158, v158, s84, -v165
    v_fma_f32 v159, v159, s84, -v165
    v_fma_f32 v160, v160, s84, -v165
    v_fma_f32 v161, v161, s84, -v165
    v_fma_f32 v162, v162, s84, -v165
    v_fma_f32 v163, v163, s84, -v165
    v_exp_f32 v152, v152
    v_exp_f32 v153, v153
    v_exp_f32 v154, v154
    v_exp_f32 v155, v155
    v_exp_f32 v156, v156
    v_exp_f32 v157, v157
    v_exp_f32 v158, v158
    v_exp_f32 v159, v159
    v_exp_f32 v160, v160
    v_exp_f32 v161, v161
    v_exp_f32 v162, v162
    v_exp_f32 v163, v163
    v_cvt_pk_bf16_f32 v176, v152, v153
    v_cvt_pk_bf16_f32 v177, v154, v155
    v_cvt_pk_bf16_f32 v178, v156, v157
    v_cvt_pk_bf16_f32 v179, v158, v159
    v_cvt_pk_bf16_f32 v180, v160, v161
    v_cvt_pk_bf16_f32 v181, v162, v163
    v_mfma_f32_16x16x32_bf16 v[244:247], v[4:7], v[176:179], 0
    v_mfma_f32_16x16x32_bf16 v[48:51], v[80:83], v[176:179], 0
    v_mfma_f32_16x16x32_bf16 v[52:55], v[84:87], v[176:179], 0
    v_mfma_f32_16x16x32_bf16 v[56:59], v[88:91], v[176:179], 0
    v_mfma_f32_16x16x32_bf16 v[60:63], v[92:95], v[176:179], 0
    v_mfma_f32_16x16x32_bf16 v[64:67], v[96:99], v[176:179], 0
    v_mfma_f32_16x16x32_bf16 v[68:71], v[100:103], v[176:179], 0
    v_mfma_f32_16x16x32_bf16 v[72:75], v[104:107], v[176:179], 0
    v_mfma_f32_16x16x32_bf16 v[76:79], v[108:111], v[176:179], 0
    v_mfma_f32_16x16x16_bf16 v[244:247], v[4:5], v[180:181], v[244:247]
    v_mfma_f32_16x16x16_bf16 v[48:51], v[128:129], v[180:181], v[48:51]
    v_mfma_f32_16x16x16_bf16 v[52:55], v[130:131], v[180:181], v[52:55]
    v_mfma_f32_16x16x16_bf16 v[56:59], v[132:133], v[180:181], v[56:59]
    v_mfma_f32_16x16x16_bf16 v[60:63], v[134:135], v[180:181], v[60:63]
    v_mfma_f32_16x16x16_bf16 v[64:67], v[136:137], v[180:181], v[64:67]
    v_mfma_f32_16x16x16_bf16 v[68:71], v[138:139], v[180:181], v[68:71]
    v_mfma_f32_16x16x16_bf16 v[72:75], v[140:141], v[180:181], v[72:75]
    v_mfma_f32_16x16x16_bf16 v[76:79], v[142:143], v[180:181], v[76:79]
    v_rcp_f32 v166, v248
    s_nop 0
    v_pk_mul_f32 v[184:185], v[184:185], v[166:167] op_sel_hi:[1,0]
    v_pk_mul_f32 v[186:187], v[186:187], v[166:167] op_sel_hi:[1,0]
    v_pk_mul_f32 v[188:189], v[188:189], v[166:167] op_sel_hi:[1,0]
    v_pk_mul_f32 v[190:191], v[190:191], v[166:167] op_sel_hi:[1,0]
    v_cvt_pk_bf16_f32 v216, v184, v185
    v_cvt_pk_bf16_f32 v217, v186, v187
    v_cvt_pk_bf16_f32 v218, v188, v189
    v_cvt_pk_bf16_f32 v219, v190, v191
    global_store_dwordx4 v1, v[216:219], s[92:93] offset:0 sc1
    v_pk_mul_f32 v[192:193], v[192:193], v[166:167] op_sel_hi:[1,0]
    v_pk_mul_f32 v[194:195], v[194:195], v[166:167] op_sel_hi:[1,0]
    v_pk_mul_f32 v[196:197], v[196:197], v[166:167] op_sel_hi:[1,0]
    v_pk_mul_f32 v[198:199], v[198:199], v[166:167] op_sel_hi:[1,0]
    v_cvt_pk_bf16_f32 v220, v192, v193
    v_cvt_pk_bf16_f32 v221, v194, v195
    v_cvt_pk_bf16_f32 v222, v196, v197
    v_cvt_pk_bf16_f32 v223, v198, v199
    global_store_dwordx4 v1, v[220:223], s[92:93] offset:1024 sc1
    v_pk_mul_f32 v[200:201], v[200:201], v[166:167] op_sel_hi:[1,0]
    v_pk_mul_f32 v[202:203], v[202:203], v[166:167] op_sel_hi:[1,0]
    v_pk_mul_f32 v[204:205], v[204:205], v[166:167] op_sel_hi:[1,0]
    v_pk_mul_f32 v[206:207], v[206:207], v[166:167] op_sel_hi:[1,0]
    v_cvt_pk_bf16_f32 v224, v200, v201
    v_cvt_pk_bf16_f32 v225, v202, v203
    v_cvt_pk_bf16_f32 v226, v204, v205
    v_cvt_pk_bf16_f32 v227, v206, v207
    global_store_dwordx4 v1, v[224:227], s[92:93] offset:2048 sc1
    v_pk_mul_f32 v[208:209], v[208:209], v[166:167] op_sel_hi:[1,0]
    v_pk_mul_f32 v[210:211], v[210:211], v[166:167] op_sel_hi:[1,0]
    v_pk_mul_f32 v[212:213], v[212:213], v[166:167] op_sel_hi:[1,0]
    v_pk_mul_f32 v[214:215], v[214:215], v[166:167] op_sel_hi:[1,0]
    v_cvt_pk_bf16_f32 v228, v208, v209
    v_cvt_pk_bf16_f32 v229, v210, v211
    v_cvt_pk_bf16_f32 v230, v212, v213
    v_cvt_pk_bf16_f32 v231, v214, v215
    global_store_dwordx4 v1, v[228:231], s[92:93] offset:3072 sc1
    s_nop 0
    s_add_u32 s92, s92, 131072
    s_addc_u32 s93, s93, 0
    v_rcp_f32 v166, v244
    s_nop 0
    v_pk_mul_f32 v[48:49], v[48:49], v[166:167] op_sel_hi:[1,0]
    v_pk_mul_f32 v[50:51], v[50:51], v[166:167] op_sel_hi:[1,0]
    v_pk_mul_f32 v[52:53], v[52:53], v[166:167] op_sel_hi:[1,0]
    v_pk_mul_f32 v[54:55], v[54:55], v[166:167] op_sel_hi:[1,0]
    v_cvt_pk_bf16_f32 v16, v48, v49
    v_cvt_pk_bf16_f32 v17, v50, v51
    v_cvt_pk_bf16_f32 v18, v52, v53
    v_cvt_pk_bf16_f32 v19, v54, v55
    global_store_dwordx4 v1, v[16:19], s[92:93] offset:0 sc1
    v_pk_mul_f32 v[56:57], v[56:57], v[166:167] op_sel_hi:[1,0]
    v_pk_mul_f32 v[58:59], v[58:59], v[166:167] op_sel_hi:[1,0]
    v_pk_mul_f32 v[60:61], v[60:61], v[166:167] op_sel_hi:[1,0]
    v_pk_mul_f32 v[62:63], v[62:63], v[166:167] op_sel_hi:[1,0]
    v_cvt_pk_bf16_f32 v20, v56, v57
    v_cvt_pk_bf16_f32 v21, v58, v59
    v_cvt_pk_bf16_f32 v22, v60, v61
    v_cvt_pk_bf16_f32 v23, v62, v63
    global_store_dwordx4 v1, v[20:23], s[92:93] offset:1024 sc1
    v_pk_mul_f32 v[64:65], v[64:65], v[166:167] op_sel_hi:[1,0]
    v_pk_mul_f32 v[66:67], v[66:67], v[166:167] op_sel_hi:[1,0]
    v_pk_mul_f32 v[68:69], v[68:69], v[166:167] op_sel_hi:[1,0]
    v_pk_mul_f32 v[70:71], v[70:71], v[166:167] op_sel_hi:[1,0]
    v_cvt_pk_bf16_f32 v24, v64, v65
    v_cvt_pk_bf16_f32 v25, v66, v67
    v_cvt_pk_bf16_f32 v26, v68, v69
    v_cvt_pk_bf16_f32 v27, v70, v71
    global_store_dwordx4 v1, v[24:27], s[92:93] offset:2048 sc1
    v_pk_mul_f32 v[72:73], v[72:73], v[166:167] op_sel_hi:[1,0]
    v_pk_mul_f32 v[74:75], v[74:75], v[166:167] op_sel_hi:[1,0]
    v_pk_mul_f32 v[76:77], v[76:77], v[166:167] op_sel_hi:[1,0]
    v_pk_mul_f32 v[78:79], v[78:79], v[166:167] op_sel_hi:[1,0]
    v_cvt_pk_bf16_f32 v28, v72, v73
    v_cvt_pk_bf16_f32 v29, v74, v75
    v_cvt_pk_bf16_f32 v30, v76, v77
    v_cvt_pk_bf16_f32 v31, v78, v79
    global_store_dwordx4 v1, v[28:31], s[92:93] offset:3072 sc1
    s_waitcnt vmcnt(0)
    s_lshl_b32 s76, s7, 5
    s_add_u32 s76, s76, s6
    s_lshl_b32 s76, s76, 2
    s_add_u32 s76, s76, 84500480
    v_mov_b32 v252, s76
    v_mov_b32 v253, 1
    s_mov_b64 exec, 1
    global_store_dword v252, v253, s[42:43] sc1
    s_mov_b64 exec, -1
    s_add_u32 s7, s7, 7
    s_cmp_lt_u32 s7, 64
    s_cbranch_scc1 L_xa_loop
    s_endpgm
L_stage2:
    s_barrier
    s_mov_b32 s6, s8
    s_mov_b32 s7, s12
    v_min_u32 v250, 46, v0
    v_lshlrev_b32 v250, 21, v250
    v_add_u32 v250, 0x1fff00, v250
    global_load_dword v251, v250, s[42:43] sc1
    v_lshlrev_b32 v3, 4, v0
    v_lshrrev_b32 v1, 2, v0
    v_and_b32 v2, 3, v0
    v_lshlrev_b32 v2, 4, v2
    v_lshl_add_u32 v4, v1, 10, v2
    s_lshl_b32 s52, s3, 15
    v_lshrrev_b32 v1, 2, v0
    v_lshlrev_b32 v5, 6, v1
    v_add_u32 v5, v5, v2
    v_add_u32 v5, s52, v5
    v_lshrrev_b32 v1, 5, v0
    v_lshl_add_u32 v6, v1, 9, v5
    s_lshl_b32 s44, s3, 20
    s_lshl_b32 s45, s6, 6
    s_add_u32 s44, s44, s45
    s_add_u32 s54, s32, s44
    s_addc_u32 s55, s33, 0
    s_add_u32 m0, s52, 0
    s_nop 0
    global_load_lds_dwordx4 v4, s[54:55]
    s_add_u32 s54, s54, 16384
    s_addc_u32 s55, s55, 0
    s_add_u32 m0, s52, 1024
    s_nop 0
    global_load_lds_dwordx4 v4, s[54:55]
    s_add_u32 s54, s54, 16384
    s_addc_u32 s55, s55, 0
    s_add_u32 m0, s52, 2048
    s_nop 0
    global_load_lds_dwordx4 v4, s[54:55]
    s_add_u32 s54, s54, 16384
    s_addc_u32 s55, s55, 0
    s_add_u32 m0, s52, 3072
    s_nop 0
    global_load_lds_dwordx4 v4, s[54:55]
    s_add_u32 s54, s54, 16384
    s_addc_u32 s55, s55, 0
    s_add_u32 m0, s52, 4096
    s_nop 0
    global_load_lds_dwordx4 v4, s[54:55]
    s_add_u32 s54, s54, 16384
    s_addc_u32 s55, s55, 0
    s_add_u32 m0, s52, 5120
    s_nop 0
    global_load_lds_dwordx4 v4, s[54:55]
    s_add_u32 s54, s54, 16384
    s_addc_u32 s55, s55, 0
    s_add_u32 m0, s52, 6144
    s_nop 0
    global_load_lds_dwordx4 v4, s[54:55]
    s_add_u32 s54, s54, 16384
    s_addc_u32 s55, s55, 0
    s_add_u32 m0, s52, 7168
    s_nop 0
    global_load_lds_dwordx4 v4, s[54:55]
    s_add_u32 s54, s54, 16384
    s_addc_u32 s55, s55, 0
    s_add_u32 m0, s52, 8192
    s_nop 0
    global_load_lds_dwordx4 v4, s[54:55]
    s_add_u32 s54, s54, 16384
    s_addc_u32 s55, s55, 0
    s_add_u32 m0, s52, 9216
    s_nop 0
    global_load_lds_dwordx4 v4, s[54:55]
    s_add_u32 s54, s54, 16384
    s_addc_u32 s55, s55, 0
    s_add_u32 m0, s52, 10240
    s_nop 0
    global_load_lds_dwordx4 v4, s[54:55]
    s_add_u32 s54, s54, 16384
    s_addc_u32 s55, s55, 0
    s_add_u32 m0, s52, 11264
    s_nop 0
    global_load_lds_dwordx4 v4, s[54:55]
    s_add_u32 s54, s54, 16384
    s_addc_u32 s55, s55, 0
    s_add_u32 m0, s52, 12288
    s_nop 0
    global_load_lds_dwordx4 v4, s[54:55]
    s_add_u32 s54, s54, 16384
    s_addc_u32 s55, s55, 0
    s_add_u32 m0, s52, 13312
    s_nop 0
    global_load_lds_dwordx4 v4, s[54:55]
    s_add_u32 s54, s54, 16384
    s_addc_u32 s55, s55, 0
    s_add_u32 m0, s52, 14336
    s_nop 0
    global_load_lds_dwordx4 v4, s[54:55]
    s_add_u32 s54, s54, 16384
    s_addc_u32 s55, s55, 0
    s_add_u32 m0, s52, 15360
    s_nop 0
    global_load_lds_dwordx4 v4, s[54:55]
    s_add_u32 s54, s54, 16384
    s_addc_u32 s55, s55, 0
    s_add_u32 m0, s52, 16384
    s_nop 0
    global_load_lds_dwordx4 v4, s[54:55]
    s_add_u32 s54, s54, 16384
    s_addc_u32 s55, s55, 0
    s_add_u32 m0, s52, 17408
    s_nop 0
    global_load_lds_dwordx4 v4, s[54:55]
    s_add_u32 s54, s54, 16384
    s_addc_u32 s55, s55, 0
    s_add_u32 m0, s52, 18432
    s_nop 0
    global_load_lds_dwordx4 v4, s[54:55]
    s_add_u32 s54, s54, 16384
    s_addc_u32 s55, s55, 0
    s_add_u32 m0, s52, 19456
    s_nop 0
    global_load_lds_dwordx4 v4, s[54:55]
    s_add_u32 s54, s54, 16384
    s_addc_u32 s55, s55, 0
    s_add_u32 m0, s52, 20480
    s_nop 0
    global_load_lds_dwordx4 v4, s[54:55]
    s_add_u32 s54, s54, 16384
    s_addc_u32 s55, s55, 0
    s_add_u32 m0, s52, 21504
    s_nop 0
    global_load_lds_dwordx4 v4, s[54:55]
    s_add_u32 s54, s54, 16384
    s_addc_u32 s55, s55, 0
    s_add_u32 m0, s52, 22528
    s_nop 0
    global_load_lds_dwordx4 v4, s[54:55]
    s_add_u32 s54, s54, 16384
    s_addc_u32 s55, s55, 0
    s_add_u32 m0, s52, 23552
    s_nop 0
    global_load_lds_dwordx4 v4, s[54:55]
    s_add_u32 s54, s54, 16384
    s_addc_u32 s55, s55, 0
    s_add_u32 m0, s52, 24576
    s_nop 0
    global_load_lds_dwordx4 v4, s[54:55]
    s_add_u32 s54, s54, 16384
    s_addc_u32 s55, s55, 0
    s_add_u32 m0, s52, 25600
    s_nop 0
    global_load_lds_dwordx4 v4, s[54:55]
    s_add_u32 s54, s54, 16384
    s_addc_u32 s55, s55, 0
    s_add_u32 m0, s52, 26624
    s_nop 0
    global_load_lds_dwordx4 v4, s[54:55]
    s_add_u32 s54, s54, 16384
    s_addc_u32 s55, s55, 0
    s_add_u32 m0, s52, 27648
    s_nop 0
    global_load_lds_dwordx4 v4, s[54:55]
    s_add_u32 s54, s54, 16384
    s_addc_u32 s55, s55, 0
    s_add_u32 m0, s52, 28672
    s_nop 0
    global_load_lds_dwordx4 v4, s[54:55]
    s_add_u32 s54, s54, 16384
    s_addc_u32 s55, s55, 0
    s_add_u32 m0, s52, 29696
    s_nop 0
    global_load_lds_dwordx4 v4, s[54:55]
    s_add_u32 s54, s54, 16384
    s_addc_u32 s55, s55, 0
    s_add_u32 m0, s52, 30720
    s_nop 0
    global_load_lds_dwordx4 v4, s[54:55]
    s_add_u32 s54, s54, 16384
    s_addc_u32 s55, s55, 0
    s_add_u32 m0, s52, 31744
    s_nop 0
    global_load_lds_dwordx4 v4, s[54:55]
    s_add_u32 s54, s54, 16384
    s_addc_u32 s55, s55, 0
    v_lshrrev_b32 v1, 4, v0
    v_lshlrev_b32 v1, 4, v1
    s_lshl_b32 s44, s3, 8
    v_add_u32 v1, s44, v1
    v_and_b32 v2, 15, v0
    v_lshl_add_u32 v7, v2, 10, v1
    s_waitcnt vmcnt(28)
    ds_read_b64_tr_b16 a[0:1], v5 offset:0
    ds_read_b64_tr_b16 a[2:3], v5 offset:1024
    ds_read_b64_tr_b16 a[4:5], v5 offset:8
    ds_read_b64_tr_b16 a[6:7], v5 offset:1032
    ds_read_b64_tr_b16 a[8:9], v5 offset:2048
    ds_read_b64_tr_b16 a[10:11], v5 offset:3072
    ds_read_b64_tr_b16 a[12:13], v5 offset:2056
    ds_read_b64_tr_b16 a[14:15], v5 offset:3080
    s_waitcnt lgkmcnt(0)
    s_add_u32 m0, s52, 0
    s_nop 0
    global_load_lds_dwordx4 v4, s[54:55]
    s_add_u32 s54, s54, 16384
    s_addc_u32 s55, s55, 0
    s_add_u32 m0, s52, 1024
    s_nop 0
    global_load_lds_dwordx4 v4, s[54:55]
    s_add_u32 s54, s54, 16384
    s_addc_u32 s55, s55, 0
    s_add_u32 m0, s52, 2048
    s_nop 0
    global_load_lds_dwordx4 v4, s[54:55]
    s_add_u32 s54, s54, 16384
    s_addc_u32 s55, s55, 0
    s_add_u32 m0, s52, 3072
    s_nop 0
    global_load_lds_dwordx4 v4, s[54:55]
    s_add_u32 s54, s54, 16384
    s_addc_u32 s55, s55, 0
    s_waitcnt vmcnt(28)
    ds_read_b64_tr_b16 a[16:17], v5 offset:4096
    ds_read_b64_tr_b16 a[18:19], v5 offset:5120
    ds_read_b64_tr_b16 a[20:21], v5 offset:4104
    ds_read_b64_tr_b16 a[22:23], v5 offset:5128
    ds_read_b64_tr_b16 a[24:25], v5 offset:6144
    ds_read_b64_tr_b16 a[26:27], v5 offset:7168
    ds_read_b64_tr_b16 a[28:29], v5 offset:6152
    ds_read_b64_tr_b16 a[30:31], v5 offset:7176
    s_waitcnt lgkmcnt(0)
    s_add_u32 m0, s52, 4096
    s_nop 0
    global_load_lds_dwordx4 v4, s[54:55]
    s_add_u32 s54, s54, 16384
    s_addc_u32 s55, s55, 0
    s_add_u32 m0, s52, 5120
    s_nop 0
    global_load_lds_dwordx4 v4, s[54:55]
    s_add_u32 s54, s54, 16384
    s_addc_u32 s55, s55, 0
    s_add_u32 m0, s52, 6144
    s_nop 0
    global_load_lds_dwordx4 v4, s[54:55]
    s_add_u32 s54, s54, 16384
    s_addc_u32 s55, s55, 0
    s_add_u32 m0, s52, 7168
    s_nop 0
    global_load_lds_dwordx4 v4, s[54:55]
    s_add_u32 s54, s54, 16384
    s_addc_u32 s55, s55, 0
    s_waitcnt vmcnt(28)
    ds_read_b64_tr_b16 a[32:33], v5 offset:8192
    ds_read_b64_tr_b16 a[34:35], v5 offset:9216
    ds_read_b64_tr_b16 a[36:37], v5 offset:8200
    ds_read_b64_tr_b16 a[38:39], v5 offset:9224
    ds_read_b64_tr_b16 a[40:41], v5 offset:10240
    ds_read_b64_tr_b16 a[42:43], v5 offset:11264
    ds_read_b64_tr_b16 a[44:45], v5 offset:10248
    ds_read_b64_tr_b16 a[46:47], v5 offset:11272
    s_waitcnt lgkmcnt(0)
    s_add_u32 m0, s52, 8192
    s_nop 0
    global_load_lds_dwordx4 v4, s[54:55]
    s_add_u32 s54, s54, 16384
    s_addc_u32 s55, s55, 0
    s_add_u32 m0, s52, 9216
    s_nop 0
    global_load_lds_dwordx4 v4, s[54:55]
    s_add_u32 s54, s54, 16384
    s_addc_u32 s55, s55, 0
    s_add_u32 m0, s52, 10240
    s_nop 0
    global_load_lds_dwordx4 v4, s[54:55]
    s_add_u32 s54, s54, 16384
    s_addc_u32 s55, s55, 0
    s_add_u32 m0, s52, 11264
    s_nop 0
    global_load_lds_dwordx4 v4, s[54:55]
    s_add_u32 s54, s54, 16384
    s_addc_u32 s55, s55, 0
    s_waitcnt vmcnt(28)
    ds_read_b64_tr_b16 a[48:49], v5 offset:12288
    ds_read_b64_tr_b16 a[50:51], v5 offset:13312
    ds_read_b64_tr_b16 a[52:53], v5 offset:12296
    ds_read_b64_tr_b16 a[54:55], v5 offset:13320
    ds_read_b64_tr_b16 a[56:57], v5 offset:14336
    ds_read_b64_tr_b16 a[58:59], v5 offset:15360
    ds_read_b64_tr_b16 a[60:61], v5 offset:14344
    ds_read_b64_tr_b16 a[62:63], v5 offset:15368
    s_waitcnt lgkmcnt(0)
    s_add_u32 m0, s52, 12288
    s_nop 0
    global_load_lds_dwordx4 v4, s[54:55]
    s_add_u32 s54, s54, 16384
    s_addc_u32 s55, s55, 0
    s_add_u32 m0, s52, 13312
    s_nop 0
    global_load_lds_dwordx4 v4, s[54:55]
    s_add_u32 s54, s54, 16384
    s_addc_u32 s55, s55, 0
    s_add_u32 m0, s52, 14336
    s_nop 0
    global_load_lds_dwordx4 v4, s[54:55]
    s_add_u32 s54, s54, 16384
    s_addc_u32 s55, s55, 0
    s_add_u32 m0, s52, 15360
    s_nop 0
    global_load_lds_dwordx4 v4, s[54:55]
    s_add_u32 s54, s54, 16384
    s_addc_u32 s55, s55, 0
    s_waitcnt vmcnt(28)
    ds_read_b64_tr_b16 a[64:65], v5 offset:16384
    ds_read_b64_tr_b16 a[66:67], v5 offset:17408
    ds_read_b64_tr_b16 a[68:69], v5 offset:16392
    ds_read_b64_tr_b16 a[70:71], v5 offset:17416
    ds_read_b64_tr_b16 a[72:73], v5 offset:18432
    ds_read_b64_tr_b16 a[74:75], v5 offset:19456
    ds_read_b64_tr_b16 a[76:77], v5 offset:18440
    ds_read_b64_tr_b16 a[78:79], v5 offset:19464
    s_waitcnt lgkmcnt(0)
    s_add_u32 m0, s52, 16384
    s_nop 0
    global_load_lds_dwordx4 v4, s[54:55]
    s_add_u32 s54, s54, 16384
    s_addc_u32 s55, s55, 0
    s_add_u32 m0, s52, 17408
    s_nop 0
    global_load_lds_dwordx4 v4, s[54:55]
    s_add_u32 s54, s54, 16384
    s_addc_u32 s55, s55, 0
    s_add_u32 m0, s52, 18432
    s_nop 0
    global_load_lds_dwordx4 v4, s[54:55]
    s_add_u32 s54, s54, 16384
    s_addc_u32 s55, s55, 0
    s_add_u32 m0, s52, 19456
    s_nop 0
    global_load_lds_dwordx4 v4, s[54:55]
    s_add_u32 s54, s54, 16384
    s_addc_u32 s55, s55, 0
    s_waitcnt vmcnt(28)
    ds_read_b64_tr_b16 a[80:81], v5 offset:20480
    ds_read_b64_tr_b16 a[82:83], v5 offset:21504
    ds_read_b64_tr_b16 a[84:85], v5 offset:20488
    ds_read_b64_tr_b16 a[86:87], v5 offset:21512
    ds_read_b64_tr_b16 a[88:89], v5 offset:22528
    ds_read_b64_tr_b16 a[90:91], v5 offset:23552
    ds_read_b64_tr_b16 a[92:93], v5 offset:22536
    ds_read_b64_tr_b16 a[94:95], v5 offset:23560
    s_waitcnt lgkmcnt(0)
    s_add_u32 m0, s52, 20480
    s_nop 0
    global_load_lds_dwordx4 v4, s[54:55]
    s_add_u32 s54, s54, 16384
    s_addc_u32 s55, s55, 0
    s_add_u32 m0, s52, 21504
    s_nop 0
    global_load_lds_dwordx4 v4, s[54:55]
    s_add_u32 s54, s54, 16384
    s_addc_u32 s55, s55, 0
    s_add_u32 m0, s52, 22528
    s_nop 0
    global_load_lds_dwordx4 v4, s[54:55]
    s_add_u32 s54, s54, 16384
    s_addc_u32 s55, s55, 0
    s_add_u32 m0, s52, 23552
    s_nop 0
    global_load_lds_dwordx4 v4, s[54:55]
    s_add_u32 s54, s54, 16384
    s_addc_u32 s55, s55, 0
    s_waitcnt vmcnt(28)
    ds_read_b64_tr_b16 a[96:97], v5 offset:24576
    ds_read_b64_tr_b16 a[98:99], v5 offset:25600
    ds_read_b64_tr_b16 a[100:101], v5 offset:24584
    ds_read_b64_tr_b16 a[102:103], v5 offset:25608
    ds_read_b64_tr_b16 a[104:105], v5 offset:26624
    ds_read_b64_tr_b16 a[106:107], v5 offset:27648
    ds_read_b64_tr_b16 a[108:109], v5 offset:26632
    ds_read_b64_tr_b16 a[110:111], v5 offset:27656
    s_waitcnt lgkmcnt(0)
    s_add_u32 m0, s52, 24576
    s_nop 0
    global_load_lds_dwordx4 v4, s[54:55]
    s_add_u32 s54, s54, 16384
    s_addc_u32 s55, s55, 0
    s_add_u32 m0, s52, 25600
    s_nop 0
    global_load_lds_dwordx4 v4, s[54:55]
    s_add_u32 s54, s54, 16384
    s_addc_u32 s55, s55, 0
    s_add_u32 m0, s52, 26624
    s_nop 0
    global_load_lds_dwordx4 v4, s[54:55]
    s_add_u32 s54, s54, 16384
    s_addc_u32 s55, s55, 0
    s_add_u32 m0, s52, 27648
    s_nop 0
    global_load_lds_dwordx4 v4, s[54:55]
    s_add_u32 s54, s54, 16384
    s_addc_u32 s55, s55, 0
    s_waitcnt vmcnt(28)
    ds_read_b64_tr_b16 a[112:113], v5 offset:28672
    ds_read_b64_tr_b16 a[114:115], v5 offset:29696
    ds_read_b64_tr_b16 a[116:117], v5 offset:28680
    ds_read_b64_tr_b16 a[118:119], v5 offset:29704
    ds_read_b64_tr_b16 a[120:121], v5 offset:30720
    ds_read_b64_tr_b16 a[122:123], v5 offset:31744
    ds_read_b64_tr_b16 a[124:125], v5 offset:30728
    ds_read_b64_tr_b16 a[126:127], v5 offset:31752
    s_waitcnt lgkmcnt(0)
    s_add_u32 m0, s52, 28672
    s_nop 0
    global_load_lds_dwordx4 v4, s[54:55]
    s_add_u32 s54, s54, 16384
    s_addc_u32 s55, s55, 0
    s_add_u32 m0, s52, 29696
    s_nop 0
    global_load_lds_dwordx4 v4, s[54:55]
    s_add_u32 s54, s54, 16384
    s_addc_u32 s55, s55, 0
    s_add_u32 m0, s52, 30720
    s_nop 0
    global_load_lds_dwordx4 v4, s[54:55]
    s_add_u32 s54, s54, 16384
    s_addc_u32 s55, s55, 0
    s_add_u32 m0, s52, 31744
    s_nop 0
    global_load_lds_dwordx4 v4, s[54:55]
    s_add_u32 s54, s54, 16384
    s_addc_u32 s55, s55, 0
    s_waitcnt vmcnt(28)
    ds_read_b64_tr_b16 a[128:129], v5 offset:0
    ds_read_b64_tr_b16 a[130:131], v5 offset:1024
    ds_read_b64_tr_b16 a[132:133], v5 offset:8
    ds_read_b64_tr_b16 a[134:135], v5 offset:1032
    ds_read_b64_tr_b16 a[136:137], v5 offset:2048
    ds_read_b64_tr_b16 a[138:139], v5 offset:3072
    ds_read_b64_tr_b16 a[140:141], v5 offset:2056
    ds_read_b64_tr_b16 a[142:143], v5 offset:3080
    s_waitcnt lgkmcnt(0)
    s_lshl_b32 s44, s3, 17
    s_lshl_b32 s45, s6, 6
    s_add_u32 s44, s44, s45
    s_add_u32 s54, s20, s44
    s_addc_u32 s55, s21, 0
    s_add_u32 m0, s52, 0
    s_nop 0
    global_load_lds_dwordx4 v4, s[54:55]
    s_add_u32 s54, s54, 16384
    s_addc_u32 s55, s55, 0
    s_add_u32 m0, s52, 1024
    s_nop 0
    global_load_lds_dwordx4 v4, s[54:55]
    s_add_u32 s54, s54, 16384
    s_addc_u32 s55, s55, 0
    s_add_u32 m0, s52, 2048
    s_nop 0
    global_load_lds_dwordx4 v4, s[54:55]
    s_add_u32 s54, s54, 16384
    s_addc_u32 s55, s55, 0
    s_add_u32 m0, s52, 3072
    s_nop 0
    global_load_lds_dwordx4 v4, s[54:55]
    s_add_u32 s54, s54, 16384
    s_addc_u32 s55, s55, 0
    s_waitcnt vmcnt(28)
    ds_read_b64_tr_b16 a[144:145], v5 offset:4096
    ds_read_b64_tr_b16 a[146:147], v5 offset:5120
    ds_read_b64_tr_b16 a[148:149], v5 offset:4104
    ds_read_b64_tr_b16 a[150:151], v5 offset:5128
    ds_read_b64_tr_b16 a[152:153], v5 offset:6144
    ds_read_b64_tr_b16 a[154:155], v5 offset:7168
    ds_read_b64_tr_b16 a[156:157], v5 offset:6152
    ds_read_b64_tr_b16 a[158:159], v5 offset:7176
    s_waitcnt lgkmcnt(0)
    s_add_u32 m0, s52, 4096
    s_nop 0
    global_load_lds_dwordx4 v4, s[54:55]
    s_add_u32 s54, s54, 16384
    s_addc_u32 s55, s55, 0
    s_add_u32 m0, s52, 5120
    s_nop 0
    global_load_lds_dwordx4 v4, s[54:55]
    s_add_u32 s54, s54, 16384
    s_addc_u32 s55, s55, 0
    s_add_u32 m0, s52, 6144
    s_nop 0
    global_load_lds_dwordx4 v4, s[54:55]
    s_add_u32 s54, s54, 16384
    s_addc_u32 s55, s55, 0
    s_add_u32 m0, s52, 7168
    s_nop 0
    global_load_lds_dwordx4 v4, s[54:55]
    s_add_u32 s54, s54, 16384
    s_addc_u32 s55, s55, 0
    s_waitcnt vmcnt(28)
    ds_read_b64_tr_b16 a[160:161], v5 offset:8192
    ds_read_b64_tr_b16 a[162:163], v5 offset:9216
    ds_read_b64_tr_b16 a[164:165], v5 offset:8200
    ds_read_b64_tr_b16 a[166:167], v5 offset:9224
    ds_read_b64_tr_b16 a[168:169], v5 offset:10240
    ds_read_b64_tr_b16 a[170:171], v5 offset:11264
    ds_read_b64_tr_b16 a[172:173], v5 offset:10248
    ds_read_b64_tr_b16 a[174:175], v5 offset:11272
    s_waitcnt lgkmcnt(0)
    s_waitcnt vmcnt(24)
    ds_read_b64_tr_b16 a[176:177], v5 offset:12288
    ds_read_b64_tr_b16 a[178:179], v5 offset:13312
    ds_read_b64_tr_b16 a[180:181], v5 offset:12296
    ds_read_b64_tr_b16 a[182:183], v5 offset:13320
    ds_read_b64_tr_b16 a[184:185], v5 offset:14336
    ds_read_b64_tr_b16 a[186:187], v5 offset:15360
    ds_read_b64_tr_b16 a[188:189], v5 offset:14344
    ds_read_b64_tr_b16 a[190:191], v5 offset:15368
    s_waitcnt lgkmcnt(0)
    s_waitcnt vmcnt(20)
    ds_read_b64_tr_b16 a[192:193], v5 offset:16384
    ds_read_b64_tr_b16 a[194:195], v5 offset:17408
    ds_read_b64_tr_b16 a[196:197], v5 offset:16392
    ds_read_b64_tr_b16 a[198:199], v5 offset:17416
    ds_read_b64_tr_b16 a[200:201], v5 offset:18432
    ds_read_b64_tr_b16 a[202:203], v5 offset:19456
    ds_read_b64_tr_b16 a[204:205], v5 offset:18440
    ds_read_b64_tr_b16 a[206:207], v5 offset:19464
    s_waitcnt lgkmcnt(0)
    s_waitcnt vmcnt(16)
    ds_read_b64_tr_b16 a[208:209], v5 offset:20480
    ds_read_b64_tr_b16 a[210:211], v5 offset:21504
    ds_read_b64_tr_b16 a[212:213], v5 offset:20488
    ds_read_b64_tr_b16 a[214:215], v5 offset:21512
    ds_read_b64_tr_b16 a[216:217], v5 offset:22528
    ds_read_b64_tr_b16 a[218:219], v5 offset:23552
    ds_read_b64_tr_b16 a[220:221], v5 offset:22536
    ds_read_b64_tr_b16 a[222:223], v5 offset:23560
    s_waitcnt lgkmcnt(0)
    s_waitcnt vmcnt(12)
    ds_read_b64_tr_b16 a[224:225], v5 offset:24576
    ds_read_b64_tr_b16 a[226:227], v5 offset:25600
    ds_read_b64_tr_b16 a[228:229], v5 offset:24584
    ds_read_b64_tr_b16 a[230:231], v5 offset:25608
    ds_read_b64_tr_b16 a[232:233], v5 offset:26624
    ds_read_b64_tr_b16 a[234:235], v5 offset:27648
    ds_read_b64_tr_b16 a[236:237], v5 offset:26632
    ds_read_b64_tr_b16 a[238:239], v5 offset:27656
    s_waitcnt lgkmcnt(0)
    s_waitcnt vmcnt(8)
    ds_read_b64_tr_b16 a[240:241], v5 offset:28672
    ds_read_b64_tr_b16 a[242:243], v5 offset:29696
    ds_read_b64_tr_b16 a[244:245], v5 offset:28680
    ds_read_b64_tr_b16 a[246:247], v5 offset:29704
    ds_read_b64_tr_b16 a[248:249], v5 offset:30720
    ds_read_b64_tr_b16 a[250:251], v5 offset:31744
    ds_read_b64_tr_b16 a[252:253], v5 offset:30728
    ds_read_b64_tr_b16 a[254:255], v5 offset:31752
    s_waitcnt lgkmcnt(0)
    s_waitcnt vmcnt(4)
    ds_read_b64_tr_b16 v[16:17], v6 offset:0
    ds_read_b64_tr_b16 v[18:19], v6 offset:512
    ds_read_b64_tr_b16 v[20:21], v6 offset:8
    ds_read_b64_tr_b16 v[22:23], v6 offset:520
    ds_read_b64_tr_b16 v[24:25], v6 offset:2048
    ds_read_b64_tr_b16 v[26:27], v6 offset:2560
    ds_read_b64_tr_b16 v[28:29], v6 offset:2056
    ds_read_b64_tr_b16 v[30:31], v6 offset:2568
    s_waitcnt lgkmcnt(0)
    s_waitcnt vmcnt(0)
    ds_read_b64_tr_b16 v[32:33], v6 offset:4096
    ds_read_b64_tr_b16 v[34:35], v6 offset:4608
    ds_read_b64_tr_b16 v[36:37], v6 offset:4104
    ds_read_b64_tr_b16 v[38:39], v6 offset:4616
    ds_read_b64_tr_b16 v[40:41], v6 offset:6144
    ds_read_b64_tr_b16 v[42:43], v6 offset:6656
    ds_read_b64_tr_b16 v[44:45], v6 offset:6152
    ds_read_b64_tr_b16 v[46:47], v6 offset:6664
    s_waitcnt lgkmcnt(0)
    global_load_dwordx4 v[48:51], v1, s[36:37] offset:0
    global_load_dwordx4 v[52:55], v1, s[36:37] offset:64
    global_load_dwordx4 v[56:59], v1, s[36:37] offset:128
    global_load_dwordx4 v[60:63], v1, s[36:37] offset:192
    v_lshrrev_b32 v1, 4, v0
    v_lshlrev_b32 v1, 4, v1
    v_lshl_add_u32 v8, v2, 10, v1
    s_lshl_b32 s44, s6, 6
    v_add_u32 v8, s44, v8
    s_mul_i32 s44, s3, 5120
    v_add_u32 v9, s44, v3
    s_mov_b32 s64, s7
    s_mov_b32 s65, 0
    s_mov_b32 s66, 0
    s_waitcnt vmcnt(0)
    s_barrier
Ls2_158:
    s_lshr_b32 s11, s64, 1
    s_lshl_b32 s44, s11, 7
    s_add_u32 s44, s44, 84508672
    v_mov_b32 v1, s44
Lwf_160:
    global_load_dword v2, v1, s[42:43] sc1
    s_add_u32 s10, s10, 1
    s_cmp_gt_u32 s10, 0x80000
    s_cbranch_scc1 Lwf_161
    s_waitcnt vmcnt(0)
    v_readfirstlane_b32 s44, v2
    s_nop 0
    s_and_b32 s44, s44, 65535
    s_cmp_eq_u32 s44, 16
    s_cbranch_scc1 Lwf_161
    s_sleep 4
    s_branch Lwf_160
Lwf_161:
    s_lshl_b32 s44, s64, 17
    s_lshl_b32 s45, s3, 15
    s_add_u32 s44, s44, s45
    s_add_u32 s56, s42, s44
    s_addc_u32 s57, s43, 0
    s_add_u32 s56, s56, 50331648
    s_addc_u32 s57, s57, 0
    s_lshl_b32 s44, s64, 14
    s_lshl_b32 s45, s3, 12
    s_add_u32 s45, s44, s45
    s_add_u32 s58, s42, s45
    s_addc_u32 s59, s43, 0
    s_add_u32 s58, s58, 81788928
    s_addc_u32 s59, s59, 0
    s_add_u32 s60, s16, s44
    s_addc_u32 s61, s17, 0
    s_add_u32 s62, s38, s44
    s_addc_u32 s63, s39, 0
    global_load_dwordx4 v[64:67], v7, s[60:61] offset:0
    global_load_dwordx4 v[68:71], v7, s[60:61] offset:64
    global_load_dwordx4 v[72:75], v7, s[60:61] offset:128
    global_load_dwordx4 v[76:79], v7, s[60:61] offset:192
    global_load_dwordx4 v[80:83], v3, s[58:59] offset:0 sc1
    global_load_dwordx4 v[84:87], v3, s[58:59] offset:1024 sc1
    global_load_dwordx4 v[88:91], v3, s[58:59] offset:2048 sc1
    global_load_dwordx4 v[92:95], v3, s[58:59] offset:3072 sc1
    s_lshr_b32 s11, s64, 1
    s_cmp_lg_u32 s3, 0
    s_cbranch_scc1 Lwx_163
    s_lshl_b32 s44, s11, 7
    s_add_u32 s44, s44, 84500480
    v_and_b32 v1, 31, v0
    v_lshlrev_b32 v1, 2, v1
    v_add_u32 v1, s44, v1
Lwx_162:
    global_load_dword v2, v1, s[42:43] sc1
    s_add_u32 s10, s10, 1
    s_cmp_gt_u32 s10, 0x80000
    s_cbranch_scc1 Lwx_163
    s_waitcnt vmcnt(0)
    v_cmp_ne_u32 vcc, 1, v2
    s_cbranch_vccz Lwx_163
    s_sleep 2
    s_branch Lwx_162
Lwx_163:
    s_barrier
    global_load_dwordx4 v[96:99], v3, s[56:57] offset:0 sc1
    global_load_dwordx4 v[100:103], v3, s[56:57] offset:1024 sc1
    global_load_dwordx4 v[104:107], v3, s[56:57] offset:2048 sc1
    global_load_dwordx4 v[108:111], v3, s[56:57] offset:3072 sc1
    s_add_u32 s56, s56, 4096
    s_addc_u32 s57, s57, 0
    global_load_dwordx4 v[112:115], v3, s[56:57] offset:0 sc1
    global_load_dwordx4 v[116:119], v3, s[56:57] offset:1024 sc1
    global_load_dwordx4 v[120:123], v3, s[56:57] offset:2048 sc1
    global_load_dwordx4 v[124:127], v3, s[56:57] offset:3072 sc1
    s_add_u32 s56, s56, 4096
    s_addc_u32 s57, s57, 0
    global_load_dwordx4 v[128:131], v3, s[56:57] offset:0 sc1
    global_load_dwordx4 v[132:135], v3, s[56:57] offset:1024 sc1
    global_load_dwordx4 v[136:139], v3, s[56:57] offset:2048 sc1
    global_load_dwordx4 v[140:143], v3, s[56:57] offset:3072 sc1
    s_add_u32 s56, s56, 4096
    s_addc_u32 s57, s57, 0
    global_load_dwordx4 v[144:147], v3, s[56:57] offset:0 sc1
    global_load_dwordx4 v[148:151], v3, s[56:57] offset:1024 sc1
    global_load_dwordx4 v[152:155], v3, s[56:57] offset:2048 sc1
    global_load_dwordx4 v[156:159], v3, s[56:57] offset:3072 sc1
    s_add_u32 s56, s56, 4096
    s_addc_u32 s57, s57, 0
    global_load_dwordx4 v[160:163], v3, s[56:57] offset:0 sc1
    global_load_dwordx4 v[164:167], v3, s[56:57] offset:1024 sc1
    global_load_dwordx4 v[168:171], v3, s[56:57] offset:2048 sc1
    global_load_dwordx4 v[172:175], v3, s[56:57] offset:3072 sc1
    s_add_u32 s56, s56, 4096
    s_addc_u32 s57, s57, 0
    global_load_dwordx4 v[176:179], v3, s[56:57] offset:0 sc1
    global_load_dwordx4 v[180:183], v3, s[56:57] offset:1024 sc1
    global_load_dwordx4 v[184:187], v3, s[56:57] offset:2048 sc1
    global_load_dwordx4 v[188:191], v3, s[56:57] offset:3072 sc1
    s_add_u32 s56, s56, 4096
    s_addc_u32 s57, s57, 0
    global_load_dwordx4 v[192:195], v3, s[56:57] offset:0 sc1
    global_load_dwordx4 v[196:199], v3, s[56:57] offset:1024 sc1
    global_load_dwordx4 v[200:203], v3, s[56:57] offset:2048 sc1
    global_load_dwordx4 v[204:207], v3, s[56:57] offset:3072 sc1
    s_add_u32 s56, s56, 4096
    s_addc_u32 s57, s57, 0
    global_load_dwordx4 v[208:211], v3, s[56:57] offset:0 sc1
    global_load_dwordx4 v[212:215], v3, s[56:57] offset:1024 sc1
    global_load_dwordx4 v[216:219], v3, s[56:57] offset:2048 sc1
    global_load_dwordx4 v[220:223], v3, s[56:57] offset:3072 sc1
    s_waitcnt vmcnt(32)
    v_mfma_f32_16x16x32_bf16 v[240:243], v[48:51], v[64:67], 0
    v_mfma_f32_16x16x32_bf16 v[240:243], v[52:55], v[68:71], v[240:243]
    v_mfma_f32_16x16x32_bf16 v[240:243], v[56:59], v[72:75], v[240:243]
    v_mfma_f32_16x16x32_bf16 v[240:243], v[60:63], v[76:79], v[240:243]
    v_mfma_f32_16x16x32_bf16 v[232:235], v[16:19], v[80:83], 0
    v_mfma_f32_16x16x32_bf16 v[236:239], v[20:23], v[80:83], 0
    v_mfma_f32_16x16x32_bf16 v[232:235], v[24:27], v[84:87], v[232:235]
    v_mfma_f32_16x16x32_bf16 v[236:239], v[28:31], v[84:87], v[236:239]
    v_mfma_f32_16x16x32_bf16 v[232:235], v[32:35], v[88:91], v[232:235]
    v_mfma_f32_16x16x32_bf16 v[236:239], v[36:39], v[88:91], v[236:239]
    v_mfma_f32_16x16x32_bf16 v[232:235], v[40:43], v[92:95], v[232:235]
    v_mfma_f32_16x16x32_bf16 v[236:239], v[44:47], v[92:95], v[236:239]
    s_waitcnt vmcnt(31)
    v_mfma_f32_16x16x32_bf16 v[224:227], a[0:3], v[96:99], 0
    v_mfma_f32_16x16x32_bf16 v[228:231], a[4:7], v[96:99], 0
    s_waitcnt vmcnt(30)
    v_mfma_f32_16x16x32_bf16 v[224:227], a[8:11], v[100:103], v[224:227]
    v_mfma_f32_16x16x32_bf16 v[228:231], a[12:15], v[100:103], v[228:231]
    s_waitcnt vmcnt(29)
    v_mfma_f32_16x16x32_bf16 v[224:227], a[16:19], v[104:107], v[224:227]
    v_mfma_f32_16x16x32_bf16 v[228:231], a[20:23], v[104:107], v[228:231]
    s_waitcnt vmcnt(28)
    v_mfma_f32_16x16x32_bf16 v[224:227], a[24:27], v[108:111], v[224:227]
    v_mfma_f32_16x16x32_bf16 v[228:231], a[28:31], v[108:111], v[228:231]
    s_waitcnt vmcnt(27)
    v_mfma_f32_16x16x32_bf16 v[224:227], a[32:35], v[112:115], v[224:227]
    v_mfma_f32_16x16x32_bf16 v[228:231], a[36:39], v[112:115], v[228:231]
    s_waitcnt vmcnt(26)
    v_mfma_f32_16x16x32_bf16 v[224:227], a[40:43], v[116:119], v[224:227]
    v_mfma_f32_16x16x32_bf16 v[228:231], a[44:47], v[116:119], v[228:231]
    s_waitcnt vmcnt(25)
    v_mfma_f32_16x16x32_bf16 v[224:227], a[48:51], v[120:123], v[224:227]
    v_mfma_f32_16x16x32_bf16 v[228:231], a[52:55], v[120:123], v[228:231]
    s_waitcnt vmcnt(24)
    v_mfma_f32_16x16x32_bf16 v[224:227], a[56:59], v[124:127], v[224:227]
    v_mfma_f32_16x16x32_bf16 v[228:231], a[60:63], v[124:127], v[228:231]
    s_waitcnt vmcnt(23)
    v_mfma_f32_16x16x32_bf16 v[224:227], a[64:67], v[128:131], v[224:227]
    v_mfma_f32_16x16x32_bf16 v[228:231], a[68:71], v[128:131], v[228:231]
    s_waitcnt vmcnt(22)
    v_mfma_f32_16x16x32_bf16 v[224:227], a[72:75], v[132:135], v[224:227]
    v_mfma_f32_16x16x32_bf16 v[228:231], a[76:79], v[132:135], v[228:231]
    s_waitcnt vmcnt(21)
    v_mfma_f32_16x16x32_bf16 v[224:227], a[80:83], v[136:139], v[224:227]
    v_mfma_f32_16x16x32_bf16 v[228:231], a[84:87], v[136:139], v[228:231]
    s_waitcnt vmcnt(20)
    v_mfma_f32_16x16x32_bf16 v[224:227], a[88:91], v[140:143], v[224:227]
    v_mfma_f32_16x16x32_bf16 v[228:231], a[92:95], v[140:143], v[228:231]
    s_waitcnt vmcnt(19)
    v_mfma_f32_16x16x32_bf16 v[224:227], a[96:99], v[144:147], v[224:227]
    v_mfma_f32_16x16x32_bf16 v[228:231], a[100:103], v[144:147], v[228:231]
    s_waitcnt vmcnt(18)
    v_mfma_f32_16x16x32_bf16 v[224:227], a[104:107], v[148:151], v[224:227]
    v_mfma_f32_16x16x32_bf16 v[228:231], a[108:111], v[148:151], v[228:231]
    s_waitcnt vmcnt(17)
    v_mfma_f32_16x16x32_bf16 v[224:227], a[112:115], v[152:155], v[224:227]
    v_mfma_f32_16x16x32_bf16 v[228:231], a[116:119], v[152:155], v[228:231]
    s_waitcnt vmcnt(16)
    v_mfma_f32_16x16x32_bf16 v[224:227], a[120:123], v[156:159], v[224:227]
    v_mfma_f32_16x16x32_bf16 v[228:231], a[124:127], v[156:159], v[228:231]
    s_waitcnt vmcnt(15)
    v_mfma_f32_16x16x32_bf16 v[224:227], a[128:131], v[160:163], v[224:227]
    v_mfma_f32_16x16x32_bf16 v[228:231], a[132:135], v[160:163], v[228:231]
    s_waitcnt vmcnt(14)
    v_mfma_f32_16x16x32_bf16 v[224:227], a[136:139], v[164:167], v[224:227]
    v_mfma_f32_16x16x32_bf16 v[228:231], a[140:143], v[164:167], v[228:231]
    s_waitcnt vmcnt(13)
    v_mfma_f32_16x16x32_bf16 v[224:227], a[144:147], v[168:171], v[224:227]
    v_mfma_f32_16x16x32_bf16 v[228:231], a[148:151], v[168:171], v[228:231]
    s_waitcnt vmcnt(12)
    v_mfma_f32_16x16x32_bf16 v[224:227], a[152:155], v[172:175], v[224:227]
    v_mfma_f32_16x16x32_bf16 v[228:231], a[156:159], v[172:175], v[228:231]
    s_waitcnt vmcnt(11)
    v_mfma_f32_16x16x32_bf16 v[224:227], a[160:163], v[176:179], v[224:227]
    v_mfma_f32_16x16x32_bf16 v[228:231], a[164:167], v[176:179], v[228:231]
    s_waitcnt vmcnt(10)
    v_mfma_f32_16x16x32_bf16 v[224:227], a[168:171], v[180:183], v[224:227]
    v_mfma_f32_16x16x32_bf16 v[228:231], a[172:175], v[180:183], v[228:231]
    s_waitcnt vmcnt(9)
    v_mfma_f32_16x16x32_bf16 v[224:227], a[176:179], v[184:187], v[224:227]
    v_mfma_f32_16x16x32_bf16 v[228:231], a[180:183], v[184:187], v[228:231]
    s_waitcnt vmcnt(8)
    v_mfma_f32_16x16x32_bf16 v[224:227], a[184:187], v[188:191], v[224:227]
    v_mfma_f32_16x16x32_bf16 v[228:231], a[188:191], v[188:191], v[228:231]
    s_waitcnt vmcnt(7)
    v_mfma_f32_16x16x32_bf16 v[224:227], a[192:195], v[192:195], v[224:227]
    v_mfma_f32_16x16x32_bf16 v[228:231], a[196:199], v[192:195], v[228:231]
    s_waitcnt vmcnt(6)
    v_mfma_f32_16x16x32_bf16 v[224:227], a[200:203], v[196:199], v[224:227]
    v_mfma_f32_16x16x32_bf16 v[228:231], a[204:207], v[196:199], v[228:231]
    s_waitcnt vmcnt(5)
    v_mfma_f32_16x16x32_bf16 v[224:227], a[208:211], v[200:203], v[224:227]
    v_mfma_f32_16x16x32_bf16 v[228:231], a[212:215], v[200:203], v[228:231]
    s_waitcnt vmcnt(4)
    v_mfma_f32_16x16x32_bf16 v[224:227], a[216:219], v[204:207], v[224:227]
    v_mfma_f32_16x16x32_bf16 v[228:231], a[220:223], v[204:207], v[228:231]
    s_waitcnt vmcnt(3)
    v_mfma_f32_16x16x32_bf16 v[224:227], a[224:227], v[208:211], v[224:227]
    v_mfma_f32_16x16x32_bf16 v[228:231], a[228:231], v[208:211], v[228:231]
    s_waitcnt vmcnt(2)
    v_mfma_f32_16x16x32_bf16 v[224:227], a[232:235], v[212:215], v[224:227]
    v_mfma_f32_16x16x32_bf16 v[228:231], a[236:239], v[212:215], v[228:231]
    s_waitcnt vmcnt(1)
    v_mfma_f32_16x16x32_bf16 v[224:227], a[240:243], v[216:219], v[224:227]
    v_mfma_f32_16x16x32_bf16 v[228:231], a[244:247], v[216:219], v[228:231]
    s_waitcnt vmcnt(0)
    v_mfma_f32_16x16x32_bf16 v[224:227], a[248:251], v[220:223], v[224:227]
    v_mfma_f32_16x16x32_bf16 v[228:231], a[252:255], v[220:223], v[228:231]
    v_add_u32 v1, s65, v9
    s_nop 2
    ds_write_b128 v1, v[224:227] offset:0
    s_nop 2
    ds_write_b128 v1, v[228:231] offset:1024
    ds_write_b128 v1, v[232:235] offset:2048
    ds_write_b128 v1, v[236:239] offset:3072
    ds_write_b128 v1, v[240:243] offset:4096
    s_waitcnt lgkmcnt(0)
    s_barrier
    s_and_b32 s44, s66, 3
    s_cmp_lg_u32 s44, s3
    s_cbranch_scc1 Ls2s_159
    v_add_u32 v1, s65, v3
    ds_read_b128 v[64:67], v1 offset:0
    ds_read_b128 v[68:71], v1 offset:1024
    ds_read_b128 v[72:75], v1 offset:2048
    ds_read_b128 v[76:79], v1 offset:3072
    ds_read_b128 v[80:83], v1 offset:4096
    ds_read_b128 v[84:87], v1 offset:5120
    ds_read_b128 v[88:91], v1 offset:6144
    ds_read_b128 v[92:95], v1 offset:7168
    ds_read_b128 v[96:99], v1 offset:8192
    ds_read_b128 v[100:103], v1 offset:9216
    ds_read_b128 v[104:107], v1 offset:10240
    ds_read_b128 v[108:111], v1 offset:11264
    ds_read_b128 v[112:115], v1 offset:12288
    ds_read_b128 v[116:119], v1 offset:13312
    ds_read_b128 v[120:123], v1 offset:14336
    ds_read_b128 v[124:127], v1 offset:15360
    ds_read_b128 v[128:131], v1 offset:16384
    ds_read_b128 v[132:135], v1 offset:17408
    ds_read_b128 v[136:139], v1 offset:18432
    ds_read_b128 v[140:143], v1 offset:19456
    s_waitcnt lgkmcnt(0)
    v_add_f32 v64, v64, v84
    v_add_f32 v104, v104, v124
    v_add_f32 v64, v64, v104
    v_add_f32 v65, v65, v85
    v_add_f32 v105, v105, v125
    v_add_f32 v65, v65, v105
    v_add_f32 v66, v66, v86
    v_add_f32 v106, v106, v126
    v_add_f32 v66, v66, v106
    v_add_f32 v67, v67, v87
    v_add_f32 v107, v107, v127
    v_add_f32 v67, v67, v107
    v_add_f32 v68, v68, v88
    v_add_f32 v108, v108, v128
    v_add_f32 v68, v68, v108
    v_add_f32 v69, v69, v89
    v_add_f32 v109, v109, v129
    v_add_f32 v69, v69, v109
    v_add_f32 v70, v70, v90
    v_add_f32 v110, v110, v130
    v_add_f32 v70, v70, v110
    v_add_f32 v71, v71, v91
    v_add_f32 v111, v111, v131
    v_add_f32 v71, v71, v111
    v_add_f32 v72, v72, v92
    v_add_f32 v112, v112, v132
    v_add_f32 v72, v72, v112
    v_add_f32 v73, v73, v93
    v_add_f32 v113, v113, v133
    v_add_f32 v73, v73, v113
    v_add_f32 v74, v74, v94
    v_add_f32 v114, v114, v134
    v_add_f32 v74, v74, v114
    v_add_f32 v75, v75, v95
    v_add_f32 v115, v115, v135
    v_add_f32 v75, v75, v115
    v_add_f32 v76, v76, v96
    v_add_f32 v116, v116, v136
    v_add_f32 v76, v76, v116
    v_add_f32 v77, v77, v97
    v_add_f32 v117, v117, v137
    v_add_f32 v77, v77, v117
    v_add_f32 v78, v78, v98
    v_add_f32 v118, v118, v138
    v_add_f32 v78, v78, v118
    v_add_f32 v79, v79, v99
    v_add_f32 v119, v119, v139
    v_add_f32 v79, v79, v119
    v_add_f32 v80, v80, v100
    v_add_f32 v120, v120, v140
    v_add_f32 v80, v80, v120
    v_mul_f32 v80, 0xbfb8aa3b, v80
    v_exp_f32 v80, v80
    s_nop 0
    v_add_f32 v80, 1.0, v80
    v_rcp_f32 v80, v80
    v_sub_f32 v72, v72, v64
    v_fma_f32 v64, v80, v72, v64
    v_sub_f32 v73, v73, v65
    v_fma_f32 v65, v80, v73, v65
    v_sub_f32 v74, v74, v66
    v_fma_f32 v66, v80, v74, v66
    v_sub_f32 v75, v75, v67
    v_fma_f32 v67, v80, v75, v67
    v_sub_f32 v76, v76, v68
    v_fma_f32 v68, v80, v76, v68
    v_sub_f32 v77, v77, v69
    v_fma_f32 v69, v80, v77, v69
    v_sub_f32 v78, v78, v70
    v_fma_f32 v70, v80, v78, v70
    v_sub_f32 v79, v79, v71
    v_fma_f32 v71, v80, v79, v71
    v_cvt_pk_bf16_f32 v84, v64, v65
    v_cvt_pk_bf16_f32 v85, v66, v67
    v_cvt_pk_bf16_f32 v86, v68, v69
    v_cvt_pk_bf16_f32 v87, v70, v71
    global_store_dwordx4 v8, v[84:87], s[62:63]
    s_nop 1
Ls2s_159:
    s_xor_b32 s65, s65, 20480
    s_add_u32 s66, s66, 1
    s_add_u32 s64, s64, 7
    s_cmp_lt_u32 s64, 128
    s_cbranch_scc1 Ls2_158
    s_waitcnt vmcnt(0)
L_end:
    s_endpgm
Lcode_end:
.section .rodata,"a"
.p2align 6
.amdhsa_kernel gated_mix__sliding_block__memory_aug_recurrent_mem_tr__prompt_kernel
  .amdhsa_next_free_vgpr 512
  .amdhsa_next_free_sgpr 102
  .amdhsa_accum_offset 256
  .amdhsa_group_segment_fixed_size 0
  .amdhsa_kernarg_size 112
  .amdhsa_user_sgpr_count 2
  .amdhsa_user_sgpr_kernarg_segment_ptr 1
  .amdhsa_system_sgpr_workgroup_id_x 1
.end_amdhsa_kernel
```
